```python
import torch

def _softmax(x, axis=-1):
    return torch.softmax(x, dim=axis)
def _gelu(x):
    return torch.nn.functional.gelu(x, approximate="tanh")
def _silu(x):
    return torch.nn.functional.silu(x)
def _sigmoid(x):
    return torch.sigmoid(x)
def _layernorm(x, axis=-1, eps=1e-5):
    m = x.mean(dim=axis, keepdim=True)
    v = x.var(dim=axis, keepdim=True, unbiased=False)
    return (x - m) / torch.sqrt(v + eps)
def _scatter_add(tgt, idx, src, axis=0):
    return tgt.clone().index_add_(axis, idx, src)
def _segment_sum(src, seg, n):
    out = torch.zeros((n,) + src.shape[1:], dtype=src.dtype)
    return out.index_add_(0, seg, src)
def _pad(x, pw):
    flat = tuple(v for pair in reversed(pw) for v in pair)
    return torch.nn.functional.pad(x, flat)

kernel_name = 'recurrent_scan__spectral_gfnet__mixer_channel_mlp__prompt'

def setup_inputs():

    _w = (lambda a: (lambda t: t.to(torch.bfloat16) if t.is_floating_point() else t)(torch.as_tensor(a)))
    def _A_setup():
        B, S, D = 1, 2048, 640
        Df = D // 2 + 1
        return {
            "x": _w((lambda *s: torch.randn(*s, dtype=torch.bfloat16) * 0.05)(B, S, D)),
            "w_r": _w((lambda *s: torch.randn(*s, dtype=torch.bfloat16) * 0.8)(S, Df) * 0.02),
            "w_i": _w((lambda *s: torch.randn(*s, dtype=torch.bfloat16) * 0.8)(S, Df) * 0.02),
        }
    _A_in = _A_setup()

    def _B_setup():
        B, S, D, F = 1, 2048, 640, 1536
        return {
            "x": _w((lambda *s: torch.randn(*s, dtype=torch.bfloat16) * 0.05)(B, S, D)),
            "w1": _w((lambda *s: torch.randn(*s, dtype=torch.bfloat16) * 3.2)(D, F) * (D ** -0.5)),
            "b1": _w((lambda *s: torch.randn(*s, dtype=torch.bfloat16) * 1.6)(F)),
            "w2": _w((lambda *s: torch.randn(*s, dtype=torch.bfloat16) * 0.2)(F, D) * (F ** -0.5)),
            "b2": _w((lambda *s: torch.randn(*s, dtype=torch.bfloat16) * 0.2)(D)),
        }
    _B_in = _B_setup()

    return {
        "A_x": _A_in["x"],
        "A_w_r": _A_in["w_r"],
        "A_w_i": _A_in["w_i"],
        "B_x": _B_in["x"],
        "B_w1": _B_in["w1"],
        "B_b1": _B_in["b1"],
        "B_w2": _B_in["w2"],
        "B_b2": _B_in["b2"],
    }

def reference(A_x, A_w_r, A_w_i, B_x, B_w1, B_b1, B_w2, B_b2):
    def _A_ref(x, w_r, w_i):
        B, S, D = x.shape
        X = (lambda x, axes=(-2,-1): torch.fft.rfft2(x.float(), dim=axes))(x, axes=(-2, -1))
        W = w_r + 1j * w_i
        X = X * W
        y = (lambda x, s, axes=(-2,-1): torch.fft.irfft2(x, s=s, dim=axes).to(torch.bfloat16))(X, (S, D), axes=(-2, -1))
        return y

    def _B_ref(x, w1, b1, w2, b2):
        y = _layernorm(x, axis=-1)
        h = _gelu(torch.einsum("bsd,df->bsf", y, w1) + b1)
        return torch.einsum("bsf,fd->bsd", h, w2) + b2

    x = A_x
    xn = _layernorm(x, axis=-1)
    s = _A_ref(xn, A_w_r, A_w_i)
    g = _silu(_B_ref(xn, B_w1, B_b1, B_w2, B_b2))
    return x + s * g
```

```asm
; @launch grid=(256,1,1) block=(512,1,1) lds=163840
.amdgcn_target "amdgcn-amd-amdhsa--gfx950"
.text
.globl recurrent_scan__spectral_gfnet__mixer_channel_mlp__prompt_kernel
.p2align 8
.type recurrent_scan__spectral_gfnet__mixer_channel_mlp__prompt_kernel,@function
recurrent_scan__spectral_gfnet__mixer_channel_mlp__prompt_kernel:
    s_cmpk_ge_u32 s2, 0x100
    s_cbranch_scc1 L_exit
    s_load_dwordx16 s[4:19], s[0:1], 0
    s_load_dwordx2 s[20:21], s[0:1], 64
    s_load_dwordx2 s[24:25], s[0:1], 80
    s_getpc_b64 s[48:49]
    s_and_b32 s48, s48, 0xffffff00
    s_mov_b32 s50, L_exit-recurrent_scan__spectral_gfnet__mixer_channel_mlp__prompt_kernel
    s_mov_b32 s51, 0x20000
    v_lshrrev_b32 v1, 3, v0
    v_lshlrev_b32 v1, 9, v1
    s_lshl_b32 s3, s2, 4
    s_and_b32 s3, s3, 0x180
    s_mov_b32 exec_lo, 0x01010101
    s_mov_b32 exec_hi, 0x01010101
    buffer_load_dword v248, v1, s[48:51], s3 offen
    s_mov_b64 exec, -1
    s_getpc_b64 s[32:33]
    s_add_u32 s32, s32, ctab@rel32@lo+4
    s_addc_u32 s33, s33, ctab@rel32@hi+12
    s_mov_b32 s34, 49152
    s_mov_b32 s35, 0x20000
    v_lshrrev_b32 v1, 6, v0
    s_nop 0
    v_readfirstlane_b32 s26, v1
    v_and_b32 v0, 63, v0
    v_and_b32 v1, 15, v0
    v_lshrrev_b32 v2, 4, v0
    v_lshlrev_b32 v3, 4, v0
    s_cmp_ge_u32 s2, 64
    s_cbranch_scc1 L_nt
    s_lshl_b32 s3, s26, 11
    s_add_u32 m0, s3, 0
    s_nop 0
    buffer_load_dwordx4 v3, s[32:35], s3 offen lds
    buffer_load_dwordx4 v3, s[32:35], s3 offen offset:1024 lds
L_nt:
    s_and_b32 s64, s2, 7
    s_lshr_b32 s65, s2, 3
    s_mul_i32 s60, s64, 24
    s_and_b32 s60, s60, 63
    s_add_u32 s59, s60, s65
    s_lshr_b32 s66, s65, 2
    s_add_u32 s60, s60, s66
    s_and_b32 s61, s65, 3
    s_lshr_b32 s66, s65, 2
    s_and_b32 s57, s65, 3
    s_sub_u32 s27, s66, 2
    s_mul_i32 s67, s64, 6
    s_add_u32 s67, s67, s27
    s_and_b32 s56, s67, 15
    s_lshr_b32 s58, s67, 4
    s_mul_i32 s62, s56, 3
    s_add_u32 s62, s62, s58
    s_lshl_b32 s62, s62, 2
    s_add_u32 s62, s62, s57
    s_lshl_b32 s52, s61, 3
    s_add_u32 s52, s52, s26
    s_lshl_b32 s52, s52, 6
    s_add_u32 s52, s52, s60
    s_mul_i32 s52, s52, 1280
    s_mov_b32 s22, 0
    s_waitcnt lgkmcnt(0)
    s_mov_b32 s36, s4
    s_mov_b32 s37, s5
    s_mov_b32 s38, 2621440
    s_mov_b32 s39, 0x20000
    s_mov_b32 s28, s24
    s_mov_b32 s29, s25
    s_mov_b32 s30, 20703360
    s_mov_b32 s31, 0x20000
    s_cmp_lt_u32 s2, 64
    s_cbranch_scc1 L_fft
    s_cmp_lt_u32 s26, 4
    s_cbranch_scc1 L_comp
    s_mov_b32 s23, 2
    s_setprio 3
    s_sub_u32 s64, s26, 4
    s_mov_b32 s40, s12
    s_mov_b32 s41, s13
    s_mov_b32 s42, 1966080
    s_mov_b32 s43, 0x20000
    v_lshrrev_b32 v4, 3, v0
    v_and_b32 v5, 7, v0
    v_xor_b32 v5, v5, v4
    v_mul_u32_u24 v160, 81920, v4
    v_lshl_add_u32 v160, v5, 4, v160
    s_lshl_b32 s65, s56, 2
    s_add_u32 s65, s65, s64
    s_mul_i32 s65, s65, 1280
    v_lshlrev_b32 v6, 1, v2
    v_xor_b32 v5, v1, v6
    v_mul_u32_u24 v161, 3072, v2
    v_lshl_add_u32 v161, v5, 4, v161
    v_xor_b32 v162, 128, v161
    s_mul_i32 s66, s64, 49152
    s_lshl_b32 s75, s58, 2
    s_add_u32 s75, s75, s57
    s_lshl_b32 s76, s75, 8
    s_add_u32 s66, s66, s76
    s_lshl_b32 s67, s64, 12
    s_lshl_b32 s75, s27, 2
    s_lshr_b32 s71, 0x663300, s75
    s_and_b32 s71, s71, 15
    s_mov_b32 s84, 0x76543210
    s_mov_b32 s85, 0x98
    s_cmp_eq_u32 s61, 1
    s_cselect_b32 s84, 0x76543210, s84
    s_cselect_b32 s85, 0x98, s85
    s_cmp_eq_u32 s61, 2
    s_cselect_b32 s84, 0x76543210, s84
    s_cselect_b32 s85, 0x98, s85
    s_cmp_eq_u32 s61, 3
    s_cselect_b32 s84, 0x76543210, s84
    s_cselect_b32 s85, 0x98, s85
    s_bfe_u32 s73, s84, 0x40000
    s_add_u32 s73, s73, s71
    s_sub_u32 s75, s73, 10
    s_cselect_b32 s73, s73, s75
    s_lshl_b32 s72, s73, 7
    s_add_u32 s72, s72, s65
    s_mul_i32 s73, s73, 196608
    s_add_u32 s73, s73, s66
    s_add_u32 m0, s67, 65536
    s_add_u32 s75, s73, 0
    buffer_load_dwordx4 v161, s[40:43], s75 offen lds
    s_add_u32 m0, s67, 66560
    s_add_u32 s75, s73, 12288
    buffer_load_dwordx4 v161, s[40:43], s75 offen lds
    s_add_u32 m0, s67, 67584
    s_add_u32 s75, s73, 24576
    buffer_load_dwordx4 v162, s[40:43], s75 offen lds
    s_add_u32 m0, s67, 68608
    s_add_u32 s75, s73, 36864
    buffer_load_dwordx4 v162, s[40:43], s75 offen lds
    s_add_u32 m0, s67, 0
    s_add_u32 s75, s72, 0
    buffer_load_dwordx4 v160, s[36:39], s75 offen lds
    s_add_u32 m0, s67, 1024
    s_add_u32 s75, s72, 655360
    buffer_load_dwordx4 v160, s[36:39], s75 offen lds
    s_add_u32 m0, s67, 2048
    s_add_u32 s75, s72, 1310720
    buffer_load_dwordx4 v160, s[36:39], s75 offen lds
    s_add_u32 m0, s67, 3072
    s_add_u32 s75, s72, 1966080
    buffer_load_dwordx4 v160, s[36:39], s75 offen lds
    s_bfe_u32 s73, s84, 0x40004
    s_add_u32 s73, s73, s71
    s_sub_u32 s75, s73, 10
    s_cselect_b32 s73, s73, s75
    s_lshl_b32 s72, s73, 7
    s_add_u32 s72, s72, s65
    s_mul_i32 s73, s73, 196608
    s_add_u32 s73, s73, s66
    s_add_u32 m0, s67, 86016
    s_add_u32 s75, s73, 0
    buffer_load_dwordx4 v161, s[40:43], s75 offen lds
    s_add_u32 m0, s67, 87040
    s_add_u32 s75, s73, 12288
    buffer_load_dwordx4 v161, s[40:43], s75 offen lds
    s_add_u32 m0, s67, 88064
    s_add_u32 s75, s73, 24576
    buffer_load_dwordx4 v162, s[40:43], s75 offen lds
    s_add_u32 m0, s67, 89088
    s_add_u32 s75, s73, 36864
    buffer_load_dwordx4 v162, s[40:43], s75 offen lds
    s_add_u32 m0, s67, 16384
    s_add_u32 s75, s72, 0
    buffer_load_dwordx4 v160, s[36:39], s75 offen lds
    s_add_u32 m0, s67, 17408
    s_add_u32 s75, s72, 655360
    buffer_load_dwordx4 v160, s[36:39], s75 offen lds
    s_add_u32 m0, s67, 18432
    s_add_u32 s75, s72, 1310720
    buffer_load_dwordx4 v160, s[36:39], s75 offen lds
    s_add_u32 m0, s67, 19456
    s_add_u32 s75, s72, 1966080
    buffer_load_dwordx4 v160, s[36:39], s75 offen lds
    s_branch L_ld
L_fft:
    s_mov_b32 s23, 0
    s_lshl_b32 s65, s26, 11
    s_lshl_b32 s64, s26, 8
    v_mul_u32_u24 v4, 81920, v2
    v_lshl_add_u32 v4, v1, 4, v4
    s_add_u32 s64, s64, s59
    s_mul_i32 s64, s64, 1280
    buffer_load_dwordx4 v[8:11], v4, s[36:39], s64 offen offset:0
    buffer_load_dwordx4 v[12:15], v4, s[36:39], s64 offen offset:256
    buffer_load_dwordx4 v[16:19], v4, s[36:39], s64 offen offset:512
    buffer_load_dwordx4 v[20:23], v4, s[36:39], s64 offen offset:768
    buffer_load_dwordx4 v[24:27], v4, s[36:39], s64 offen offset:1024
    s_add_u32 s66, s24, 20480000
    s_addc_u32 s67, s25, 0
    s_load_dwordx2 s[10:11], s[66:67], 0
    s_mul_i32 s64, s26, 5120
    s_add_u32 s64, s64, 14336
    v_mul_u32_u24 v28, 1280, v2
    v_lshl_add_u32 v28, v1, 4, v28
    v_add_u32 v28, s64, v28
    v_and_b32 v4, 3, v0
    v_lshlrev_b32 v4, 3, v4
    v_add_u32 v4, s64, v4
    v_lshrrev_b32 v5, 2, v0
    v_lshl_add_u32 v29, v5, 6, v4
    v_and_b32 v5, 3, v5
    v_lshl_add_u32 v30, v5, 6, v4
    v_add_u32 v30, 1024, v30
    s_and_b32 s64, s26, 1
    s_lshl_b32 s64, s64, 4
    v_add_u32 v7, s64, v1
    s_and_b32 s64, s26, 2
    s_lshl_b32 s64, s64, 8
    v_lshlrev_b32 v4, 8, v2
    v_add_u32 v4, s59, v4
    v_mul_u32_u24 v4, v4, v7
    v_add_u32 v4, s64, v4
    v_lshlrev_b32 v7, 6, v7
    v_mad_u32_u24 v5, v7, 0, v4
    v_and_b32 v5, 2047, v5
    v_cvt_f32_u32 v5, v5
    v_mul_f32 v5, 0x3a000000, v5
    v_cos_f32 v6, v5
    v_sin_f32 v5, v5
    s_nop 0
    v_cvt_pk_bf16_f32 v32, v6, v5
    v_mad_u32_u24 v5, v7, 1, v4
    v_and_b32 v5, 2047, v5
    v_cvt_f32_u32 v5, v5
    v_mul_f32 v5, 0x3a000000, v5
    v_cos_f32 v6, v5
    v_sin_f32 v5, v5
    s_nop 0
    v_cvt_pk_bf16_f32 v33, v6, v5
    v_mad_u32_u24 v5, v7, 2, v4
    v_and_b32 v5, 2047, v5
    v_cvt_f32_u32 v5, v5
    v_mul_f32 v5, 0x3a000000, v5
    v_cos_f32 v6, v5
    v_sin_f32 v5, v5
    s_nop 0
    v_cvt_pk_bf16_f32 v34, v6, v5
    v_mad_u32_u24 v5, v7, 3, v4
    v_and_b32 v5, 2047, v5
    v_cvt_f32_u32 v5, v5
    v_mul_f32 v5, 0x3a000000, v5
    v_cos_f32 v6, v5
    v_sin_f32 v5, v5
    s_nop 0
    v_cvt_pk_bf16_f32 v35, v6, v5
    v_mad_u32_u24 v5, v7, 16, v4
    v_and_b32 v5, 2047, v5
    v_cvt_f32_u32 v5, v5
    v_mul_f32 v5, 0x3a000000, v5
    v_cos_f32 v6, v5
    v_sin_f32 v5, v5
    s_nop 0
    v_cvt_pk_bf16_f32 v36, v6, v5
    v_mad_u32_u24 v5, v7, 17, v4
    v_and_b32 v5, 2047, v5
    v_cvt_f32_u32 v5, v5
    v_mul_f32 v5, 0x3a000000, v5
    v_cos_f32 v6, v5
    v_sin_f32 v5, v5
    s_nop 0
    v_cvt_pk_bf16_f32 v37, v6, v5
    v_mad_u32_u24 v5, v7, 18, v4
    v_and_b32 v5, 2047, v5
    v_cvt_f32_u32 v5, v5
    v_mul_f32 v5, 0x3a000000, v5
    v_cos_f32 v6, v5
    v_sin_f32 v5, v5
    s_nop 0
    v_cvt_pk_bf16_f32 v38, v6, v5
    v_mad_u32_u24 v5, v7, 19, v4
    v_and_b32 v5, 2047, v5
    v_cvt_f32_u32 v5, v5
    v_mul_f32 v5, 0x3a000000, v5
    v_cos_f32 v6, v5
    v_sin_f32 v5, v5
    s_nop 0
    v_cvt_pk_bf16_f32 v39, v6, v5
    v_mov_b32 v5, 0
    v_and_b32 v4, 31, v0
    v_lshlrev_b32 v4, 2, v4
    v_add_u32 v4, 96384, v4
    ds_write_b32 v4, v5
    v_mul_u32_u24 v4, 80, v2
    v_add_u32 v4, v4, v1
    v_add_u32 v5, 432, v4
    v_xor_b32 v6, s26, v5
    v_and_b32 v6, 7, v6
    v_lshlrev_b32 v6, 4, v6
    v_lshl_add_u32 v40, v5, 7, v6
    v_add_u32 v5, 452, v4
    v_xor_b32 v6, s26, v5
    v_and_b32 v6, 7, v6
    v_lshlrev_b32 v6, 4, v6
    v_lshl_add_u32 v41, v5, 7, v6
    v_add_u32 v5, 472, v4
    v_xor_b32 v6, s26, v5
    v_and_b32 v6, 7, v6
    v_lshlrev_b32 v6, 4, v6
    v_lshl_add_u32 v42, v5, 7, v6
    v_add_u32 v5, 492, v4
    v_xor_b32 v6, s26, v5
    v_and_b32 v6, 7, v6
    v_lshlrev_b32 v6, 4, v6
    v_lshl_add_u32 v43, v5, 7, v6
    v_sub_u32 v5, 752, v4
    v_xor_b32 v6, s26, v5
    v_and_b32 v6, 7, v6
    v_lshlrev_b32 v6, 4, v6
    v_lshl_add_u32 v44, v5, 7, v6
    v_sub_u32 v5, 732, v4
    v_xor_b32 v6, s26, v5
    v_and_b32 v6, 7, v6
    v_lshlrev_b32 v6, 4, v6
    v_lshl_add_u32 v45, v5, 7, v6
    v_sub_u32 v5, 712, v4
    v_xor_b32 v6, s26, v5
    v_and_b32 v6, 7, v6
    v_lshlrev_b32 v6, 4, v6
    v_lshl_add_u32 v46, v5, 7, v6
    v_sub_u32 v5, 692, v4
    v_xor_b32 v6, s26, v5
    v_and_b32 v6, 7, v6
    v_lshlrev_b32 v6, 4, v6
    v_lshl_add_u32 v47, v5, 7, v6
    s_lshr_b32 s68, s26, 2
    v_and_b32 v4, 7, v0
    v_xor_b32 v4, v4, v2
    v_lshlrev_b32 v4, 4, v4
    v_lshl_add_u32 v4, v1, 7, v4
    s_mul_i32 s64, s68, 24576
    s_add_u32 s64, s64, 55296
    v_add_u32 v48, s64, v4
    v_xor_b32 v49, 64, v48
    v_lshlrev_b32 v4, 4, v2
    v_add_u32 v4, 96256, v4
    v_add_u32 v5, 128, v4
    v_cmp_eq_u32 vcc, 7, v1
    s_nop 1
    v_cndmask_b32 v4, v5, v4, vcc
    v_add_u32 v5, 16384, v48
    s_cmp_eq_u32 s68, 1
    s_cselect_b64 vcc, -1, 0
    v_cndmask_b32 v50, v5, v4, vcc
    v_xor_b32 v51, 64, v50
    s_mul_i32 s64, s26, 6400
    v_mul_u32_u24 v52, 400, v1
    v_lshl_add_u32 v52, v2, 3, v52
    v_add_u32 v52, s64, v52
    v_lshrrev_b32 v4, 3, v0
    v_and_b32 v5, 7, v0
    v_mul_u32_u24 v54, 98304, v4
    v_lshl_add_u32 v54, v5, 4, v54
    s_and_b32 s65, s59, 6
    v_xor_b32 v5, s65, v5
    v_lshlrev_b32 v5, 4, v5
    v_mul_u32_u24 v53, 400, v4
    v_add3_u32 v53, v53, v5, s64
    s_lshr_b32 s71, s59, 1
    s_and_b32 s72, s59, 1
    s_mul_i32 s65, s72, 192
    s_lshl_b32 s64, s26, 6
    s_add_u32 s64, s64, 0
    v_add_u32 v6, s64, v0
    v_mul_u32_u24 v4, 10923, v6
    v_lshrrev_b32 v4, 18, v4
    v_mul_u32_u24 v5, 24, v4
    v_sub_u32 v5, v6, v5
    v_and_b32 v6, 6, v4
    v_xor_b32 v5, v5, v6
    v_lshl_add_u32 v5, v5, 3, s65
    v_min_u32 v5, 313, v5
    v_mul_u32_u24 v55, 20544, v4
    v_lshl_add_u32 v55, v5, 1, v55
    s_lshl_b32 s64, s26, 6
    s_add_u32 s64, s64, 512
    v_add_u32 v6, s64, v0
    v_mul_u32_u24 v4, 10923, v6
    v_lshrrev_b32 v4, 18, v4
    v_mul_u32_u24 v5, 24, v4
    v_sub_u32 v5, v6, v5
    v_and_b32 v6, 6, v4
    v_xor_b32 v5, v5, v6
    v_lshl_add_u32 v5, v5, 3, s65
    v_min_u32 v5, 313, v5
    v_mul_u32_u24 v56, 20544, v4
    v_lshl_add_u32 v56, v5, 1, v56
    s_lshl_b32 s64, s26, 6
    s_add_u32 s64, s64, 1024
    v_add_u32 v6, s64, v0
    v_mul_u32_u24 v4, 10923, v6
    v_lshrrev_b32 v4, 18, v4
    v_mul_u32_u24 v5, 24, v4
    v_sub_u32 v5, v6, v5
    v_and_b32 v6, 6, v4
    v_xor_b32 v5, v5, v6
    v_lshl_add_u32 v5, v5, 3, s65
    v_min_u32 v5, 313, v5
    v_mul_u32_u24 v57, 20544, v4
    v_lshl_add_u32 v57, v5, 1, v57
    s_mov_b32 s40, s6
    s_mov_b32 s41, s7
    s_mov_b32 s42, 1314816
    s_mov_b32 s43, 0x20000
    s_mov_b32 s44, s8
    s_mov_b32 s45, s9
    s_mov_b32 s46, 1314816
    s_mov_b32 s47, 0x20000
    s_mul_i32 s73, s71, 642
    s_lshl_b32 s74, s26, 10
    s_and_b32 s69, s26, 1
    s_lshl_b32 s69, s69, 12
    s_lshl_b32 s64, s68, 7
    s_add_u32 s69, s69, s64
    s_and_b32 s64, s26, 2
    s_lshl_b32 s64, s64, 5
    s_add_u32 s69, s69, s64
    s_add_u32 s69, s69, s59
    s_mul_i32 s69, s69, 384
    s_add_u32 s69, s69, 6291456
    s_add_u32 s70, s69, 786432
    s_waitcnt vmcnt(5)
    s_barrier
    ds_read_b128 v[60:63], v3 offset:0
    ds_read_b128 v[64:67], v3 offset:1024
    ds_read_b128 v[68:71], v3 offset:2048
    ds_read_b128 v[72:75], v3 offset:3072
    ds_read_b128 v[76:79], v3 offset:4096
    ds_read_b128 v[80:83], v3 offset:5120
    ds_read_b128 v[84:87], v3 offset:6144
    ds_read_b128 v[88:91], v3 offset:7168
    ds_read_b128 v[92:95], v3 offset:8192
    ds_read_b128 v[96:99], v3 offset:9216
    ds_read_b128 v[100:103], v3 offset:10240
    ds_read_b128 v[104:107], v3 offset:11264
    ds_read_b128 v[108:111], v3 offset:12288
    ds_read_b128 v[112:115], v3 offset:13312
    s_waitcnt vmcnt(4)
    v_lshlrev_b32 v116, 16, v8
    v_and_b32 v117, 0xffff0000, v8
    v_pk_mul_f32 v[160:161], v[116:117], v[116:117]
    v_lshlrev_b32 v118, 16, v9
    v_and_b32 v119, 0xffff0000, v9
    v_pk_mul_f32 v[162:163], v[118:119], v[118:119]
    v_lshlrev_b32 v120, 16, v10
    v_and_b32 v121, 0xffff0000, v10
    v_pk_fma_f32 v[160:161], v[120:121], v[120:121], v[160:161]
    v_pk_add_f32 v[156:157], v[116:117], v[120:121]
    v_lshlrev_b32 v122, 16, v11
    v_and_b32 v123, 0xffff0000, v11
    v_pk_fma_f32 v[162:163], v[122:123], v[122:123], v[162:163]
    v_pk_add_f32 v[158:159], v[118:119], v[122:123]
    s_waitcnt vmcnt(3)
    v_lshlrev_b32 v124, 16, v12
    v_and_b32 v125, 0xffff0000, v12
    v_pk_fma_f32 v[160:161], v[124:125], v[124:125], v[160:161]
    v_pk_add_f32 v[156:157], v[156:157], v[124:125]
    v_lshlrev_b32 v126, 16, v13
    v_and_b32 v127, 0xffff0000, v13
    v_pk_fma_f32 v[162:163], v[126:127], v[126:127], v[162:163]
    v_pk_add_f32 v[158:159], v[158:159], v[126:127]
    v_lshlrev_b32 v128, 16, v14
    v_and_b32 v129, 0xffff0000, v14
    v_pk_fma_f32 v[160:161], v[128:129], v[128:129], v[160:161]
    v_pk_add_f32 v[156:157], v[156:157], v[128:129]
    v_lshlrev_b32 v130, 16, v15
    v_and_b32 v131, 0xffff0000, v15
    v_pk_fma_f32 v[162:163], v[130:131], v[130:131], v[162:163]
    v_pk_add_f32 v[158:159], v[158:159], v[130:131]
    s_waitcnt vmcnt(2)
    v_lshlrev_b32 v132, 16, v16
    v_and_b32 v133, 0xffff0000, v16
    v_pk_fma_f32 v[160:161], v[132:133], v[132:133], v[160:161]
    v_pk_add_f32 v[156:157], v[156:157], v[132:133]
    v_lshlrev_b32 v134, 16, v17
    v_and_b32 v135, 0xffff0000, v17
    v_pk_fma_f32 v[162:163], v[134:135], v[134:135], v[162:163]
    v_pk_add_f32 v[158:159], v[158:159], v[134:135]
    v_lshlrev_b32 v136, 16, v18
    v_and_b32 v137, 0xffff0000, v18
    v_pk_fma_f32 v[160:161], v[136:137], v[136:137], v[160:161]
    v_pk_add_f32 v[156:157], v[156:157], v[136:137]
    v_lshlrev_b32 v138, 16, v19
    v_and_b32 v139, 0xffff0000, v19
    v_pk_fma_f32 v[162:163], v[138:139], v[138:139], v[162:163]
    v_pk_add_f32 v[158:159], v[158:159], v[138:139]
    s_waitcnt vmcnt(1)
    v_lshlrev_b32 v140, 16, v20
    v_and_b32 v141, 0xffff0000, v20
    v_pk_fma_f32 v[160:161], v[140:141], v[140:141], v[160:161]
    v_pk_add_f32 v[156:157], v[156:157], v[140:141]
    v_lshlrev_b32 v142, 16, v21
    v_and_b32 v143, 0xffff0000, v21
    v_pk_fma_f32 v[162:163], v[142:143], v[142:143], v[162:163]
    v_pk_add_f32 v[158:159], v[158:159], v[142:143]
    v_lshlrev_b32 v144, 16, v22
    v_and_b32 v145, 0xffff0000, v22
    v_pk_fma_f32 v[160:161], v[144:145], v[144:145], v[160:161]
    v_pk_add_f32 v[156:157], v[156:157], v[144:145]
    v_lshlrev_b32 v146, 16, v23
    v_and_b32 v147, 0xffff0000, v23
    v_pk_fma_f32 v[162:163], v[146:147], v[146:147], v[162:163]
    v_pk_add_f32 v[158:159], v[158:159], v[146:147]
    s_waitcnt vmcnt(0)
    v_lshlrev_b32 v148, 16, v24
    v_and_b32 v149, 0xffff0000, v24
    v_pk_fma_f32 v[160:161], v[148:149], v[148:149], v[160:161]
    v_pk_add_f32 v[156:157], v[156:157], v[148:149]
    v_lshlrev_b32 v150, 16, v25
    v_and_b32 v151, 0xffff0000, v25
    v_pk_fma_f32 v[162:163], v[150:151], v[150:151], v[162:163]
    v_pk_add_f32 v[158:159], v[158:159], v[150:151]
    v_lshlrev_b32 v152, 16, v26
    v_and_b32 v153, 0xffff0000, v26
    v_pk_fma_f32 v[160:161], v[152:153], v[152:153], v[160:161]
    v_pk_add_f32 v[156:157], v[156:157], v[152:153]
    v_lshlrev_b32 v154, 16, v27
    v_and_b32 v155, 0xffff0000, v27
    v_pk_fma_f32 v[162:163], v[154:155], v[154:155], v[162:163]
    v_pk_add_f32 v[158:159], v[158:159], v[154:155]
    s_lshl_b32 s65, s26, 11
    s_add_u32 m0, s65, 147456
    s_add_u32 s65, s65, 16384
    buffer_load_dwordx4 v3, s[32:35], s65 offen lds
    buffer_load_dwordx4 v3, s[32:35], s65 offen offset:1024 lds
    v_lshlrev_b32 v4, 7, v0
    s_mov_b32 s48, s16
    s_mov_b32 s49, s17
    s_mov_b32 s50, 1966080
    s_mov_b32 s51, 0x20000
    s_lshl_b32 s64, s2, 3
    s_add_u32 s64, s64, s26
    s_mul_i32 s64, s64, 3840
    s_mov_b64 exec, 0x3fffffff
    buffer_load_dword v7, v4, s[48:51], s64 offen
    s_and_b32 s64, s2, 0x38
    s_add_u32 s64, s64, s26
    s_lshl_b32 s64, s64, 8
    s_mov_b32 s48, s18
    s_mov_b32 s49, s19
    s_mov_b32 s50, 1280
    s_mov_b32 s51, 0x20000
    s_mov_b64 exec, 3
    buffer_load_dword v7, v4, s[48:51], s64 offen
    s_add_u32 s64, s64, 32768
    buffer_load_dword v7, v4, s[32:35], s64 offen
    s_mov_b64 exec, -1
    v_pk_add_f32 v[156:157], v[156:157], v[158:159]
    v_pk_add_f32 v[160:161], v[160:161], v[162:163]
    v_add_f32 v222, v156, v157
    v_add_f32 v223, v160, v161
    s_nop 0
    v_add_f32_dpp v222, v222, v222 row_ror:8 row_mask:0xf bank_mask:0xf
    v_add_f32_dpp v223, v223, v223 row_ror:8 row_mask:0xf bank_mask:0xf
    s_nop 0
    v_add_f32_dpp v222, v222, v222 row_ror:4 row_mask:0xf bank_mask:0xf
    v_add_f32_dpp v223, v223, v223 row_ror:4 row_mask:0xf bank_mask:0xf
    s_nop 0
    v_add_f32_dpp v222, v222, v222 row_ror:2 row_mask:0xf bank_mask:0xf
    v_add_f32_dpp v223, v223, v223 row_ror:2 row_mask:0xf bank_mask:0xf
    s_nop 0
    v_add_f32_dpp v222, v222, v222 row_ror:1 row_mask:0xf bank_mask:0xf
    v_add_f32_dpp v223, v223, v223 row_ror:1 row_mask:0xf bank_mask:0xf
    v_mul_f32 v222, 0x3acccccd, v222
    v_mul_f32 v223, 0x3acccccd, v223
    v_fma_f32 v223, -v222, v222, v223
    v_max_f32 v223, 0, v223
    v_cvt_pk_bf16_f32 v224, v222, v222
    v_lshlrev_b32 v224, 16, v224
    v_cvt_pk_bf16_f32 v225, v223, v223
    v_lshlrev_b32 v225, 16, v225
    v_add_f32 v225, 0x3727c5ac, v225
    v_cvt_pk_bf16_f32 v225, v225, v225
    v_lshlrev_b32 v225, 16, v225
    v_sqrt_f32 v225, v225
    s_nop 0
    v_cvt_pk_bf16_f32 v225, v225, v225
    v_lshlrev_b32 v225, 16, v225
    v_rcp_f32 v220, v225
    v_rcp_f32 v221, v225
    v_mul_f32 v156, v224, v220
    v_sub_f32 v156, 0, v156
    v_mov_b32 v157, v156
    v_pk_fma_f32 v[116:117], v[116:117], v[220:221], v[156:157]
    v_pk_fma_f32 v[118:119], v[118:119], v[220:221], v[156:157]
    v_cvt_pk_bf16_f32 v8, v116, v117
    v_pk_fma_f32 v[120:121], v[120:121], v[220:221], v[156:157]
    v_cvt_pk_bf16_f32 v9, v118, v119
    v_pk_fma_f32 v[122:123], v[122:123], v[220:221], v[156:157]
    v_cvt_pk_bf16_f32 v10, v120, v121
    v_pk_fma_f32 v[124:125], v[124:125], v[220:221], v[156:157]
    v_cvt_pk_bf16_f32 v11, v122, v123
    ds_write_b128 v28, v[8:11] offset:0
    v_pk_fma_f32 v[126:127], v[126:127], v[220:221], v[156:157]
    v_cvt_pk_bf16_f32 v12, v124, v125
    v_pk_fma_f32 v[128:129], v[128:129], v[220:221], v[156:157]
    v_cvt_pk_bf16_f32 v13, v126, v127
    v_pk_fma_f32 v[130:131], v[130:131], v[220:221], v[156:157]
    v_cvt_pk_bf16_f32 v14, v128, v129
    v_pk_fma_f32 v[132:133], v[132:133], v[220:221], v[156:157]
    v_cvt_pk_bf16_f32 v15, v130, v131
    ds_write_b128 v28, v[12:15] offset:256
    v_pk_fma_f32 v[134:135], v[134:135], v[220:221], v[156:157]
    v_cvt_pk_bf16_f32 v16, v132, v133
    v_pk_fma_f32 v[136:137], v[136:137], v[220:221], v[156:157]
    v_cvt_pk_bf16_f32 v17, v134, v135
    v_pk_fma_f32 v[138:139], v[138:139], v[220:221], v[156:157]
    v_cvt_pk_bf16_f32 v18, v136, v137
    v_pk_fma_f32 v[140:141], v[140:141], v[220:221], v[156:157]
    v_cvt_pk_bf16_f32 v19, v138, v139
    ds_write_b128 v28, v[16:19] offset:512
    v_pk_fma_f32 v[142:143], v[142:143], v[220:221], v[156:157]
    v_cvt_pk_bf16_f32 v20, v140, v141
    v_pk_fma_f32 v[144:145], v[144:145], v[220:221], v[156:157]
    v_cvt_pk_bf16_f32 v21, v142, v143
    v_pk_fma_f32 v[146:147], v[146:147], v[220:221], v[156:157]
    v_cvt_pk_bf16_f32 v22, v144, v145
    v_pk_fma_f32 v[148:149], v[148:149], v[220:221], v[156:157]
    v_cvt_pk_bf16_f32 v23, v146, v147
    ds_write_b128 v28, v[20:23] offset:768
    v_pk_fma_f32 v[150:151], v[150:151], v[220:221], v[156:157]
    v_cvt_pk_bf16_f32 v24, v148, v149
    v_pk_fma_f32 v[152:153], v[152:153], v[220:221], v[156:157]
    v_cvt_pk_bf16_f32 v25, v150, v151
    v_pk_fma_f32 v[154:155], v[154:155], v[220:221], v[156:157]
    v_cvt_pk_bf16_f32 v26, v152, v153
    v_cvt_pk_bf16_f32 v27, v154, v155
    ds_write_b128 v28, v[24:27] offset:1024
    v_sub_f32 v226, v222, v224
    v_mul_f32 v226, v226, v220
    v_cvt_pk_bf16_f32 v226, v226, v226
    v_lshlrev_b32 v226, 16, v226
    v_mul_f32 v227, v223, v220
    v_mul_f32 v227, v227, v220
    v_cvt_pk_bf16_f32 v227, v227, v227
    v_lshlrev_b32 v227, 16, v227
    v_add_f32 v227, 0x3727c5ac, v227
    v_cvt_pk_bf16_f32 v227, v227, v227
    v_lshlrev_b32 v227, 16, v227
    s_waitcnt lgkmcnt(0)
    ds_read_b64_tr_b16 v[180:181], v29 offset:0
    ds_read_b64_tr_b16 v[182:183], v30 offset:0
    ds_read_b64_tr_b16 v[184:185], v29 offset:32
    ds_read_b64_tr_b16 v[186:187], v30 offset:32
    ds_read_b64_tr_b16 v[188:189], v29 offset:1280
    ds_read_b64_tr_b16 v[190:191], v30 offset:1280
    ds_read_b64_tr_b16 v[192:193], v29 offset:1312
    ds_read_b64_tr_b16 v[194:195], v30 offset:1312
    ds_read_b64_tr_b16 v[196:197], v29 offset:2560
    ds_read_b64_tr_b16 v[198:199], v30 offset:2560
    ds_read_b64_tr_b16 v[200:201], v29 offset:2592
    ds_read_b64_tr_b16 v[202:203], v30 offset:2592
    s_mul_i32 s10, s10, 1664525
    s_add_u32 s10, s10, 1013904223
    s_mul_i32 s11, s11, 22695477
    s_add_u32 s11, s11, 1
    v_sqrt_f32 v227, v227
    s_nop 0
    v_cvt_pk_bf16_f32 v227, v227, v227
    v_lshlrev_b32 v227, 16, v227
    v_rcp_f32 v227, v227
    v_fma_f32 v224, v226, v225, v224
    v_mul_f32 v216, v220, v227
    v_mul_f32 v218, v216, v224
    v_sub_f32 v218, 0, v218
    v_mov_b32 v217, s10
    v_mov_b32 v219, s11
    s_waitcnt lgkmcnt(8)
    ds_read_b64_tr_b16 v[204:205], v29 offset:3840
    ds_read_b64_tr_b16 v[206:207], v30 offset:3840
    ds_read_b64_tr_b16 v[208:209], v29 offset:3872
    ds_read_b64_tr_b16 v[210:211], v30 offset:3872
    s_lshl_b32 s64, s59, 3
    s_add_u32 s64, s64, s26
    s_lshl_b32 s64, s64, 6
    s_add_u32 s64, s64, 20447232
    v_lshlrev_b32 v4, 4, v2
    s_mov_b32 exec_lo, 0x00010001
    s_mov_b32 exec_hi, 0x00010001
    buffer_store_dwordx4 v[216:219], v4, s[28:31], s64 offen sc1
    s_mov_b64 exec, -1
    s_cmp_lg_u32 s26, 0
    s_cbranch_scc1 L_px_1
    s_lshl_b32 s64, s2, 3
    s_add_u32 s64, s64, 20504704
    v_mov_b32 v4, s10
    v_mov_b32 v5, s11
    v_lshlrev_b32 v6, 3, v0
    s_mov_b64 exec, 1
    buffer_store_dwordx2 v[4:5], v6, s[28:31], s64 offen sc1
    s_mov_b64 exec, -1
L_px_1:
    s_nop 3
    v_mfma_f32_16x16x32_bf16 v[116:119], v[180:183], v[60:63], 0
    v_mfma_f32_16x16x32_bf16 v[120:123], v[180:183], v[64:67], 0
    v_mfma_f32_16x16x32_bf16 v[124:127], v[184:187], v[60:63], 0
    v_mfma_f32_16x16x32_bf16 v[128:131], v[184:187], v[64:67], 0
    s_waitcnt lgkmcnt(8)
    v_mfma_f32_16x16x32_bf16 v[132:135], v[188:191], v[60:63], 0
    v_mfma_f32_16x16x32_bf16 v[136:139], v[188:191], v[64:67], 0
    v_mfma_f32_16x16x32_bf16 v[140:143], v[192:195], v[60:63], 0
    v_mfma_f32_16x16x32_bf16 v[144:147], v[192:195], v[64:67], 0
    s_add_u32 m0, s74, 98304
    s_nop 0
    buffer_load_dwordx4 v55, s[40:43], s73 offen lds
    s_waitcnt lgkmcnt(0)
    v_mfma_f32_16x16x32_bf16 v[148:151], v[196:199], v[60:63], 0
    v_mul_f32 v212, v116, v104
    v_mul_f32 v213, v117, v105
    v_mul_f32 v214, v118, v106
    v_mul_f32 v215, v119, v107
    v_mul_f32 v116, v116, v100
    v_mfma_f32_16x16x32_bf16 v[152:155], v[196:199], v[64:67], 0
    v_mul_f32 v117, v117, v101
    v_mul_f32 v118, v118, v102
    v_mul_f32 v119, v119, v103
    v_fmac_f32 v116, v120, v104
    v_fmac_f32 v117, v121, v105
    v_mfma_f32_16x16x32_bf16 v[156:159], v[200:203], v[60:63], 0
    v_fmac_f32 v118, v122, v106
    v_fmac_f32 v119, v123, v107
    v_fma_f32 v120, v120, v100, -v212
    v_fma_f32 v121, v121, v101, -v213
    v_fma_f32 v122, v122, v102, -v214
    v_mfma_f32_16x16x32_bf16 v[160:163], v[200:203], v[64:67], 0
    v_fma_f32 v123, v123, v103, -v215
    v_mul_f32 v228, v124, v112
    v_mul_f32 v229, v125, v113
    v_mul_f32 v230, v126, v114
    v_mul_f32 v231, v127, v115
    v_mfma_f32_16x16x32_bf16 v[164:167], v[204:207], v[60:63], 0
    v_mul_f32 v124, v124, v108
    v_mul_f32 v125, v125, v109
    v_mul_f32 v126, v126, v110
    v_mul_f32 v127, v127, v111
    v_fmac_f32 v124, v128, v112
    v_mfma_f32_16x16x32_bf16 v[168:171], v[204:207], v[64:67], 0
    v_fmac_f32 v125, v129, v113
    v_fmac_f32 v126, v130, v114
    v_fmac_f32 v127, v131, v115
    v_fma_f32 v128, v128, v108, -v228
    v_fma_f32 v129, v129, v109, -v229
    v_mfma_f32_16x16x32_bf16 v[172:175], v[208:211], v[60:63], 0
    v_fma_f32 v130, v130, v110, -v230
    v_fma_f32 v131, v131, v111, -v231
    v_cvt_pk_bf16_f32 v180, v116, v117
    v_cvt_pk_bf16_f32 v181, v118, v119
    v_cvt_pk_bf16_f32 v182, v124, v125
    v_mfma_f32_16x16x32_bf16 v[176:179], v[208:211], v[64:67], 0
    v_cvt_pk_bf16_f32 v183, v126, v127
    v_cvt_pk_bf16_f32 v184, v120, v121
    v_cvt_pk_bf16_f32 v185, v122, v123
    v_cvt_pk_bf16_f32 v186, v128, v129
    v_cvt_pk_bf16_f32 v187, v130, v131
    s_add_u32 m0, s74, 122880
    s_nop 0
    buffer_load_dwordx4 v55, s[44:47], s73 offen lds
    v_mfma_f32_16x16x32_bf16 v[116:119], v[68:71], v[180:183], 0
    v_mul_f32 v212, v132, v104
    v_mul_f32 v213, v133, v105
    v_mul_f32 v214, v134, v106
    v_mul_f32 v215, v135, v107
    v_mul_f32 v132, v132, v100
    v_mfma_f32_16x16x32_bf16 v[120:123], v[76:79], v[180:183], 0
    v_mul_f32 v133, v133, v101
    v_mul_f32 v134, v134, v102
    v_mul_f32 v135, v135, v103
    v_fmac_f32 v132, v136, v104
    v_fmac_f32 v133, v137, v105
    v_mfma_f32_16x16x32_bf16 v[124:127], v[84:87], v[180:183], 0
    v_fmac_f32 v134, v138, v106
    v_fmac_f32 v135, v139, v107
    v_fma_f32 v136, v136, v100, -v212
    v_fma_f32 v137, v137, v101, -v213
    v_fma_f32 v138, v138, v102, -v214
    v_mfma_f32_16x16x32_bf16 v[128:131], v[92:95], v[180:183], 0
    v_fma_f32 v139, v139, v103, -v215
    v_mul_f32 v228, v140, v112
    v_mul_f32 v229, v141, v113
    v_mul_f32 v230, v142, v114
    v_mul_f32 v231, v143, v115
    v_mfma_f32_16x16x32_bf16 v[116:119], v[72:75], v[184:187], v[116:119]
    v_mul_f32 v140, v140, v108
    v_mul_f32 v141, v141, v109
    v_mul_f32 v142, v142, v110
    v_mul_f32 v143, v143, v111
    v_fmac_f32 v140, v144, v112
    v_mfma_f32_16x16x32_bf16 v[120:123], v[80:83], v[184:187], v[120:123]
    v_fmac_f32 v141, v145, v113
    v_fmac_f32 v142, v146, v114
    v_fmac_f32 v143, v147, v115
    v_fma_f32 v144, v144, v108, -v228
    v_fma_f32 v145, v145, v109, -v229
    v_mfma_f32_16x16x32_bf16 v[124:127], v[88:91], v[184:187], v[124:127]
    v_fma_f32 v146, v146, v110, -v230
    v_fma_f32 v147, v147, v111, -v231
    v_cvt_pk_bf16_f32 v188, v132, v133
    v_cvt_pk_bf16_f32 v189, v134, v135
    v_cvt_pk_bf16_f32 v190, v140, v141
    v_mfma_f32_16x16x32_bf16 v[128:131], v[96:99], v[184:187], v[128:131]
    v_cvt_pk_bf16_f32 v191, v142, v143
    v_cvt_pk_bf16_f32 v192, v136, v137
    v_cvt_pk_bf16_f32 v193, v138, v139
    v_cvt_pk_bf16_f32 v194, v144, v145
    v_cvt_pk_bf16_f32 v195, v146, v147
    s_add_u32 m0, s74, 106496
    s_nop 0
    buffer_load_dwordx4 v56, s[40:43], s73 offen lds
    v_mfma_f32_16x16x32_bf16 v[132:135], v[68:71], v[188:191], 0
    v_mul_f32 v212, v148, v104
    v_mul_f32 v213, v149, v105
    v_mul_f32 v214, v150, v106
    v_mul_f32 v215, v151, v107
    v_mul_f32 v148, v148, v100
    v_mul_f32 v149, v149, v101
    v_mfma_f32_16x16x32_bf16 v[136:139], v[76:79], v[188:191], 0
    v_mul_f32 v150, v150, v102
    v_mul_f32 v151, v151, v103
    v_fmac_f32 v148, v152, v104
    v_fmac_f32 v149, v153, v105
    v_fmac_f32 v150, v154, v106
    v_fmac_f32 v151, v155, v107
    v_mfma_f32_16x16x32_bf16 v[140:143], v[84:87], v[188:191], 0
    v_fma_f32 v152, v152, v100, -v212
    v_fma_f32 v153, v153, v101, -v213
    v_fma_f32 v154, v154, v102, -v214
    v_fma_f32 v155, v155, v103, -v215
    v_mul_f32 v228, v156, v112
    v_mul_f32 v229, v157, v113
    v_mfma_f32_16x16x32_bf16 v[144:147], v[92:95], v[188:191], 0
    v_mul_f32 v230, v158, v114
    v_mul_f32 v231, v159, v115
    v_mul_f32 v156, v156, v108
    v_mul_f32 v157, v157, v109
    v_mul_f32 v158, v158, v110
    v_mul_f32 v159, v159, v111
    v_mfma_f32_16x16x32_bf16 v[132:135], v[72:75], v[192:195], v[132:135]
    v_fmac_f32 v156, v160, v112
    v_fmac_f32 v157, v161, v113
    v_fmac_f32 v158, v162, v114
    v_fmac_f32 v159, v163, v115
    v_fma_f32 v160, v160, v108, -v228
    v_fma_f32 v161, v161, v109, -v229
    v_mfma_f32_16x16x32_bf16 v[136:139], v[80:83], v[192:195], v[136:139]
    v_fma_f32 v162, v162, v110, -v230
    v_fma_f32 v163, v163, v111, -v231
    v_cvt_pk_bf16_f32 v196, v148, v149
    v_cvt_pk_bf16_f32 v197, v150, v151
    v_cvt_pk_bf16_f32 v198, v156, v157
    v_cvt_pk_bf16_f32 v199, v158, v159
    v_mfma_f32_16x16x32_bf16 v[140:143], v[88:91], v[192:195], v[140:143]
    v_cvt_pk_bf16_f32 v200, v152, v153
    v_cvt_pk_bf16_f32 v201, v154, v155
    v_cvt_pk_bf16_f32 v202, v160, v161
    v_cvt_pk_bf16_f32 v203, v162, v163
    v_cvt_pk_bf16_f32 v8, v116, v120
    v_cvt_pk_bf16_f32 v12, v117, v121
    v_mfma_f32_16x16x32_bf16 v[144:147], v[96:99], v[192:195], v[144:147]
    v_cvt_pk_bf16_f32 v16, v118, v122
    v_cvt_pk_bf16_f32 v20, v119, v123
    v_cvt_pk_bf16_f32 v24, v124, v128
    v_cvt_pk_bf16_f32 v232, v125, v129
    v_cvt_pk_bf16_f32 v236, v126, v130
    v_cvt_pk_bf16_f32 v240, v127, v131
    s_add_u32 m0, s74, 131072
    s_nop 0
    buffer_load_dwordx4 v56, s[44:47], s73 offen lds
    v_mfma_f32_16x16x32_bf16 v[148:151], v[68:71], v[196:199], 0
    v_mul_f32 v212, v164, v104
    v_mul_f32 v213, v165, v105
    v_mul_f32 v214, v166, v106
    v_mul_f32 v215, v167, v107
    v_mul_f32 v164, v164, v100
    v_mul_f32 v165, v165, v101
    v_mfma_f32_16x16x32_bf16 v[152:155], v[76:79], v[196:199], 0
    v_mul_f32 v166, v166, v102
    v_mul_f32 v167, v167, v103
    v_fmac_f32 v164, v168, v104
    v_fmac_f32 v165, v169, v105
    v_fmac_f32 v166, v170, v106
    v_fmac_f32 v167, v171, v107
    v_mfma_f32_16x16x32_bf16 v[156:159], v[84:87], v[196:199], 0
    v_fma_f32 v168, v168, v100, -v212
    v_fma_f32 v169, v169, v101, -v213
    v_fma_f32 v170, v170, v102, -v214
    v_fma_f32 v171, v171, v103, -v215
    v_mul_f32 v228, v172, v112
    v_mul_f32 v229, v173, v113
    v_mfma_f32_16x16x32_bf16 v[160:163], v[92:95], v[196:199], 0
    v_mul_f32 v230, v174, v114
    v_mul_f32 v231, v175, v115
    v_mul_f32 v172, v172, v108
    v_mul_f32 v173, v173, v109
    v_mul_f32 v174, v174, v110
    v_mul_f32 v175, v175, v111
    v_mfma_f32_16x16x32_bf16 v[148:151], v[72:75], v[200:203], v[148:151]
    v_fmac_f32 v172, v176, v112
    v_fmac_f32 v173, v177, v113
    v_fmac_f32 v174, v178, v114
    v_fmac_f32 v175, v179, v115
    v_fma_f32 v176, v176, v108, -v228
    v_fma_f32 v177, v177, v109, -v229
    v_mfma_f32_16x16x32_bf16 v[152:155], v[80:83], v[200:203], v[152:155]
    v_fma_f32 v178, v178, v110, -v230
    v_fma_f32 v179, v179, v111, -v231
    v_cvt_pk_bf16_f32 v204, v164, v165
    v_cvt_pk_bf16_f32 v205, v166, v167
    v_cvt_pk_bf16_f32 v206, v172, v173
    v_cvt_pk_bf16_f32 v207, v174, v175
    v_mfma_f32_16x16x32_bf16 v[156:159], v[88:91], v[200:203], v[156:159]
    v_cvt_pk_bf16_f32 v208, v168, v169
    v_cvt_pk_bf16_f32 v209, v170, v171
    v_cvt_pk_bf16_f32 v210, v176, v177
    v_cvt_pk_bf16_f32 v211, v178, v179
    v_cvt_pk_bf16_f32 v9, v132, v136
    v_cvt_pk_bf16_f32 v13, v133, v137
    v_mfma_f32_16x16x32_bf16 v[160:163], v[96:99], v[200:203], v[160:163]
    v_cvt_pk_bf16_f32 v17, v134, v138
    v_cvt_pk_bf16_f32 v21, v135, v139
    v_cvt_pk_bf16_f32 v25, v140, v144
    v_cvt_pk_bf16_f32 v233, v141, v145
    v_cvt_pk_bf16_f32 v237, v142, v146
    v_cvt_pk_bf16_f32 v241, v143, v147
    s_add_u32 m0, s74, 114688
    s_nop 0
    buffer_load_dwordx4 v57, s[40:43], s73 offen lds
    v_mfma_f32_16x16x32_bf16 v[164:167], v[68:71], v[204:207], 0
    v_cvt_pk_bf16_f32 v10, v148, v152
    v_mfma_f32_16x16x32_bf16 v[168:171], v[76:79], v[204:207], 0
    v_cvt_pk_bf16_f32 v14, v149, v153
    v_mfma_f32_16x16x32_bf16 v[172:175], v[84:87], v[204:207], 0
    v_cvt_pk_bf16_f32 v18, v150, v154
    v_mfma_f32_16x16x32_bf16 v[176:179], v[92:95], v[204:207], 0
    v_cvt_pk_bf16_f32 v22, v151, v155
    v_mfma_f32_16x16x32_bf16 v[164:167], v[72:75], v[208:211], v[164:167]
    v_cvt_pk_bf16_f32 v26, v156, v160
    v_mfma_f32_16x16x32_bf16 v[168:171], v[80:83], v[208:211], v[168:171]
    v_cvt_pk_bf16_f32 v234, v157, v161
    v_mfma_f32_16x16x32_bf16 v[172:175], v[88:91], v[208:211], v[172:175]
    v_cvt_pk_bf16_f32 v238, v158, v162
    v_mfma_f32_16x16x32_bf16 v[176:179], v[96:99], v[208:211], v[176:179]
    v_cvt_pk_bf16_f32 v242, v159, v163
    s_add_u32 m0, s74, 139264
    s_nop 0
    buffer_load_dwordx4 v57, s[44:47], s73 offen lds
    v_cvt_pk_bf16_f32 v11, v164, v168
    ds_write_b128 v40, v[8:11]
    v_cvt_pk_bf16_f32 v15, v165, v169
    ds_write_b128 v41, v[12:15]
    v_cvt_pk_bf16_f32 v19, v166, v170
    ds_write_b128 v42, v[16:19]
    v_cvt_pk_bf16_f32 v23, v167, v171
    ds_write_b128 v43, v[20:23]
    v_cvt_pk_bf16_f32 v27, v172, v176
    ds_write_b128 v44, v[24:27]
    v_cvt_pk_bf16_f32 v235, v173, v177
    ds_write_b128 v45, v[232:235]
    v_cvt_pk_bf16_f32 v239, v174, v178
    ds_write_b128 v46, v[236:239]
    v_cvt_pk_bf16_f32 v243, v175, v179
    ds_write_b128 v47, v[240:243]
    s_waitcnt vmcnt(6) lgkmcnt(0)
    s_barrier
    ds_read_b128 v[60:63], v48 offset:0
    ds_read_b128 v[64:67], v49 offset:0
    ds_read_b128 v[68:71], v48 offset:2048
    ds_read_b128 v[72:75], v49 offset:2048
    ds_read_b128 v[76:79], v48 offset:4096
    ds_read_b128 v[80:83], v49 offset:4096
    ds_read_b128 v[84:87], v48 offset:6144
    ds_read_b128 v[88:91], v49 offset:6144
    s_waitcnt lgkmcnt(6)
    v_mfma_f32_16x16x32_bf16 v[156:159], v[60:63], v[32:35], 0
    v_mfma_f32_16x16x32_bf16 v[156:159], v[64:67], v[36:39], v[156:159]
    ds_read_b128 v[92:95], v48 offset:8192
    ds_read_b128 v[96:99], v49 offset:8192
    s_waitcnt lgkmcnt(6)
    v_mfma_f32_16x16x32_bf16 v[160:163], v[68:71], v[32:35], 0
    v_mfma_f32_16x16x32_bf16 v[160:163], v[72:75], v[36:39], v[160:163]
    ds_read_b128 v[100:103], v48 offset:10240
    ds_read_b128 v[104:107], v49 offset:10240
    s_waitcnt lgkmcnt(6)
    v_mfma_f32_16x16x32_bf16 v[164:167], v[76:79], v[32:35], 0
    v_mfma_f32_16x16x32_bf16 v[164:167], v[80:83], v[36:39], v[164:167]
    ds_read_b128 v[108:111], v48 offset:12288
    ds_read_b128 v[112:115], v49 offset:12288
    s_waitcnt lgkmcnt(6)
    v_mfma_f32_16x16x32_bf16 v[168:171], v[84:87], v[32:35], 0
    v_mfma_f32_16x16x32_bf16 v[168:171], v[88:91], v[36:39], v[168:171]
    ds_read_b128 v[116:119], v48 offset:14336
    ds_read_b128 v[120:123], v49 offset:14336
    v_cvt_pk_bf16_f32 v156, v156, v157
    v_cvt_pk_bf16_f32 v157, v158, v159
    ds_write_b64 v52, v[156:157] offset:0
    s_waitcnt lgkmcnt(7)
    v_mfma_f32_16x16x32_bf16 v[172:175], v[92:95], v[32:35], 0
    v_mfma_f32_16x16x32_bf16 v[172:175], v[96:99], v[36:39], v[172:175]
    ds_read_b128 v[124:127], v50
    ds_read_b128 v[128:131], v51
    v_cvt_pk_bf16_f32 v160, v160, v161
    v_cvt_pk_bf16_f32 v161, v162, v163
    ds_write_b64 v52, v[160:161] offset:32
    s_waitcnt lgkmcnt(8)
    v_mfma_f32_16x16x32_bf16 v[176:179], v[100:103], v[32:35], 0
    v_mfma_f32_16x16x32_bf16 v[176:179], v[104:107], v[36:39], v[176:179]
    ds_read_b128 v[132:135], v48 offset:18432
    ds_read_b128 v[136:139], v49 offset:18432
    v_cvt_pk_bf16_f32 v164, v164, v165
    v_cvt_pk_bf16_f32 v165, v166, v167
    ds_write_b64 v52, v[164:165] offset:64
    s_waitcnt lgkmcnt(9)
    v_mfma_f32_16x16x32_bf16 v[180:183], v[108:111], v[32:35], 0
    v_mfma_f32_16x16x32_bf16 v[180:183], v[112:115], v[36:39], v[180:183]
    ds_read_b128 v[140:143], v48 offset:20480
    ds_read_b128 v[144:147], v49 offset:20480
    v_cvt_pk_bf16_f32 v168, v168, v169
    v_cvt_pk_bf16_f32 v169, v170, v171
    ds_write_b64 v52, v[168:169] offset:96
    ds_read_b128 v[204:207], v53 offset:0
    ds_read_b128 v[208:211], v53 offset:3200
    s_waitcnt lgkmcnt(12)
    v_mfma_f32_16x16x32_bf16 v[184:187], v[116:119], v[32:35], 0
    v_mfma_f32_16x16x32_bf16 v[184:187], v[120:123], v[36:39], v[184:187]
    ds_read_b128 v[148:151], v48 offset:22528
    ds_read_b128 v[152:155], v49 offset:22528
    v_cvt_pk_bf16_f32 v172, v172, v173
    v_cvt_pk_bf16_f32 v173, v174, v175
    ds_write_b64 v52, v[172:173] offset:128
    s_waitcnt lgkmcnt(12)
    v_mfma_f32_16x16x32_bf16 v[188:191], v[124:127], v[32:35], 0
    v_mfma_f32_16x16x32_bf16 v[188:191], v[128:131], v[36:39], v[188:191]
    v_cvt_pk_bf16_f32 v176, v176, v177
    v_cvt_pk_bf16_f32 v177, v178, v179
    ds_write_b64 v52, v[176:177] offset:160
    s_waitcnt lgkmcnt(10)
    v_mfma_f32_16x16x32_bf16 v[192:195], v[132:135], v[32:35], 0
    v_mfma_f32_16x16x32_bf16 v[192:195], v[136:139], v[36:39], v[192:195]
    v_cvt_pk_bf16_f32 v180, v180, v181
    v_cvt_pk_bf16_f32 v181, v182, v183
    ds_write_b64 v52, v[180:181] offset:192
    s_waitcnt lgkmcnt(5)
    buffer_store_dwordx4 v[204:207], v54, s[28:31], s69 offen offset:0 sc1
    buffer_store_dwordx4 v[208:211], v54, s[28:31], s70 offen offset:0 sc1
    v_mfma_f32_16x16x32_bf16 v[196:199], v[140:143], v[32:35], 0
    v_mfma_f32_16x16x32_bf16 v[196:199], v[144:147], v[36:39], v[196:199]
    v_cvt_pk_bf16_f32 v184, v184, v185
    v_cvt_pk_bf16_f32 v185, v186, v187
    ds_write_b64 v52, v[184:185] offset:224
    ds_read_b128 v[212:215], v53 offset:128
    ds_read_b128 v[216:219], v53 offset:3328
    s_waitcnt lgkmcnt(6)
    v_mfma_f32_16x16x32_bf16 v[200:203], v[148:151], v[32:35], 0
    v_mfma_f32_16x16x32_bf16 v[200:203], v[152:155], v[36:39], v[200:203]
    v_cvt_pk_bf16_f32 v188, v188, v189
    v_cvt_pk_bf16_f32 v189, v190, v191
    ds_write_b64 v52, v[188:189] offset:256
    v_cvt_pk_bf16_f32 v192, v192, v193
    v_cvt_pk_bf16_f32 v193, v194, v195
    ds_write_b64 v52, v[192:193] offset:288
    v_cvt_pk_bf16_f32 v196, v196, v197
    v_cvt_pk_bf16_f32 v197, v198, v199
    ds_write_b64 v52, v[196:197] offset:320
    s_waitcnt lgkmcnt(3)
    buffer_store_dwordx4 v[212:215], v54, s[28:31], s69 offen offset:128 sc1
    buffer_store_dwordx4 v[216:219], v54, s[28:31], s70 offen offset:128 sc1
    v_cvt_pk_bf16_f32 v200, v200, v201
    v_cvt_pk_bf16_f32 v201, v202, v203
    ds_write_b64 v52, v[200:201] offset:352
    ds_read_b128 v[220:223], v53 offset:256
    ds_read_b128 v[224:227], v53 offset:3456
    s_waitcnt lgkmcnt(0)
    buffer_store_dwordx4 v[220:223], v54, s[28:31], s69 offen offset:256 sc1
    buffer_store_dwordx4 v[224:227], v54, s[28:31], s70 offen offset:256 sc1
    v_lshrrev_b32 v4, 2, v0
    v_mul_u32_u24 v40, 384, v4
    v_bfe_u32 v4, v0, 3, 2
    v_xor_b32 v4, s26, v4
    v_lshl_add_u32 v40, v4, 5, v40
    v_and_b32 v4, 3, v0
    v_lshl_add_u32 v40, v4, 3, v40
    v_add_u32 v41, 98304, v40
    v_mul_u32_u24 v42, 384, v1
    v_bfe_u32 v4, v0, 1, 2
    v_xor_b32 v4, s26, v4
    v_lshl_add_u32 v42, v4, 5, v42
    v_lshl_add_u32 v42, v2, 3, v42
    v_and_b32 v4, 16, v3
    v_xor_b32 v42, v42, v4
    v_add_u32 v43, 147456, v3
    v_lshrrev_b32 v4, 3, v0
    v_and_b32 v5, 7, v0
    v_mul_u32_u24 v45, 49152, v4
    v_lshl_add_u32 v45, v5, 4, v45
    s_and_b32 s64, s71, 6
    v_xor_b32 v6, s64, v4
    v_xor_b32 v5, v5, v6
    v_mul_u32_u24 v44, 384, v4
    v_lshl_add_u32 v44, v5, 4, v44
    ds_read_b128 v[108:111], v43 offset:0
    ds_read_b128 v[112:115], v43 offset:1024
    ds_read_b128 v[116:119], v43 offset:2048
    ds_read_b128 v[120:123], v43 offset:3072
    ds_read_b128 v[124:127], v43 offset:4096
    ds_read_b128 v[128:131], v43 offset:5120
    ds_read_b128 v[132:135], v43 offset:6144
    ds_read_b128 v[136:139], v43 offset:7168
    ds_read_b128 v[140:143], v43 offset:8192
    ds_read_b128 v[144:147], v43 offset:9216
    ds_read_b128 v[148:151], v43 offset:10240
    ds_read_b128 v[152:155], v43 offset:11264
    s_waitcnt lgkmcnt(4)
    ds_read_b128 v[156:159], v43 offset:12288
    ds_read_b128 v[160:163], v43 offset:13312
    ds_read_b128 v[164:167], v43 offset:14336
    ds_read_b128 v[168:171], v43 offset:15360
    s_and_b32 s64, s26, 1
    s_lshl_b32 s64, s64, 5
    s_add_u32 s64, s64, s68
    s_lshl_b32 s64, s64, 10
    s_lshl_b32 s65, s59, 4
    s_add_u32 s64, s64, s65
    s_and_b32 s65, s26, 2
    s_lshl_b32 s65, s65, 2
    s_add_u32 s64, s64, s65
    s_add_u32 s64, s64, 20506752
    v_mov_b32 v4, s10
    v_mov_b32 v5, s11
    v_lshlrev_b32 v6, 11, v0
    s_mov_b64 exec, 0xffff
    s_waitcnt vmcnt(0)
    buffer_store_dwordx2 v[4:5], v6, s[28:31], s64 offen sc1
    s_mov_b64 exec, -1
    s_barrier
    s_waitcnt lgkmcnt(0)
    ds_read_b64_tr_b16 v[8:9], v41 offset:0
    ds_read_b64_tr_b16 v[16:17], v41 offset:24576
    ds_read_b64_tr_b16 v[10:11], v41 offset:6144
    ds_read_b64_tr_b16 v[18:19], v41 offset:30720
    ds_read_b64_tr_b16 v[12:13], v41 offset:12288
    ds_read_b64_tr_b16 v[20:21], v41 offset:36864
    ds_read_b64_tr_b16 v[14:15], v41 offset:18432
    ds_read_b64_tr_b16 v[22:23], v41 offset:43008
    v_xor_b32 v172, 0x80008000, v140
    v_xor_b32 v173, 0x80008000, v141
    v_xor_b32 v174, 0x80008000, v142
    v_xor_b32 v175, 0x80008000, v143
    v_xor_b32 v176, 0x80008000, v144
    v_xor_b32 v177, 0x80008000, v145
    v_xor_b32 v178, 0x80008000, v146
    v_xor_b32 v179, 0x80008000, v147
    v_xor_b32 v180, 0x80008000, v148
    v_xor_b32 v181, 0x80008000, v149
    v_xor_b32 v182, 0x80008000, v150
    v_xor_b32 v183, 0x80008000, v151
    v_xor_b32 v184, 0x80008000, v152
    v_xor_b32 v185, 0x80008000, v153
    v_xor_b32 v186, 0x80008000, v154
    v_xor_b32 v187, 0x80008000, v155
    v_xor_b32 v188, 0x80008000, v156
    v_xor_b32 v189, 0x80008000, v157
    v_xor_b32 v190, 0x80008000, v158
    v_xor_b32 v191, 0x80008000, v159
    v_xor_b32 v192, 0x80008000, v160
    v_xor_b32 v193, 0x80008000, v161
    v_xor_b32 v194, 0x80008000, v162
    v_xor_b32 v195, 0x80008000, v163
    v_xor_b32 v196, 0x80008000, v164
    v_xor_b32 v197, 0x80008000, v165
    v_xor_b32 v198, 0x80008000, v166
    v_xor_b32 v199, 0x80008000, v167
    v_xor_b32 v200, 0x80008000, v168
    v_xor_b32 v201, 0x80008000, v169
    v_xor_b32 v202, 0x80008000, v170
    v_xor_b32 v203, 0x80008000, v171
    s_lshl_b32 s66, s59, 3
    s_add_u32 s66, s66, s26
    s_lshl_b32 s66, s66, 7
    s_add_u32 s66, s66, 20506752
    s_add_u32 s67, s66, 64
    s_mov_b32 s64, 0x40000
L_zp_2:
    s_load_dwordx16 s[36:51], s[24:25], s66 glc
    s_load_dwordx16 s[84:99], s[24:25], s67 glc
    s_waitcnt lgkmcnt(0)
    s_xor_b64 s[36:37], s[36:37], s[10:11]
    s_xor_b64 s[38:39], s[38:39], s[10:11]
    s_or_b64 s[36:37], s[36:37], s[38:39]
    s_xor_b64 s[40:41], s[40:41], s[10:11]
    s_or_b64 s[36:37], s[36:37], s[40:41]
    s_xor_b64 s[42:43], s[42:43], s[10:11]
    s_or_b64 s[36:37], s[36:37], s[42:43]
    s_xor_b64 s[44:45], s[44:45], s[10:11]
    s_or_b64 s[36:37], s[36:37], s[44:45]
    s_xor_b64 s[46:47], s[46:47], s[10:11]
    s_or_b64 s[36:37], s[36:37], s[46:47]
    s_xor_b64 s[48:49], s[48:49], s[10:11]
    s_or_b64 s[36:37], s[36:37], s[48:49]
    s_xor_b64 s[50:51], s[50:51], s[10:11]
    s_or_b64 s[36:37], s[36:37], s[50:51]
    s_xor_b64 s[84:85], s[84:85], s[10:11]
    s_or_b64 s[36:37], s[36:37], s[84:85]
    s_xor_b64 s[86:87], s[86:87], s[10:11]
    s_or_b64 s[36:37], s[36:37], s[86:87]
    s_xor_b64 s[88:89], s[88:89], s[10:11]
    s_or_b64 s[36:37], s[36:37], s[88:89]
    s_xor_b64 s[90:91], s[90:91], s[10:11]
    s_or_b64 s[36:37], s[36:37], s[90:91]
    s_xor_b64 s[92:93], s[92:93], s[10:11]
    s_or_b64 s[36:37], s[36:37], s[92:93]
    s_xor_b64 s[94:95], s[94:95], s[10:11]
    s_or_b64 s[36:37], s[36:37], s[94:95]
    s_xor_b64 s[96:97], s[96:97], s[10:11]
    s_or_b64 s[36:37], s[36:37], s[96:97]
    s_xor_b64 s[98:99], s[98:99], s[10:11]
    s_or_b64 s[36:37], s[36:37], s[98:99]
    s_cbranch_scc0 L_zq_3
    s_sub_u32 s64, s64, 1
    s_cbranch_scc0 L_zp_2
L_zq_3:
    s_mov_b32 s36, s4
    s_mov_b32 s37, s5
    s_mov_b32 s38, 2621440
    s_mov_b32 s39, 0x20000
    s_mul_i32 s69, s59, 49152
    s_mul_i32 s65, s26, 3072
    s_add_u32 s69, s69, s65
    s_add_u32 s69, s69, 6291456
    s_add_u32 m0, s65, 0
    s_nop 0
    buffer_load_dwordx4 v3, s[28:31], s69 offen sc1 lds
    buffer_load_dwordx4 v3, s[28:31], s69 offen offset:1024 sc1 lds
    buffer_load_dwordx4 v3, s[28:31], s69 offen offset:2048 sc1 lds
    s_add_u32 s69, s69, 24576
    s_add_u32 m0, s65, 24576
    s_nop 0
    buffer_load_dwordx4 v3, s[28:31], s69 offen sc1 lds
    buffer_load_dwordx4 v3, s[28:31], s69 offen offset:1024 sc1 lds
    buffer_load_dwordx4 v3, s[28:31], s69 offen offset:2048 sc1 lds
    v_mov_b32 v47, 0
    v_lshlrev_b32 v46, 2, v1
    ds_write_b32 v46, v47 offset:61440
    v_mov_b32 v47, 1
    s_and_b32 s64, s26, 4
    s_add_u32 s64, s64, 61440
    v_mov_b32 v46, s64
    s_lshl_b32 s69, s72, 6
    s_add_u32 s69, s69, s71
    s_mul_i32 s69, s69, 384
    s_add_u32 s69, s69, 9437184
    s_mul_i32 s70, s72, 3
    s_add_u32 s70, s70, s26
    s_waitcnt vmcnt(0) lgkmcnt(0)
    s_cmp_lt_u32 s26, 4
    s_cbranch_scc1 L_pr_4
    s_setprio 2
L_pr_4:
    s_barrier
    ds_read_b64_tr_b16 v[92:93], v40 offset:0
    ds_read_b64_tr_b16 v[94:95], v40 offset:6144
    ds_read_b64_tr_b16 v[100:101], v40 offset:24576
    ds_read_b64_tr_b16 v[102:103], v40 offset:30720
    ds_read_b64_tr_b16 v[96:97], v40 offset:12288
    ds_read_b64_tr_b16 v[98:99], v40 offset:18432
    ds_read_b64_tr_b16 v[104:105], v40 offset:36864
    ds_read_b64_tr_b16 v[106:107], v40 offset:43008
    v_lshlrev_b32 v220, 16, v8
    v_and_b32 v221, 0xffff0000, v8
    v_lshlrev_b32 v222, 16, v9
    v_and_b32 v223, 0xffff0000, v9
    v_lshlrev_b32 v224, 16, v16
    v_and_b32 v225, 0xffff0000, v16
    v_lshlrev_b32 v226, 16, v17
    v_and_b32 v227, 0xffff0000, v17
    v_lshlrev_b32 v228, 16, v10
    v_and_b32 v229, 0xffff0000, v10
    v_lshlrev_b32 v230, 16, v11
    v_and_b32 v231, 0xffff0000, v11
    v_lshlrev_b32 v232, 16, v18
    v_and_b32 v233, 0xffff0000, v18
    v_lshlrev_b32 v234, 16, v19
    v_and_b32 v235, 0xffff0000, v19
L_f2l_5:
    s_waitcnt lgkmcnt(0)
    v_mfma_f32_16x16x32_bf16 v[60:63], v[108:111], v[92:95], 0
    v_lshlrev_b32 v236, 16, v12
    v_and_b32 v237, 0xffff0000, v12
    v_lshlrev_b32 v238, 16, v13
    v_mfma_f32_16x16x32_bf16 v[76:79], v[108:111], v[100:103], 0
    v_and_b32 v239, 0xffff0000, v13
    v_lshlrev_b32 v240, 16, v20
    v_mfma_f32_16x16x32_bf16 v[60:63], v[140:143], v[100:103], v[60:63]
    v_and_b32 v241, 0xffff0000, v20
    v_lshlrev_b32 v242, 16, v21
    v_mfma_f32_16x16x32_bf16 v[76:79], v[172:175], v[92:95], v[76:79]
    v_and_b32 v243, 0xffff0000, v21
    v_lshlrev_b32 v248, 16, v14
    v_mfma_f32_16x16x32_bf16 v[60:63], v[112:115], v[96:99], v[60:63]
    v_and_b32 v249, 0xffff0000, v14
    v_lshlrev_b32 v250, 16, v15
    v_and_b32 v251, 0xffff0000, v15
    v_mfma_f32_16x16x32_bf16 v[76:79], v[112:115], v[104:107], v[76:79]
    v_lshlrev_b32 v252, 16, v22
    v_and_b32 v253, 0xffff0000, v22
    v_mfma_f32_16x16x32_bf16 v[60:63], v[144:147], v[104:107], v[60:63]
    v_lshlrev_b32 v254, 16, v23
    v_and_b32 v255, 0xffff0000, v23
    v_mfma_f32_16x16x32_bf16 v[76:79], v[176:179], v[96:99], v[76:79]
    v_add_u32 v40, 256, v40
    v_add_u32 v41, 256, v41
    v_mfma_f32_16x16x32_bf16 v[64:67], v[116:119], v[92:95], 0
    ds_read_b64_tr_b16 v[8:9], v41 offset:0
    ds_read_b64_tr_b16 v[16:17], v41 offset:24576
    v_mfma_f32_16x16x32_bf16 v[80:83], v[116:119], v[100:103], 0
    ds_read_b64_tr_b16 v[10:11], v41 offset:6144
    v_mfma_f32_16x16x32_bf16 v[64:67], v[148:151], v[100:103], v[64:67]
    ds_read_b64_tr_b16 v[18:19], v41 offset:30720
    v_mfma_f32_16x16x32_bf16 v[80:83], v[180:183], v[92:95], v[80:83]
    v_mul_f32 v24, v76, v224
    v_mul_f32 v25, v77, v225
    v_mul_f32 v26, v78, v226
    v_mfma_f32_16x16x32_bf16 v[64:67], v[120:123], v[96:99], v[64:67]
    v_mul_f32 v27, v79, v227
    v_mul_f32 v76, v76, v220
    v_mfma_f32_16x16x32_bf16 v[80:83], v[120:123], v[104:107], v[80:83]
    v_mul_f32 v77, v77, v221
    v_mul_f32 v78, v78, v222
    v_mfma_f32_16x16x32_bf16 v[64:67], v[152:155], v[104:107], v[64:67]
    v_mul_f32 v79, v79, v223
    v_fmac_f32 v76, v60, v224
    v_mfma_f32_16x16x32_bf16 v[80:83], v[184:187], v[96:99], v[80:83]
    v_fmac_f32 v77, v61, v225
    v_fmac_f32 v78, v62, v226
    v_mfma_f32_16x16x32_bf16 v[68:71], v[124:127], v[92:95], 0
    v_fmac_f32 v79, v63, v227
    v_fma_f32 v60, v60, v220, -v24
    v_mfma_f32_16x16x32_bf16 v[84:87], v[124:127], v[100:103], 0
    v_fma_f32 v61, v61, v221, -v25
    v_fma_f32 v62, v62, v222, -v26
    v_mfma_f32_16x16x32_bf16 v[68:71], v[156:159], v[100:103], v[68:71]
    v_fma_f32 v63, v63, v223, -v27
    v_cvt_pk_bf16_f32 v204, v60, v61
    v_mfma_f32_16x16x32_bf16 v[84:87], v[188:191], v[92:95], v[84:87]
    v_cvt_pk_bf16_f32 v205, v62, v63
    v_cvt_pk_bf16_f32 v212, v76, v77
    v_mfma_f32_16x16x32_bf16 v[68:71], v[128:131], v[96:99], v[68:71]
    v_cvt_pk_bf16_f32 v213, v78, v79
    v_mul_f32 v24, v80, v232
    v_mfma_f32_16x16x32_bf16 v[84:87], v[128:131], v[104:107], v[84:87]
    v_mul_f32 v25, v81, v233
    v_mul_f32 v26, v82, v234
    v_mul_f32 v27, v83, v235
    v_mfma_f32_16x16x32_bf16 v[68:71], v[160:163], v[104:107], v[68:71]
    v_mul_f32 v80, v80, v228
    v_mul_f32 v81, v81, v229
    v_mfma_f32_16x16x32_bf16 v[84:87], v[192:195], v[96:99], v[84:87]
    v_mul_f32 v82, v82, v230
    v_mul_f32 v83, v83, v231
    v_mfma_f32_16x16x32_bf16 v[72:75], v[132:135], v[92:95], 0
    v_fmac_f32 v80, v64, v232
    v_fmac_f32 v81, v65, v233
    v_mfma_f32_16x16x32_bf16 v[88:91], v[132:135], v[100:103], 0
    v_fmac_f32 v82, v66, v234
    v_fmac_f32 v83, v67, v235
    v_mfma_f32_16x16x32_bf16 v[72:75], v[164:167], v[100:103], v[72:75]
    v_fma_f32 v64, v64, v228, -v24
    v_fma_f32 v65, v65, v229, -v25
    v_mfma_f32_16x16x32_bf16 v[88:91], v[196:199], v[92:95], v[88:91]
    v_fma_f32 v66, v66, v230, -v26
    v_fma_f32 v67, v67, v231, -v27
    v_mfma_f32_16x16x32_bf16 v[72:75], v[136:139], v[96:99], v[72:75]
    v_cvt_pk_bf16_f32 v206, v64, v65
    v_cvt_pk_bf16_f32 v207, v66, v67
    v_mfma_f32_16x16x32_bf16 v[88:91], v[136:139], v[104:107], v[88:91]
    v_cvt_pk_bf16_f32 v214, v80, v81
    v_cvt_pk_bf16_f32 v215, v82, v83
    v_mfma_f32_16x16x32_bf16 v[72:75], v[168:171], v[104:107], v[72:75]
    v_mul_f32 v24, v84, v240
    v_mul_f32 v25, v85, v241
    v_mfma_f32_16x16x32_bf16 v[88:91], v[200:203], v[96:99], v[88:91]
    v_mul_f32 v26, v86, v242
    v_mul_f32 v27, v87, v243
    v_mfma_f32_16x16x32_bf16 v[60:63], v[204:207], v[108:111], 0
    v_mul_f32 v84, v84, v236
    v_mul_f32 v85, v85, v237
    v_mul_f32 v86, v86, v238
    v_mfma_f32_16x16x32_bf16 v[76:79], v[212:215], v[108:111], 0
    v_mul_f32 v87, v87, v239
    v_fmac_f32 v84, v68, v240
    v_fmac_f32 v85, v69, v241
    v_mfma_f32_16x16x32_bf16 v[60:63], v[212:215], v[172:175], v[60:63]
    v_fmac_f32 v86, v70, v242
    v_fmac_f32 v87, v71, v243
    v_fma_f32 v68, v68, v236, -v24
    v_mfma_f32_16x16x32_bf16 v[76:79], v[204:207], v[140:143], v[76:79]
    v_fma_f32 v69, v69, v237, -v25
    v_fma_f32 v70, v70, v238, -v26
    v_fma_f32 v71, v71, v239, -v27
    v_mfma_f32_16x16x32_bf16 v[64:67], v[204:207], v[116:119], 0
    v_cvt_pk_bf16_f32 v208, v68, v69
    v_cvt_pk_bf16_f32 v209, v70, v71
    v_cvt_pk_bf16_f32 v216, v84, v85
    v_mfma_f32_16x16x32_bf16 v[80:83], v[212:215], v[116:119], 0
    v_cvt_pk_bf16_f32 v217, v86, v87
    ds_read_b64_tr_b16 v[92:93], v40 offset:0
    ds_read_b64_tr_b16 v[94:95], v40 offset:6144
    v_mfma_f32_16x16x32_bf16 v[64:67], v[212:215], v[180:183], v[64:67]
    ds_read_b64_tr_b16 v[100:101], v40 offset:24576
    ds_read_b64_tr_b16 v[102:103], v40 offset:30720
    ds_read_b64_tr_b16 v[96:97], v40 offset:12288
    v_mfma_f32_16x16x32_bf16 v[80:83], v[204:207], v[148:151], v[80:83]
    ds_read_b64_tr_b16 v[98:99], v40 offset:18432
    ds_read_b64_tr_b16 v[104:105], v40 offset:36864
    ds_read_b64_tr_b16 v[106:107], v40 offset:43008
    v_mfma_f32_16x16x32_bf16 v[68:71], v[204:207], v[124:127], 0
    v_mul_f32 v24, v88, v252
    v_mul_f32 v25, v89, v253
    v_mul_f32 v26, v90, v254
    v_mfma_f32_16x16x32_bf16 v[84:87], v[212:215], v[124:127], 0
    v_mul_f32 v27, v91, v255
    v_mul_f32 v88, v88, v248
    v_mfma_f32_16x16x32_bf16 v[68:71], v[212:215], v[188:191], v[68:71]
    v_mul_f32 v89, v89, v249
    v_mul_f32 v90, v90, v250
    v_mul_f32 v91, v91, v251
    v_mfma_f32_16x16x32_bf16 v[84:87], v[204:207], v[156:159], v[84:87]
    v_fmac_f32 v88, v72, v252
    v_fmac_f32 v89, v73, v253
    s_waitcnt lgkmcnt(4)
    v_fmac_f32 v90, v74, v254
    v_fmac_f32 v91, v75, v255
    v_fma_f32 v72, v72, v248, -v24
    v_fma_f32 v73, v73, v249, -v25
    v_fma_f32 v74, v74, v250, -v26
    v_fma_f32 v75, v75, v251, -v27
    v_cvt_pk_bf16_f32 v210, v72, v73
    v_cvt_pk_bf16_f32 v211, v74, v75
    v_cvt_pk_bf16_f32 v218, v88, v89
    v_cvt_pk_bf16_f32 v219, v90, v91
    v_mfma_f32_16x16x32_bf16 v[60:63], v[208:211], v[112:115], v[60:63]
    ds_read_b64_tr_b16 v[12:13], v41 offset:12288
    ds_read_b64_tr_b16 v[20:21], v41 offset:36864
    v_mfma_f32_16x16x32_bf16 v[76:79], v[216:219], v[112:115], v[76:79]
    ds_read_b64_tr_b16 v[14:15], v41 offset:18432
    ds_read_b64_tr_b16 v[22:23], v41 offset:43008
    v_mfma_f32_16x16x32_bf16 v[60:63], v[216:219], v[176:179], v[60:63]
    v_lshlrev_b32 v220, 16, v8
    v_mfma_f32_16x16x32_bf16 v[76:79], v[208:211], v[144:147], v[76:79]
    v_and_b32 v221, 0xffff0000, v8
    v_lshlrev_b32 v222, 16, v9
    v_mfma_f32_16x16x32_bf16 v[72:75], v[204:207], v[132:135], 0
    v_and_b32 v223, 0xffff0000, v9
    v_lshlrev_b32 v224, 16, v16
    v_mfma_f32_16x16x32_bf16 v[88:91], v[212:215], v[132:135], 0
    v_and_b32 v225, 0xffff0000, v16
    v_mfma_f32_16x16x32_bf16 v[72:75], v[212:215], v[196:199], v[72:75]
    v_lshlrev_b32 v226, 16, v17
    v_and_b32 v227, 0xffff0000, v17
    v_mfma_f32_16x16x32_bf16 v[88:91], v[204:207], v[164:167], v[88:91]
    v_lshlrev_b32 v228, 16, v10
    v_and_b32 v229, 0xffff0000, v10
    v_mfma_f32_16x16x32_bf16 v[64:67], v[208:211], v[120:123], v[64:67]
    v_lshlrev_b32 v230, 16, v11
    v_mfma_f32_16x16x32_bf16 v[80:83], v[216:219], v[120:123], v[80:83]
    v_and_b32 v231, 0xffff0000, v11
    v_lshlrev_b32 v232, 16, v18
    v_mfma_f32_16x16x32_bf16 v[64:67], v[216:219], v[184:187], v[64:67]
    v_and_b32 v233, 0xffff0000, v18
    v_lshlrev_b32 v234, 16, v19
    v_mfma_f32_16x16x32_bf16 v[80:83], v[208:211], v[152:155], v[80:83]
    v_and_b32 v235, 0xffff0000, v19
    v_mfma_f32_16x16x32_bf16 v[68:71], v[208:211], v[128:131], v[68:71]
    v_cvt_pk_bf16_f32 v60, v60, v61
    v_cvt_pk_bf16_f32 v61, v62, v63
    v_mfma_f32_16x16x32_bf16 v[84:87], v[216:219], v[128:131], v[84:87]
    ds_write_b64 v42, v[60:61] offset:0
    v_mfma_f32_16x16x32_bf16 v[68:71], v[216:219], v[192:195], v[68:71]
    v_cvt_pk_bf16_f32 v76, v76, v77
    v_cvt_pk_bf16_f32 v77, v78, v79
    v_mfma_f32_16x16x32_bf16 v[84:87], v[208:211], v[160:163], v[84:87]
    ds_write_b64 v42, v[76:77] offset:24576
    v_mfma_f32_16x16x32_bf16 v[72:75], v[208:211], v[136:139], v[72:75]
    v_cvt_pk_bf16_f32 v64, v64, v65
    v_cvt_pk_bf16_f32 v65, v66, v67
    v_mfma_f32_16x16x32_bf16 v[88:91], v[216:219], v[136:139], v[88:91]
    ds_write_b64 v42, v[64:65] offset:6144
    v_mfma_f32_16x16x32_bf16 v[72:75], v[216:219], v[200:203], v[72:75]
    v_cvt_pk_bf16_f32 v80, v80, v81
    v_cvt_pk_bf16_f32 v81, v82, v83
    v_mfma_f32_16x16x32_bf16 v[88:91], v[208:211], v[168:171], v[88:91]
    ds_write_b64 v42, v[80:81] offset:30720
    s_waitcnt lgkmcnt(6)
    v_cvt_pk_bf16_f32 v68, v68, v69
    v_cvt_pk_bf16_f32 v69, v70, v71
    ds_write_b64 v42, v[68:69] offset:12288
    v_cvt_pk_bf16_f32 v84, v84, v85
    v_cvt_pk_bf16_f32 v85, v86, v87
    ds_write_b64 v42, v[84:85] offset:36864
    v_cvt_pk_bf16_f32 v72, v72, v73
    v_cvt_pk_bf16_f32 v73, v74, v75
    ds_write_b64 v42, v[72:73] offset:18432
    v_cvt_pk_bf16_f32 v88, v88, v89
    v_cvt_pk_bf16_f32 v89, v90, v91
    ds_write_b64 v42, v[88:89] offset:43008
    v_add_u32 v42, 256, v42
    s_mov_b64 exec, 1
    ds_add_u32 v46, v47
    s_mov_b64 exec, -1
    v_add_u32 v46, 8, v46
    s_cmp_ge_u32 s26, 4
    s_cbranch_scc1 L_f2h_8
    s_cmp_lt_u32 s70, 4
    s_mov_b32 s70, 64
    s_cbranch_scc1 L_f2l_5
    s_waitcnt lgkmcnt(0)
    s_lshl_b32 s64, s26, 8
    s_add_u32 s64, s64, s2
    s_cmp_lg_u32 s64, 0x108
    s_cbranch_scc1 L_f2e_9
    s_mov_b32 s64, 0x20000
    s_mov_b32 s65, 20504704
L_ep_10:
    buffer_load_dwordx4 v[60:63], v3, s[28:31], s65 offen offset:0 sc1
    buffer_load_dwordx4 v[64:67], v3, s[28:31], s65 offen offset:1024 sc1
    s_waitcnt vmcnt(0)
    v_xor_b32 v60, s10, v60
    v_xor_b32 v61, s11, v61
    v_or_b32 v60, v60, v61
    v_xor_b32 v62, s10, v62
    v_or_b32 v60, v60, v62
    v_xor_b32 v63, s11, v63
    v_or_b32 v60, v60, v63
    v_xor_b32 v64, s10, v64
    v_or_b32 v60, v60, v64
    v_xor_b32 v65, s11, v65
    v_or_b32 v60, v60, v65
    v_xor_b32 v66, s10, v66
    v_or_b32 v60, v60, v66
    v_xor_b32 v67, s11, v67
    v_or_b32 v60, v60, v67
    v_cmp_ne_u32 vcc, 0, v60
    s_nop 0
    s_cbranch_vccz L_eq_11
    s_sleep 8
    s_sub_u32 s64, s64, 1
    s_cbranch_scc0 L_ep_10
L_eq_11:
    s_mov_b32 s63, 20480000
    v_mov_b32 v4, s10
    v_mov_b32 v5, s11
    v_lshlrev_b32 v6, 3, v0
    s_mov_b64 exec, 1
    buffer_store_dwordx2 v[4:5], v6, s[28:31], s63 offen sc1
    s_mov_b64 exec, -1
    s_branch L_f2e_9
L_f2h_8:
    s_setprio 0
    s_and_b32 s64, s26, 3
    s_mul_i32 s65, s64, 12288
    v_add_u32 v44, s65, v44
    s_and_b32 s65, s64, 1
    s_mul_i32 s65, s65, 1572864
    s_lshr_b32 s64, s64, 1
    s_mul_i32 s64, s64, 12288
    s_add_u32 s69, s69, s65
    s_add_u32 s69, s69, s64
    v_mov_b32 v46, 61440
    s_mul_i32 s70, s72, 3
    s_sub_u32 s70, 4, s70
    s_mov_b32 s65, 0x100000
L_lw_12:
    ds_read_b32 v4, v46 offset:4
    s_waitcnt lgkmcnt(0)
    v_readfirstlane_b32 s64, v4
    s_nop 0
    s_cmp_eq_u32 s64, 4
    s_cbranch_scc1 L_lo_13
    s_sleep 1
    s_sub_u32 s65, s65, 1
    s_cbranch_scc0 L_lw_12
L_lo_13:
    ds_read_b128 v[60:63], v44 offset:128
    ds_read_b128 v[64:67], v44 offset:3200
    ds_read_b128 v[68:71], v44 offset:6272
    ds_read_b128 v[72:75], v44 offset:9344
    s_add_u32 s64, s69, 0
    s_waitcnt lgkmcnt(3)
    buffer_store_dwordx4 v[60:63], v45, s[28:31], s64 offen offset:128 sc1
    s_add_u32 s64, s69, 393216
    s_waitcnt lgkmcnt(2)
    buffer_store_dwordx4 v[64:67], v45, s[28:31], s64 offen offset:128 sc1
    s_add_u32 s64, s69, 786432
    s_waitcnt lgkmcnt(1)
    buffer_store_dwordx4 v[68:71], v45, s[28:31], s64 offen offset:128 sc1
    s_add_u32 s64, s69, 1179648
    s_waitcnt lgkmcnt(0)
    buffer_store_dwordx4 v[72:75], v45, s[28:31], s64 offen offset:128 sc1
    s_and_b32 s64, s26, 3
    s_lshl_b32 s64, s64, 12
    s_add_u32 m0, s64, 147456
    s_add_u32 s64, s64, 32768
    buffer_load_dwordx4 v3, s[32:35], s64 offen lds
    buffer_load_dwordx4 v3, s[32:35], s64 offen offset:1024 lds
    buffer_load_dwordx4 v3, s[32:35], s64 offen offset:2048 lds
    buffer_load_dwordx4 v3, s[32:35], s64 offen offset:3072 lds
    s_mov_b32 s65, 0x100000
L_lw_14:
    ds_read_b32 v4, v46 offset:0
    s_waitcnt lgkmcnt(0)
    v_readfirstlane_b32 s64, v4
    s_nop 0
    s_cmp_eq_u32 s64, 4
    s_cbranch_scc1 L_lo_15
    s_sleep 1
    s_sub_u32 s65, s65, 1
    s_cbranch_scc0 L_lw_14
L_lo_15:
    ds_read_b128 v[76:79], v44 offset:0
    ds_read_b128 v[80:83], v44 offset:3072
    ds_read_b128 v[84:87], v44 offset:6144
    ds_read_b128 v[88:91], v44 offset:9216
    s_add_u32 s64, s69, 0
    s_waitcnt lgkmcnt(3)
    buffer_store_dwordx4 v[76:79], v45, s[28:31], s64 offen offset:0 sc1
    s_add_u32 s64, s69, 393216
    s_waitcnt lgkmcnt(2)
    buffer_store_dwordx4 v[80:83], v45, s[28:31], s64 offen offset:0 sc1
    s_add_u32 s64, s69, 786432
    s_waitcnt lgkmcnt(1)
    buffer_store_dwordx4 v[84:87], v45, s[28:31], s64 offen offset:0 sc1
    s_add_u32 s64, s69, 1179648
    s_waitcnt lgkmcnt(0)
    buffer_store_dwordx4 v[88:91], v45, s[28:31], s64 offen offset:0 sc1
    s_and_b32 s63, s26, 1
    s_lshl_b32 s63, s63, 15
    s_lshl_b32 s64, s72, 9
    s_add_u32 s63, s63, s64
    s_and_b32 s64, s26, 2
    s_lshl_b32 s64, s64, 7
    s_add_u32 s63, s63, s64
    s_lshl_b32 s64, s71, 3
    s_add_u32 s63, s63, s64
    s_add_u32 s63, s63, 20572288
    v_mov_b32 v92, s10
    v_mov_b32 v93, s11
    v_lshlrev_b32 v94, 10, v0
    s_mov_b32 s65, 0x100000
L_lw_16:
    ds_read_b32 v4, v46 offset:8
    s_waitcnt lgkmcnt(0)
    v_readfirstlane_b32 s64, v4
    s_nop 0
    s_cmp_eq_u32 s64, s70
    s_cbranch_scc1 L_lo_17
    s_sleep 1
    s_sub_u32 s65, s65, 1
    s_cbranch_scc0 L_lw_16
L_lo_17:
    ds_read_b128 v[60:63], v44 offset:256
    ds_read_b128 v[64:67], v44 offset:3328
    ds_read_b128 v[68:71], v44 offset:6400
    ds_read_b128 v[72:75], v44 offset:9472
    s_add_u32 s64, s69, 0
    s_waitcnt lgkmcnt(3)
    buffer_store_dwordx4 v[60:63], v45, s[28:31], s64 offen offset:256 sc1
    s_add_u32 s64, s69, 393216
    s_waitcnt lgkmcnt(2)
    buffer_store_dwordx4 v[64:67], v45, s[28:31], s64 offen offset:256 sc1
    s_add_u32 s64, s69, 786432
    s_waitcnt lgkmcnt(1)
    buffer_store_dwordx4 v[68:71], v45, s[28:31], s64 offen offset:256 sc1
    s_add_u32 s64, s69, 1179648
    s_waitcnt lgkmcnt(0)
    buffer_store_dwordx4 v[72:75], v45, s[28:31], s64 offen offset:256 sc1
    s_mov_b32 exec_hi, 0
    s_waitcnt vmcnt(0)
    buffer_store_dwordx2 v[92:93], v94, s[28:31], s63 offen sc1
    s_mov_b64 exec, -1
L_f2e_9:
    v_lshrrev_b32 v4, 1, v1
    s_lshl_b32 s64, s61, 9
    s_add_u32 s64, s64, s60
    v_lshlrev_b32 v232, 6, v4
    v_add_u32 v232, s64, v232
    v_lshlrev_b32 v4, 2, v2
    v_mul_u32_u24 v233, v232, v4
    v_and_b32 v4, 1, v0
    v_mul_u32_u24 v4, 1536, v4
    v_add_u32 v233, v233, v4
    v_mad_u32_u24 v5, v232, 0, v233
    v_and_b32 v5, 2047, v5
    v_cvt_f32_u32 v5, v5
    v_mul_f32 v5, 0x3a000000, v5
    v_mad_u32_u24 v6, v232, 1, v233
    v_and_b32 v6, 2047, v6
    v_cvt_f32_u32 v6, v6
    v_mul_f32 v6, 0x3a000000, v6
    v_cos_f32 v228, v5
    v_cos_f32 v229, v6
    v_sin_f32 v230, v5
    v_sin_f32 v231, v6
    v_cvt_pk_bf16_f32 v236, v228, v229
    v_cvt_pk_bf16_f32 v240, -v230, -v231
    v_mad_u32_u24 v5, v232, 2, v233
    v_and_b32 v5, 2047, v5
    v_cvt_f32_u32 v5, v5
    v_mul_f32 v5, 0x3a000000, v5
    v_mad_u32_u24 v6, v232, 3, v233
    v_and_b32 v6, 2047, v6
    v_cvt_f32_u32 v6, v6
    v_mul_f32 v6, 0x3a000000, v6
    v_cos_f32 v228, v5
    v_cos_f32 v229, v6
    v_sin_f32 v230, v5
    v_sin_f32 v231, v6
    v_cvt_pk_bf16_f32 v237, v228, v229
    v_cvt_pk_bf16_f32 v241, -v230, -v231
    v_mad_u32_u24 v5, v232, 16, v233
    v_and_b32 v5, 2047, v5
    v_cvt_f32_u32 v5, v5
    v_mul_f32 v5, 0x3a000000, v5
    v_mad_u32_u24 v6, v232, 17, v233
    v_and_b32 v6, 2047, v6
    v_cvt_f32_u32 v6, v6
    v_mul_f32 v6, 0x3a000000, v6
    v_cos_f32 v228, v5
    v_cos_f32 v229, v6
    v_sin_f32 v230, v5
    v_sin_f32 v231, v6
    v_cvt_pk_bf16_f32 v238, v228, v229
    v_cvt_pk_bf16_f32 v242, -v230, -v231
    v_mad_u32_u24 v5, v232, 18, v233
    v_and_b32 v5, 2047, v5
    v_cvt_f32_u32 v5, v5
    v_mul_f32 v5, 0x3a000000, v5
    v_mad_u32_u24 v6, v232, 19, v233
    v_and_b32 v6, 2047, v6
    v_cvt_f32_u32 v6, v6
    v_mul_f32 v6, 0x3a000000, v6
    v_cos_f32 v228, v5
    v_cos_f32 v229, v6
    v_sin_f32 v230, v5
    v_sin_f32 v231, v6
    v_cvt_pk_bf16_f32 v239, v228, v229
    v_cvt_pk_bf16_f32 v243, -v230, -v231
    s_mov_b32 s48, s18
    s_mov_b32 s49, s19
    s_mov_b32 s50, 1280
    s_mov_b32 s51, 0x20000
    v_lshlrev_b32 v246, 2, v0
    buffer_load_dwordx4 v[228:231], v3, s[36:39], s52 offen
    buffer_load_dword v244, v246, s[36:39], s52 offen offset:1024
    buffer_load_dwordx4 v[232:235], v3, s[48:51], 0 offen
    buffer_load_dword v245, v246, s[48:51], 0 offen offset:1024
    s_barrier
    s_branch L_f3
L_ld:
    s_add_u32 s76, s24, 20480000
    s_addc_u32 s77, s25, 0
    s_load_dwordx2 s[10:11], s[76:77], 0
    s_waitcnt vmcnt(8)
    s_barrier
    s_bfe_u32 s73, s84, 0x40008
    s_add_u32 s73, s73, s71
    s_sub_u32 s75, s73, 10
    s_cselect_b32 s73, s73, s75
    s_lshl_b32 s72, s73, 7
    s_add_u32 s72, s72, s65
    s_mul_i32 s73, s73, 196608
    s_add_u32 s73, s73, s66
    s_add_u32 m0, s67, 106496
    s_add_u32 s75, s73, 0
    buffer_load_dwordx4 v161, s[40:43], s75 offen lds
    s_add_u32 m0, s67, 107520
    s_add_u32 s75, s73, 12288
    buffer_load_dwordx4 v161, s[40:43], s75 offen lds
    s_add_u32 m0, s67, 108544
    s_add_u32 s75, s73, 24576
    buffer_load_dwordx4 v162, s[40:43], s75 offen lds
    s_add_u32 m0, s67, 109568
    s_add_u32 s75, s73, 36864
    buffer_load_dwordx4 v162, s[40:43], s75 offen lds
    s_add_u32 m0, s67, 32768
    s_add_u32 s75, s72, 0
    buffer_load_dwordx4 v160, s[36:39], s75 offen lds
    s_add_u32 m0, s67, 33792
    s_add_u32 s75, s72, 655360
    buffer_load_dwordx4 v160, s[36:39], s75 offen lds
    s_add_u32 m0, s67, 34816
    s_add_u32 s75, s72, 1310720
    buffer_load_dwordx4 v160, s[36:39], s75 offen lds
    s_add_u32 m0, s67, 35840
    s_add_u32 s75, s72, 1966080
    buffer_load_dwordx4 v160, s[36:39], s75 offen lds
    s_setprio 0
    s_mov_b32 s44, s16
    s_mov_b32 s45, s17
    s_mov_b32 s46, 1966080
    s_mov_b32 s47, 0x20000
    s_mul_i32 s69, s56, 393216
    s_lshl_b32 s75, s58, 17
    s_add_u32 s69, s69, s75
    s_and_b32 s75, s64, 1
    s_lshl_b32 s75, s75, 13
    s_add_u32 s69, s69, s75
    v_add_u32 v6, 0, v0
    v_mul_u32_u24 v4, 13108, v6
    v_lshrrev_b32 v4, 18, v4
    v_mul_u32_u24 v5, 20, v4
    v_sub_u32 v5, v6, v5
    v_lshrrev_b32 v6, 1, v4
    v_and_b32 v6, 2, v6
    v_xor_b32 v5, v5, v6
    v_mul_u32_u24 v163, 1280, v4
    v_lshl_add_u32 v163, v5, 4, v163
    v_add_u32 v6, 64, v0
    v_mul_u32_u24 v4, 13108, v6
    v_lshrrev_b32 v4, 18, v4
    v_mul_u32_u24 v5, 20, v4
    v_sub_u32 v5, v6, v5
    v_lshrrev_b32 v6, 1, v4
    v_and_b32 v6, 2, v6
    v_xor_b32 v5, v5, v6
    v_mul_u32_u24 v164, 1280, v4
    v_lshl_add_u32 v164, v5, 4, v164
    v_add_u32 v6, 128, v0
    v_mul_u32_u24 v4, 13108, v6
    v_lshrrev_b32 v4, 18, v4
    v_mul_u32_u24 v5, 20, v4
    v_sub_u32 v5, v6, v5
    v_lshrrev_b32 v6, 1, v4
    v_and_b32 v6, 2, v6
    v_xor_b32 v5, v5, v6
    v_mul_u32_u24 v165, 1280, v4
    v_lshl_add_u32 v165, v5, 4, v165
    v_add_u32 v6, 192, v0
    v_mul_u32_u24 v4, 13108, v6
    v_lshrrev_b32 v4, 18, v4
    v_mul_u32_u24 v5, 20, v4
    v_sub_u32 v5, v6, v5
    v_lshrrev_b32 v6, 1, v4
    v_and_b32 v6, 2, v6
    v_xor_b32 v5, v5, v6
    v_mul_u32_u24 v166, 1280, v4
    v_lshl_add_u32 v166, v5, 4, v166
    v_add_u32 v6, 256, v0
    v_mul_u32_u24 v4, 13108, v6
    v_lshrrev_b32 v4, 18, v4
    v_mul_u32_u24 v5, 20, v4
    v_sub_u32 v5, v6, v5
    v_lshrrev_b32 v6, 1, v4
    v_and_b32 v6, 2, v6
    v_xor_b32 v5, v5, v6
    v_mul_u32_u24 v167, 1280, v4
    v_lshl_add_u32 v167, v5, 4, v167
    s_lshl_b32 s70, s58, 5
    s_lshl_b32 s75, s64, 2
    s_add_u32 s70, s70, s75
    s_mul_i32 s70, s70, 20480
    s_mul_i32 s75, s57, 320
    s_add_u32 s70, s70, s75
    s_mul_i32 s68, s64, 10240
    s_lshl_b32 s74, s62, 7
    s_add_u32 s74, s74, 20480128
    v_lshlrev_b32 v180, 7, v0
    s_and_b32 s75, s64, 1
    s_lshl_b32 s75, s75, 10
    v_add_u32 v181, s75, v3
    v_add_u32 v182, 147456, v181
    v_lshlrev_b32 v184, 3, v0
    s_setprio 3
    s_waitcnt vmcnt(8)
    s_barrier
    s_bfe_u32 s73, s84, 0x4000c
    s_add_u32 s73, s73, s71
    s_sub_u32 s75, s73, 10
    s_cselect_b32 s73, s73, s75
    s_lshl_b32 s72, s73, 7
    s_add_u32 s72, s72, s65
    s_mul_i32 s73, s73, 196608
    s_add_u32 s73, s73, s66
    s_add_u32 m0, s67, 126976
    s_add_u32 s75, s73, 0
    buffer_load_dwordx4 v161, s[40:43], s75 offen lds
    s_add_u32 m0, s67, 128000
    s_add_u32 s75, s73, 12288
    buffer_load_dwordx4 v161, s[40:43], s75 offen lds
    s_add_u32 m0, s67, 129024
    s_add_u32 s75, s73, 24576
    buffer_load_dwordx4 v162, s[40:43], s75 offen lds
    s_add_u32 m0, s67, 130048
    s_add_u32 s75, s73, 36864
    buffer_load_dwordx4 v162, s[40:43], s75 offen lds
    s_add_u32 m0, s67, 49152
    s_add_u32 s75, s72, 0
    buffer_load_dwordx4 v160, s[36:39], s75 offen lds
    s_add_u32 m0, s67, 50176
    s_add_u32 s75, s72, 655360
    buffer_load_dwordx4 v160, s[36:39], s75 offen lds
    s_add_u32 m0, s67, 51200
    s_add_u32 s75, s72, 1310720
    buffer_load_dwordx4 v160, s[36:39], s75 offen lds
    s_add_u32 m0, s67, 52224
    s_add_u32 s75, s72, 1966080
    buffer_load_dwordx4 v160, s[36:39], s75 offen lds
    s_bfe_u32 s73, s84, 0x40010
    s_add_u32 s73, s73, s71
    s_sub_u32 s75, s73, 10
    s_cselect_b32 s73, s73, s75
    s_lshl_b32 s72, s73, 7
    s_add_u32 s72, s72, s65
    s_mul_i32 s73, s73, 196608
    s_add_u32 s73, s73, s66
    s_add_u32 m0, s67, 65536
    s_add_u32 s75, s73, 0
    buffer_load_dwordx4 v161, s[40:43], s75 offen lds
    s_add_u32 m0, s67, 66560
    s_add_u32 s75, s73, 12288
    buffer_load_dwordx4 v161, s[40:43], s75 offen lds
    s_add_u32 m0, s67, 67584
    s_add_u32 s75, s73, 24576
    buffer_load_dwordx4 v162, s[40:43], s75 offen lds
    s_add_u32 m0, s67, 68608
    s_add_u32 s75, s73, 36864
    buffer_load_dwordx4 v162, s[40:43], s75 offen lds
    s_add_u32 m0, s67, 0
    s_add_u32 s75, s72, 0
    buffer_load_dwordx4 v160, s[36:39], s75 offen lds
    s_add_u32 m0, s67, 1024
    s_add_u32 s75, s72, 655360
    buffer_load_dwordx4 v160, s[36:39], s75 offen lds
    s_add_u32 m0, s67, 2048
    s_add_u32 s75, s72, 1310720
    buffer_load_dwordx4 v160, s[36:39], s75 offen lds
    s_add_u32 m0, s67, 3072
    s_add_u32 s75, s72, 1966080
    buffer_load_dwordx4 v160, s[36:39], s75 offen lds
    s_waitcnt vmcnt(16)
    s_barrier
    s_bfe_u32 s73, s84, 0x40014
    s_add_u32 s73, s73, s71
    s_sub_u32 s75, s73, 10
    s_cselect_b32 s73, s73, s75
    s_lshl_b32 s72, s73, 7
    s_add_u32 s72, s72, s65
    s_mul_i32 s73, s73, 196608
    s_add_u32 s73, s73, s66
    s_add_u32 m0, s67, 86016
    s_add_u32 s75, s73, 0
    buffer_load_dwordx4 v161, s[40:43], s75 offen lds
    s_add_u32 m0, s67, 87040
    s_add_u32 s75, s73, 12288
    buffer_load_dwordx4 v161, s[40:43], s75 offen lds
    s_add_u32 m0, s67, 88064
    s_add_u32 s75, s73, 24576
    buffer_load_dwordx4 v162, s[40:43], s75 offen lds
    s_add_u32 m0, s67, 89088
    s_add_u32 s75, s73, 36864
    buffer_load_dwordx4 v162, s[40:43], s75 offen lds
    s_add_u32 m0, s67, 16384
    s_add_u32 s75, s72, 0
    buffer_load_dwordx4 v160, s[36:39], s75 offen lds
    s_add_u32 m0, s67, 17408
    s_add_u32 s75, s72, 655360
    buffer_load_dwordx4 v160, s[36:39], s75 offen lds
    s_add_u32 m0, s67, 18432
    s_add_u32 s75, s72, 1310720
    buffer_load_dwordx4 v160, s[36:39], s75 offen lds
    s_add_u32 m0, s67, 19456
    s_add_u32 s75, s72, 1966080
    buffer_load_dwordx4 v160, s[36:39], s75 offen lds
    s_waitcnt lgkmcnt(0)
    s_mul_i32 s10, s10, 1664525
    s_add_u32 s10, s10, 1013904223
    s_mul_i32 s11, s11, 22695477
    s_add_u32 s11, s11, 1
    s_waitcnt vmcnt(16)
    s_barrier
    s_bfe_u32 s73, s84, 0x40018
    s_add_u32 s73, s73, s71
    s_sub_u32 s75, s73, 10
    s_cselect_b32 s73, s73, s75
    s_lshl_b32 s72, s73, 7
    s_add_u32 s72, s72, s65
    s_mul_i32 s73, s73, 196608
    s_add_u32 s73, s73, s66
    s_add_u32 m0, s67, 106496
    s_add_u32 s75, s73, 0
    buffer_load_dwordx4 v161, s[40:43], s75 offen lds
    s_add_u32 m0, s67, 107520
    s_add_u32 s75, s73, 12288
    buffer_load_dwordx4 v161, s[40:43], s75 offen lds
    s_add_u32 m0, s67, 108544
    s_add_u32 s75, s73, 24576
    buffer_load_dwordx4 v162, s[40:43], s75 offen lds
    s_add_u32 m0, s67, 109568
    s_add_u32 s75, s73, 36864
    buffer_load_dwordx4 v162, s[40:43], s75 offen lds
    s_add_u32 m0, s67, 32768
    s_add_u32 s75, s72, 0
    buffer_load_dwordx4 v160, s[36:39], s75 offen lds
    s_add_u32 m0, s67, 33792
    s_add_u32 s75, s72, 655360
    buffer_load_dwordx4 v160, s[36:39], s75 offen lds
    s_add_u32 m0, s67, 34816
    s_add_u32 s75, s72, 1310720
    buffer_load_dwordx4 v160, s[36:39], s75 offen lds
    s_add_u32 m0, s67, 35840
    s_add_u32 s75, s72, 1966080
    buffer_load_dwordx4 v160, s[36:39], s75 offen lds
    s_waitcnt vmcnt(16)
    s_barrier
    s_bfe_u32 s73, s84, 0x4001c
    s_add_u32 s73, s73, s71
    s_sub_u32 s75, s73, 10
    s_cselect_b32 s73, s73, s75
    s_lshl_b32 s72, s73, 7
    s_add_u32 s72, s72, s65
    s_mul_i32 s73, s73, 196608
    s_add_u32 s73, s73, s66
    s_add_u32 m0, s67, 126976
    s_add_u32 s75, s73, 0
    buffer_load_dwordx4 v161, s[40:43], s75 offen lds
    s_add_u32 m0, s67, 128000
    s_add_u32 s75, s73, 12288
    buffer_load_dwordx4 v161, s[40:43], s75 offen lds
    s_add_u32 m0, s67, 129024
    s_add_u32 s75, s73, 24576
    buffer_load_dwordx4 v162, s[40:43], s75 offen lds
    s_add_u32 m0, s67, 130048
    s_add_u32 s75, s73, 36864
    buffer_load_dwordx4 v162, s[40:43], s75 offen lds
    s_add_u32 m0, s67, 49152
    s_add_u32 s75, s72, 0
    buffer_load_dwordx4 v160, s[36:39], s75 offen lds
    s_add_u32 m0, s67, 50176
    s_add_u32 s75, s72, 655360
    buffer_load_dwordx4 v160, s[36:39], s75 offen lds
    s_add_u32 m0, s67, 51200
    s_add_u32 s75, s72, 1310720
    buffer_load_dwordx4 v160, s[36:39], s75 offen lds
    s_add_u32 m0, s67, 52224
    s_add_u32 s75, s72, 1966080
    buffer_load_dwordx4 v160, s[36:39], s75 offen lds
    s_cmp_lg_u32 s64, 1
    s_cbranch_scc1 L_on_18
    s_lshl_b32 s75, s2, 3
    s_add_u32 s75, s75, 20504704
    v_mov_b32 v4, s10
    v_mov_b32 v5, s11
    v_lshlrev_b32 v6, 3, v0
    s_mov_b64 exec, 1
    buffer_store_dwordx2 v[4:5], v6, s[28:31], s75 offen sc1
    s_mov_b64 exec, -1
L_on_18:
    s_waitcnt vmcnt(16)
    s_barrier
    s_bfe_u32 s73, s85, 0x40000
    s_add_u32 s73, s73, s71
    s_sub_u32 s75, s73, 10
    s_cselect_b32 s73, s73, s75
    s_lshl_b32 s72, s73, 7
    s_add_u32 s72, s72, s65
    s_mul_i32 s73, s73, 196608
    s_add_u32 s73, s73, s66
    s_add_u32 m0, s67, 65536
    s_add_u32 s75, s73, 0
    buffer_load_dwordx4 v161, s[40:43], s75 offen lds
    s_add_u32 m0, s67, 66560
    s_add_u32 s75, s73, 12288
    buffer_load_dwordx4 v161, s[40:43], s75 offen lds
    s_add_u32 m0, s67, 67584
    s_add_u32 s75, s73, 24576
    buffer_load_dwordx4 v162, s[40:43], s75 offen lds
    s_add_u32 m0, s67, 68608
    s_add_u32 s75, s73, 36864
    buffer_load_dwordx4 v162, s[40:43], s75 offen lds
    s_add_u32 m0, s67, 0
    s_add_u32 s75, s72, 0
    buffer_load_dwordx4 v160, s[36:39], s75 offen lds
    s_add_u32 m0, s67, 1024
    s_add_u32 s75, s72, 655360
    buffer_load_dwordx4 v160, s[36:39], s75 offen lds
    s_add_u32 m0, s67, 2048
    s_add_u32 s75, s72, 1310720
    buffer_load_dwordx4 v160, s[36:39], s75 offen lds
    s_add_u32 m0, s67, 3072
    s_add_u32 s75, s72, 1966080
    buffer_load_dwordx4 v160, s[36:39], s75 offen lds
    s_waitcnt vmcnt(16)
    s_barrier
    s_bfe_u32 s73, s85, 0x40004
    s_add_u32 s73, s73, s71
    s_sub_u32 s75, s73, 10
    s_cselect_b32 s73, s73, s75
    s_lshl_b32 s72, s73, 7
    s_add_u32 s72, s72, s65
    s_mul_i32 s73, s73, 196608
    s_add_u32 s73, s73, s66
    s_add_u32 m0, s67, 86016
    s_add_u32 s75, s73, 0
    buffer_load_dwordx4 v161, s[40:43], s75 offen lds
    s_add_u32 m0, s67, 87040
    s_add_u32 s75, s73, 12288
    buffer_load_dwordx4 v161, s[40:43], s75 offen lds
    s_add_u32 m0, s67, 88064
    s_add_u32 s75, s73, 24576
    buffer_load_dwordx4 v162, s[40:43], s75 offen lds
    s_add_u32 m0, s67, 89088
    s_add_u32 s75, s73, 36864
    buffer_load_dwordx4 v162, s[40:43], s75 offen lds
    s_add_u32 m0, s67, 16384
    s_add_u32 s75, s72, 0
    buffer_load_dwordx4 v160, s[36:39], s75 offen lds
    s_add_u32 m0, s67, 17408
    s_add_u32 s75, s72, 655360
    buffer_load_dwordx4 v160, s[36:39], s75 offen lds
    s_add_u32 m0, s67, 18432
    s_add_u32 s75, s72, 1310720
    buffer_load_dwordx4 v160, s[36:39], s75 offen lds
    s_add_u32 m0, s67, 19456
    s_add_u32 s75, s72, 1966080
    buffer_load_dwordx4 v160, s[36:39], s75 offen lds
    s_cmp_ge_u32 s64, 2
    s_cbranch_scc1 L_hw_19
    s_waitcnt vmcnt(16)
    s_barrier
    s_add_u32 s76, s57, 0
    s_and_b32 s76, s76, 3
    s_mul_i32 s75, s76, 163840
    s_add_u32 s75, s75, s70
    s_add_u32 m0, s68, 106496
    s_nop 0
    buffer_load_dwordx4 v163, s[44:47], s75 offen lds
    s_add_u32 m0, s68, 107520
    s_nop 0
    buffer_load_dwordx4 v164, s[44:47], s75 offen lds
    s_add_u32 m0, s68, 108544
    s_nop 0
    buffer_load_dwordx4 v165, s[44:47], s75 offen lds
    s_add_u32 m0, s68, 109568
    s_nop 0
    buffer_load_dwordx4 v166, s[44:47], s75 offen lds
    s_add_u32 m0, s68, 110592
    s_nop 0
    buffer_load_dwordx4 v167, s[44:47], s75 offen lds
    s_add_u32 s75, s75, 20480
    s_add_u32 m0, s68, 111616
    s_nop 0
    buffer_load_dwordx4 v163, s[44:47], s75 offen lds
    s_add_u32 m0, s68, 112640
    s_nop 0
    buffer_load_dwordx4 v164, s[44:47], s75 offen lds
    s_add_u32 m0, s68, 113664
    s_nop 0
    buffer_load_dwordx4 v165, s[44:47], s75 offen lds
    s_add_u32 m0, s68, 114688
    s_nop 0
    buffer_load_dwordx4 v166, s[44:47], s75 offen lds
    s_add_u32 m0, s68, 115712
    s_nop 0
    buffer_load_dwordx4 v167, s[44:47], s75 offen lds
    s_waitcnt vmcnt(18)
    s_barrier
    s_add_u32 s76, s57, 0
    s_and_b32 s76, s76, 3
    s_mul_i32 s75, s76, 163840
    s_add_u32 s75, s75, s70
    s_add_u32 s75, s75, 40960
    s_add_u32 m0, s68, 126976
    s_nop 0
    buffer_load_dwordx4 v163, s[44:47], s75 offen lds
    s_add_u32 m0, s68, 128000
    s_nop 0
    buffer_load_dwordx4 v164, s[44:47], s75 offen lds
    s_add_u32 m0, s68, 129024
    s_nop 0
    buffer_load_dwordx4 v165, s[44:47], s75 offen lds
    s_add_u32 m0, s68, 130048
    s_nop 0
    buffer_load_dwordx4 v166, s[44:47], s75 offen lds
    s_add_u32 m0, s68, 131072
    s_nop 0
    buffer_load_dwordx4 v167, s[44:47], s75 offen lds
    s_add_u32 s75, s75, 20480
    s_add_u32 m0, s68, 132096
    s_nop 0
    buffer_load_dwordx4 v163, s[44:47], s75 offen lds
    s_add_u32 m0, s68, 133120
    s_nop 0
    buffer_load_dwordx4 v164, s[44:47], s75 offen lds
    s_add_u32 m0, s68, 134144
    s_nop 0
    buffer_load_dwordx4 v165, s[44:47], s75 offen lds
    s_add_u32 m0, s68, 135168
    s_nop 0
    buffer_load_dwordx4 v166, s[44:47], s75 offen lds
    s_add_u32 m0, s68, 136192
    s_nop 0
    buffer_load_dwordx4 v167, s[44:47], s75 offen lds
    s_waitcnt vmcnt(20)
    s_barrier
    s_add_u32 s76, s57, 1
    s_and_b32 s76, s76, 3
    s_mul_i32 s75, s76, 163840
    s_add_u32 s75, s75, s70
    s_add_u32 m0, s68, 65536
    s_nop 0
    buffer_load_dwordx4 v163, s[44:47], s75 offen lds
    s_add_u32 m0, s68, 66560
    s_nop 0
    buffer_load_dwordx4 v164, s[44:47], s75 offen lds
    s_add_u32 m0, s68, 67584
    s_nop 0
    buffer_load_dwordx4 v165, s[44:47], s75 offen lds
    s_add_u32 m0, s68, 68608
    s_nop 0
    buffer_load_dwordx4 v166, s[44:47], s75 offen lds
    s_add_u32 m0, s68, 69632
    s_nop 0
    buffer_load_dwordx4 v167, s[44:47], s75 offen lds
    s_add_u32 s75, s75, 20480
    s_add_u32 m0, s68, 70656
    s_nop 0
    buffer_load_dwordx4 v163, s[44:47], s75 offen lds
    s_add_u32 m0, s68, 71680
    s_nop 0
    buffer_load_dwordx4 v164, s[44:47], s75 offen lds
    s_add_u32 m0, s68, 72704
    s_nop 0
    buffer_load_dwordx4 v165, s[44:47], s75 offen lds
    s_add_u32 m0, s68, 73728
    s_nop 0
    buffer_load_dwordx4 v166, s[44:47], s75 offen lds
    s_add_u32 m0, s68, 74752
    s_nop 0
    buffer_load_dwordx4 v167, s[44:47], s75 offen lds
    s_barrier
    s_barrier
    s_waitcnt vmcnt(10)
    s_add_u32 s76, s57, 2
    s_and_b32 s76, s76, 3
    s_mul_i32 s75, s76, 163840
    s_add_u32 s75, s75, s70
    s_add_u32 m0, s68, 86016
    s_nop 0
    buffer_load_dwordx4 v163, s[44:47], s75 offen lds
    s_add_u32 m0, s68, 87040
    s_nop 0
    buffer_load_dwordx4 v164, s[44:47], s75 offen lds
    s_add_u32 m0, s68, 88064
    s_nop 0
    buffer_load_dwordx4 v165, s[44:47], s75 offen lds
    s_add_u32 m0, s68, 89088
    s_nop 0
    buffer_load_dwordx4 v166, s[44:47], s75 offen lds
    s_add_u32 m0, s68, 90112
    s_nop 0
    buffer_load_dwordx4 v167, s[44:47], s75 offen lds
    s_add_u32 s75, s75, 20480
    s_add_u32 m0, s68, 91136
    s_nop 0
    buffer_load_dwordx4 v163, s[44:47], s75 offen lds
    s_add_u32 m0, s68, 92160
    s_nop 0
    buffer_load_dwordx4 v164, s[44:47], s75 offen lds
    s_add_u32 m0, s68, 93184
    s_nop 0
    buffer_load_dwordx4 v165, s[44:47], s75 offen lds
    s_add_u32 m0, s68, 94208
    s_nop 0
    buffer_load_dwordx4 v166, s[44:47], s75 offen lds
    s_add_u32 m0, s68, 95232
    s_nop 0
    buffer_load_dwordx4 v167, s[44:47], s75 offen lds
    s_barrier
    s_barrier
    s_barrier
    s_add_u32 s76, s57, 3
    s_and_b32 s76, s76, 3
    s_mul_i32 s75, s76, 163840
    s_add_u32 s75, s75, s70
    s_add_u32 m0, s68, 106496
    s_nop 0
    buffer_load_dwordx4 v163, s[44:47], s75 offen lds
    s_add_u32 m0, s68, 107520
    s_nop 0
    buffer_load_dwordx4 v164, s[44:47], s75 offen lds
    s_add_u32 m0, s68, 108544
    s_nop 0
    buffer_load_dwordx4 v165, s[44:47], s75 offen lds
    s_add_u32 m0, s68, 109568
    s_nop 0
    buffer_load_dwordx4 v166, s[44:47], s75 offen lds
    s_add_u32 m0, s68, 110592
    s_nop 0
    buffer_load_dwordx4 v167, s[44:47], s75 offen lds
    s_add_u32 s75, s75, 20480
    s_add_u32 m0, s68, 111616
    s_nop 0
    buffer_load_dwordx4 v163, s[44:47], s75 offen lds
    s_add_u32 m0, s68, 112640
    s_nop 0
    buffer_load_dwordx4 v164, s[44:47], s75 offen lds
    s_add_u32 m0, s68, 113664
    s_nop 0
    buffer_load_dwordx4 v165, s[44:47], s75 offen lds
    s_add_u32 m0, s68, 114688
    s_nop 0
    buffer_load_dwordx4 v166, s[44:47], s75 offen lds
    s_add_u32 m0, s68, 115712
    s_nop 0
    buffer_load_dwordx4 v167, s[44:47], s75 offen lds
    s_waitcnt vmcnt(20)
    s_barrier
    s_add_u32 s76, s57, 1
    s_and_b32 s76, s76, 3
    s_mul_i32 s75, s76, 163840
    s_add_u32 s75, s75, s70
    s_add_u32 s75, s75, 40960
    s_add_u32 m0, s68, 126976
    s_nop 0
    buffer_load_dwordx4 v163, s[44:47], s75 offen lds
    s_add_u32 m0, s68, 128000
    s_nop 0
    buffer_load_dwordx4 v164, s[44:47], s75 offen lds
    s_add_u32 m0, s68, 129024
    s_nop 0
    buffer_load_dwordx4 v165, s[44:47], s75 offen lds
    s_add_u32 m0, s68, 130048
    s_nop 0
    buffer_load_dwordx4 v166, s[44:47], s75 offen lds
    s_add_u32 m0, s68, 131072
    s_nop 0
    buffer_load_dwordx4 v167, s[44:47], s75 offen lds
    s_add_u32 s75, s75, 20480
    s_add_u32 m0, s68, 132096
    s_nop 0
    buffer_load_dwordx4 v163, s[44:47], s75 offen lds
    s_add_u32 m0, s68, 133120
    s_nop 0
    buffer_load_dwordx4 v164, s[44:47], s75 offen lds
    s_add_u32 m0, s68, 134144
    s_nop 0
    buffer_load_dwordx4 v165, s[44:47], s75 offen lds
    s_add_u32 m0, s68, 135168
    s_nop 0
    buffer_load_dwordx4 v166, s[44:47], s75 offen lds
    s_add_u32 m0, s68, 136192
    s_nop 0
    buffer_load_dwordx4 v167, s[44:47], s75 offen lds
    s_waitcnt vmcnt(20)
    s_barrier
    s_add_u32 s76, s57, 2
    s_and_b32 s76, s76, 3
    s_mul_i32 s75, s76, 163840
    s_add_u32 s75, s75, s70
    s_add_u32 s75, s75, 40960
    s_add_u32 m0, s68, 65536
    s_nop 0
    buffer_load_dwordx4 v163, s[44:47], s75 offen lds
    s_add_u32 m0, s68, 66560
    s_nop 0
    buffer_load_dwordx4 v164, s[44:47], s75 offen lds
    s_add_u32 m0, s68, 67584
    s_nop 0
    buffer_load_dwordx4 v165, s[44:47], s75 offen lds
    s_add_u32 m0, s68, 68608
    s_nop 0
    buffer_load_dwordx4 v166, s[44:47], s75 offen lds
    s_add_u32 m0, s68, 69632
    s_nop 0
    buffer_load_dwordx4 v167, s[44:47], s75 offen lds
    s_add_u32 s75, s75, 20480
    s_add_u32 m0, s68, 70656
    s_nop 0
    buffer_load_dwordx4 v163, s[44:47], s75 offen lds
    s_add_u32 m0, s68, 71680
    s_nop 0
    buffer_load_dwordx4 v164, s[44:47], s75 offen lds
    s_add_u32 m0, s68, 72704
    s_nop 0
    buffer_load_dwordx4 v165, s[44:47], s75 offen lds
    s_add_u32 m0, s68, 73728
    s_nop 0
    buffer_load_dwordx4 v166, s[44:47], s75 offen lds
    s_add_u32 m0, s68, 74752
    s_nop 0
    buffer_load_dwordx4 v167, s[44:47], s75 offen lds
    s_waitcnt vmcnt(20)
    s_barrier
    s_add_u32 s76, s57, 3
    s_and_b32 s76, s76, 3
    s_mul_i32 s75, s76, 163840
    s_add_u32 s75, s75, s70
    s_add_u32 s75, s75, 40960
    s_add_u32 m0, s68, 86016
    s_nop 0
    buffer_load_dwordx4 v163, s[44:47], s75 offen lds
    s_add_u32 m0, s68, 87040
    s_nop 0
    buffer_load_dwordx4 v164, s[44:47], s75 offen lds
    s_add_u32 m0, s68, 88064
    s_nop 0
    buffer_load_dwordx4 v165, s[44:47], s75 offen lds
    s_add_u32 m0, s68, 89088
    s_nop 0
    buffer_load_dwordx4 v166, s[44:47], s75 offen lds
    s_add_u32 m0, s68, 90112
    s_nop 0
    buffer_load_dwordx4 v167, s[44:47], s75 offen lds
    s_add_u32 s75, s75, 20480
    s_add_u32 m0, s68, 91136
    s_nop 0
    buffer_load_dwordx4 v163, s[44:47], s75 offen lds
    s_add_u32 m0, s68, 92160
    s_nop 0
    buffer_load_dwordx4 v164, s[44:47], s75 offen lds
    s_add_u32 m0, s68, 93184
    s_nop 0
    buffer_load_dwordx4 v165, s[44:47], s75 offen lds
    s_add_u32 m0, s68, 94208
    s_nop 0
    buffer_load_dwordx4 v166, s[44:47], s75 offen lds
    s_add_u32 m0, s68, 95232
    s_nop 0
    buffer_load_dwordx4 v167, s[44:47], s75 offen lds
    s_waitcnt vmcnt(20)
    s_barrier
    s_and_b32 s75, s26, 3
    s_lshl_b32 s75, s75, 12
    s_add_u32 m0, s75, 147456
    s_add_u32 s75, s75, 32768
    buffer_load_dwordx4 v3, s[32:35], s75 offen lds
    buffer_load_dwordx4 v3, s[32:35], s75 offen offset:1024 lds
    buffer_load_dwordx4 v3, s[32:35], s75 offen offset:2048 lds
    buffer_load_dwordx4 v3, s[32:35], s75 offen offset:3072 lds
    s_mov_b32 s48, s18
    s_mov_b32 s49, s19
    s_mov_b32 s50, 1280
    s_mov_b32 s51, 0x20000
    v_lshlrev_b32 v246, 2, v0
    buffer_load_dwordx4 v[228:231], v3, s[36:39], s52 offen
    buffer_load_dword v244, v246, s[36:39], s52 offen offset:1024
    buffer_load_dwordx4 v[232:235], v3, s[48:51], 0 offen
    buffer_load_dword v245, v246, s[48:51], 0 offen offset:1024
    s_waitcnt vmcnt(18)
    s_barrier
    s_cmp_lg_u32 s64, 3
    s_cbranch_scc1 L_on_20
    ds_write_b128 v3, v[236:239] offset:57344
    ds_write_b128 v3, v[240:243] offset:58368
    s_waitcnt lgkmcnt(0)
L_on_20:
    s_waitcnt vmcnt(8)
    s_barrier
    s_waitcnt vmcnt(0)
    s_barrier
    ds_read_b128 v[236:239], v3 offset:57344
    ds_read_b128 v[240:243], v3 offset:58368
    s_waitcnt lgkmcnt(0)
    s_branch L_f3
L_hw_19:
    s_lshl_b32 s75, s56, 11
    s_add_u32 s75, s75, 20447232
    buffer_load_dwordx4 v[168:171], v181, s[28:31], s75 offen sc1
    s_waitcnt vmcnt(17)
    s_barrier
    s_waitcnt vmcnt(9)
    s_barrier
    s_waitcnt vmcnt(0)
    s_mov_b32 s77, 0x40000
L_chk_22:
    v_xor_b32 v4, s10, v169
    v_xor_b32 v5, s11, v171
    v_or_b32 v4, v4, v5
    v_cmp_ne_u32 vcc, 0, v4
    s_nop 0
    s_cbranch_vccz L_ok_23
    s_lshl_b32 s75, s56, 11
    s_add_u32 s75, s75, 20447232
    buffer_load_dwordx4 v[168:171], v181, s[28:31], s75 offen sc1
    s_waitcnt vmcnt(0)
    s_sub_u32 s77, s77, 1
    s_cbranch_scc0 L_chk_22
L_ok_23:
    v_mov_b32 v169, v168
    v_mov_b32 v171, v170
    ds_write_b128 v182, v[168:171]
    s_cmp_lg_u32 s64, 2
    s_cbranch_scc1 L_on_24
    v_mov_b32 v176, s10
    v_mov_b32 v177, s11
    v_mov_b32 v4, 150528
    ds_write_b128 v4, v[176:179]
L_on_24:
    s_waitcnt lgkmcnt(0)
    s_and_b32 s67, s64, 1
    s_lshl_b32 s67, s67, 13
    v_and_b32 v183, 3, v0
    v_lshlrev_b32 v183, 3, v183
    s_barrier
    s_setprio 0
    s_cmp_lg_u32 s64, 3
    s_cbranch_scc1 L_on_25
    v_lshrrev_b32 v4, 1, v1
    s_lshl_b32 s75, s61, 9
    s_add_u32 s75, s75, s60
    v_lshlrev_b32 v232, 6, v4
    v_add_u32 v232, s75, v232
    v_lshlrev_b32 v4, 2, v2
    v_mul_u32_u24 v233, v232, v4
    v_and_b32 v4, 1, v0
    v_mul_u32_u24 v4, 1536, v4
    v_add_u32 v233, v233, v4
    v_mad_u32_u24 v5, v232, 0, v233
    v_and_b32 v5, 2047, v5
    v_cvt_f32_u32 v5, v5
    v_mul_f32 v5, 0x3a000000, v5
    v_mad_u32_u24 v6, v232, 1, v233
    v_and_b32 v6, 2047, v6
    v_cvt_f32_u32 v6, v6
    v_mul_f32 v6, 0x3a000000, v6
    v_cos_f32 v228, v5
    v_cos_f32 v229, v6
    v_sin_f32 v230, v5
    v_sin_f32 v231, v6
    v_cvt_pk_bf16_f32 v236, v228, v229
    v_cvt_pk_bf16_f32 v240, -v230, -v231
    v_mad_u32_u24 v5, v232, 2, v233
    v_and_b32 v5, 2047, v5
    v_cvt_f32_u32 v5, v5
    v_mul_f32 v5, 0x3a000000, v5
    v_mad_u32_u24 v6, v232, 3, v233
    v_and_b32 v6, 2047, v6
    v_cvt_f32_u32 v6, v6
    v_mul_f32 v6, 0x3a000000, v6
    v_cos_f32 v228, v5
    v_cos_f32 v229, v6
    v_sin_f32 v230, v5
    v_sin_f32 v231, v6
    v_cvt_pk_bf16_f32 v237, v228, v229
    v_cvt_pk_bf16_f32 v241, -v230, -v231
    v_mad_u32_u24 v5, v232, 16, v233
    v_and_b32 v5, 2047, v5
    v_cvt_f32_u32 v5, v5
    v_mul_f32 v5, 0x3a000000, v5
    v_mad_u32_u24 v6, v232, 17, v233
    v_and_b32 v6, 2047, v6
    v_cvt_f32_u32 v6, v6
    v_mul_f32 v6, 0x3a000000, v6
    v_cos_f32 v228, v5
    v_cos_f32 v229, v6
    v_sin_f32 v230, v5
    v_sin_f32 v231, v6
    v_cvt_pk_bf16_f32 v238, v228, v229
    v_cvt_pk_bf16_f32 v242, -v230, -v231
    v_mad_u32_u24 v5, v232, 18, v233
    v_and_b32 v5, 2047, v5
    v_cvt_f32_u32 v5, v5
    v_mul_f32 v5, 0x3a000000, v5
    v_mad_u32_u24 v6, v232, 19, v233
    v_and_b32 v6, 2047, v6
    v_cvt_f32_u32 v6, v6
    v_mul_f32 v6, 0x3a000000, v6
    v_cos_f32 v228, v5
    v_cos_f32 v229, v6
    v_sin_f32 v230, v5
    v_sin_f32 v231, v6
    v_cvt_pk_bf16_f32 v239, v228, v229
    v_cvt_pk_bf16_f32 v243, -v230, -v231
L_on_25:
    s_setprio 3
    s_barrier
    s_barrier
    s_mov_b32 s78, 0
    s_barrier
    s_cmp_lg_u32 s64, 2
    s_cbranch_scc1 L_on_26
    s_and_b32 s75, s62, 0xfc
    s_lshl_b32 s75, s75, 7
    s_lshl_b32 s76, s57, 3
    s_add_u32 s75, s75, s76
    s_add_u32 s75, s75, 20480128
    v_mov_b32 v4, s10
    v_mov_b32 v5, s11
    v_lshlrev_b32 v6, 7, v0
    s_mov_b64 exec, 15
    buffer_store_dwordx2 v[4:5], v6, s[28:31], s75 offen sc1
    s_mov_b64 exec, -1
L_on_26:
    s_barrier
    s_load_dwordx8 s[84:91], s[24:25], s74 glc
    s_barrier
    s_cmp_lg_u32 s64, 3
    s_cbranch_scc1 L_on_29
    s_and_b32 s75, s62, 0xfc
    s_lshl_b32 s75, s75, 7
    s_lshl_b32 s76, s57, 3
    s_add_u32 s75, s75, s76
    s_add_u32 s75, s75, 20480160
    v_mov_b32 v4, s10
    v_mov_b32 v5, s11
    v_lshlrev_b32 v6, 7, v0
    s_mov_b64 exec, 15
    buffer_store_dwordx2 v[4:5], v6, s[28:31], s75 offen sc1
    s_mov_b64 exec, -1
L_on_29:
    s_waitcnt lgkmcnt(0)
    s_xor_b64 s[84:85], s[84:85], s[10:11]
    s_xor_b64 s[86:87], s[86:87], s[10:11]
    s_or_b64 s[84:85], s[84:85], s[86:87]
    s_xor_b64 s[88:89], s[88:89], s[10:11]
    s_or_b64 s[84:85], s[84:85], s[88:89]
    s_xor_b64 s[90:91], s[90:91], s[10:11]
    s_or_b64 s[84:85], s[84:85], s[90:91]
    s_cbranch_scc0 L_ha_27
    s_mov_b32 s75, 0x40000
L_sp_30:
    s_load_dwordx8 s[84:91], s[24:25], s74 glc
    s_waitcnt lgkmcnt(0)
    s_xor_b64 s[84:85], s[84:85], s[10:11]
    s_xor_b64 s[86:87], s[86:87], s[10:11]
    s_or_b64 s[84:85], s[84:85], s[86:87]
    s_xor_b64 s[88:89], s[88:89], s[10:11]
    s_or_b64 s[84:85], s[84:85], s[88:89]
    s_xor_b64 s[90:91], s[90:91], s[10:11]
    s_or_b64 s[84:85], s[84:85], s[90:91]
    s_cbranch_scc0 L_sd_31
    s_sub_u32 s75, s75, 1
    s_cbranch_scc0 L_sp_30
L_sd_31:
L_ha_27:
    s_cmp_lg_u32 s78, 0
    s_cbranch_scc1 L_hb_28
    s_add_u32 s76, s57, 1
    s_and_b32 s76, s76, 3
    s_lshl_b32 s75, s76, 15
    s_add_u32 s75, s75, s69
    s_add_u32 m0, s67, 0
    s_nop 0
    buffer_load_dwordx4 v3, s[28:31], s75 offen sc1 lds
    buffer_load_dwordx4 v3, s[28:31], s75 offen offset:1024 sc1 lds
    buffer_load_dwordx4 v3, s[28:31], s75 offen offset:2048 sc1 lds
    buffer_load_dwordx4 v3, s[28:31], s75 offen offset:3072 sc1 lds
    s_add_u32 s75, s75, 4096
    s_add_u32 m0, s67, 4096
    s_nop 0
    buffer_load_dwordx4 v3, s[28:31], s75 offen sc1 lds
    buffer_load_dwordx4 v3, s[28:31], s75 offen offset:1024 sc1 lds
    buffer_load_dwordx4 v3, s[28:31], s75 offen offset:2048 sc1 lds
    buffer_load_dwordx4 v3, s[28:31], s75 offen offset:3072 sc1 lds
    s_add_u32 s76, s57, 2
    s_and_b32 s76, s76, 3
    s_lshl_b32 s75, s76, 15
    s_add_u32 s75, s75, s69
    s_add_u32 m0, s67, 16384
    s_nop 0
    buffer_load_dwordx4 v3, s[28:31], s75 offen sc1 lds
    buffer_load_dwordx4 v3, s[28:31], s75 offen offset:1024 sc1 lds
    buffer_load_dwordx4 v3, s[28:31], s75 offen offset:2048 sc1 lds
    buffer_load_dwordx4 v3, s[28:31], s75 offen offset:3072 sc1 lds
    s_add_u32 s75, s75, 4096
    s_add_u32 m0, s67, 20480
    s_nop 0
    buffer_load_dwordx4 v3, s[28:31], s75 offen sc1 lds
    buffer_load_dwordx4 v3, s[28:31], s75 offen offset:1024 sc1 lds
    buffer_load_dwordx4 v3, s[28:31], s75 offen offset:2048 sc1 lds
    buffer_load_dwordx4 v3, s[28:31], s75 offen offset:3072 sc1 lds
L_hb_28:
    s_waitcnt vmcnt(8)
    s_barrier
    s_add_u32 s74, s74, 32
    s_load_dwordx8 s[84:91], s[24:25], s74 glc
    s_add_u32 s76, s57, 3
    s_and_b32 s76, s76, 3
    s_lshl_b32 s75, s76, 15
    s_add_u32 s75, s75, s69
    s_add_u32 m0, s67, 32768
    s_nop 0
    buffer_load_dwordx4 v3, s[28:31], s75 offen sc1 lds
    buffer_load_dwordx4 v3, s[28:31], s75 offen offset:1024 sc1 lds
    buffer_load_dwordx4 v3, s[28:31], s75 offen offset:2048 sc1 lds
    buffer_load_dwordx4 v3, s[28:31], s75 offen offset:3072 sc1 lds
    s_add_u32 s75, s75, 4096
    s_add_u32 m0, s67, 36864
    s_nop 0
    buffer_load_dwordx4 v3, s[28:31], s75 offen sc1 lds
    buffer_load_dwordx4 v3, s[28:31], s75 offen offset:1024 sc1 lds
    buffer_load_dwordx4 v3, s[28:31], s75 offen offset:2048 sc1 lds
    buffer_load_dwordx4 v3, s[28:31], s75 offen offset:3072 sc1 lds
    s_mov_b32 s78, 0
    s_waitcnt vmcnt(8)
    s_barrier
    s_waitcnt lgkmcnt(0)
    s_xor_b64 s[84:85], s[84:85], s[10:11]
    s_xor_b64 s[86:87], s[86:87], s[10:11]
    s_or_b64 s[84:85], s[84:85], s[86:87]
    s_xor_b64 s[88:89], s[88:89], s[10:11]
    s_or_b64 s[84:85], s[84:85], s[88:89]
    s_xor_b64 s[90:91], s[90:91], s[10:11]
    s_or_b64 s[84:85], s[84:85], s[90:91]
    s_cbranch_scc1 L_hc_32
    s_mov_b32 s78, 1
    s_add_u32 s76, s57, 1
    s_and_b32 s76, s76, 3
    s_lshl_b32 s75, s76, 15
    s_add_u32 s75, s75, s69
    s_add_u32 s75, s75, 16384
    s_add_u32 m0, s67, 49152
    s_nop 0
    buffer_load_dwordx4 v3, s[28:31], s75 offen sc1 lds
    buffer_load_dwordx4 v3, s[28:31], s75 offen offset:1024 sc1 lds
    buffer_load_dwordx4 v3, s[28:31], s75 offen offset:2048 sc1 lds
    buffer_load_dwordx4 v3, s[28:31], s75 offen offset:3072 sc1 lds
    s_add_u32 s75, s75, 4096
    s_add_u32 m0, s67, 53248
    s_nop 0
    buffer_load_dwordx4 v3, s[28:31], s75 offen sc1 lds
    buffer_load_dwordx4 v3, s[28:31], s75 offen offset:1024 sc1 lds
    buffer_load_dwordx4 v3, s[28:31], s75 offen offset:2048 sc1 lds
    buffer_load_dwordx4 v3, s[28:31], s75 offen offset:3072 sc1 lds
    s_add_u32 s76, s57, 2
    s_and_b32 s76, s76, 3
    s_lshl_b32 s75, s76, 15
    s_add_u32 s75, s75, s69
    s_add_u32 s75, s75, 16384
    s_add_u32 m0, s67, 0
    s_nop 0
    buffer_load_dwordx4 v3, s[28:31], s75 offen sc1 lds
    buffer_load_dwordx4 v3, s[28:31], s75 offen offset:1024 sc1 lds
    buffer_load_dwordx4 v3, s[28:31], s75 offen offset:2048 sc1 lds
    buffer_load_dwordx4 v3, s[28:31], s75 offen offset:3072 sc1 lds
    s_add_u32 s75, s75, 4096
    s_add_u32 m0, s67, 4096
    s_nop 0
    buffer_load_dwordx4 v3, s[28:31], s75 offen sc1 lds
    buffer_load_dwordx4 v3, s[28:31], s75 offen offset:1024 sc1 lds
    buffer_load_dwordx4 v3, s[28:31], s75 offen offset:2048 sc1 lds
    buffer_load_dwordx4 v3, s[28:31], s75 offen offset:3072 sc1 lds
    s_waitcnt vmcnt(16)
    s_branch L_hd_33
L_hc_32:
    s_waitcnt vmcnt(0)
    s_cmp_lg_u32 s78, 0
    s_cbranch_scc1 L_tn_34
    s_load_dwordx8 s[84:91], s[24:25], s74 glc
    s_waitcnt lgkmcnt(0)
    s_xor_b64 s[84:85], s[84:85], s[10:11]
    s_xor_b64 s[86:87], s[86:87], s[10:11]
    s_or_b64 s[84:85], s[84:85], s[86:87]
    s_xor_b64 s[88:89], s[88:89], s[10:11]
    s_or_b64 s[84:85], s[84:85], s[88:89]
    s_xor_b64 s[90:91], s[90:91], s[10:11]
    s_or_b64 s[84:85], s[84:85], s[90:91]
    s_cbranch_scc1 L_td_35
    s_mov_b32 s78, 1
    s_add_u32 s76, s57, 1
    s_and_b32 s76, s76, 3
    s_lshl_b32 s75, s76, 15
    s_add_u32 s75, s75, s69
    s_add_u32 s75, s75, 16384
    s_add_u32 m0, s67, 49152
    s_nop 0
    buffer_load_dwordx4 v3, s[28:31], s75 offen sc1 lds
    buffer_load_dwordx4 v3, s[28:31], s75 offen offset:1024 sc1 lds
    buffer_load_dwordx4 v3, s[28:31], s75 offen offset:2048 sc1 lds
    buffer_load_dwordx4 v3, s[28:31], s75 offen offset:3072 sc1 lds
    s_add_u32 s75, s75, 4096
    s_add_u32 m0, s67, 53248
    s_nop 0
    buffer_load_dwordx4 v3, s[28:31], s75 offen sc1 lds
    buffer_load_dwordx4 v3, s[28:31], s75 offen offset:1024 sc1 lds
    buffer_load_dwordx4 v3, s[28:31], s75 offen offset:2048 sc1 lds
    buffer_load_dwordx4 v3, s[28:31], s75 offen offset:3072 sc1 lds
    s_add_u32 s76, s57, 2
    s_and_b32 s76, s76, 3
    s_lshl_b32 s75, s76, 15
    s_add_u32 s75, s75, s69
    s_add_u32 s75, s75, 16384
    s_add_u32 m0, s67, 0
    s_nop 0
    buffer_load_dwordx4 v3, s[28:31], s75 offen sc1 lds
    buffer_load_dwordx4 v3, s[28:31], s75 offen offset:1024 sc1 lds
    buffer_load_dwordx4 v3, s[28:31], s75 offen offset:2048 sc1 lds
    buffer_load_dwordx4 v3, s[28:31], s75 offen offset:3072 sc1 lds
    s_add_u32 s75, s75, 4096
    s_add_u32 m0, s67, 4096
    s_nop 0
    buffer_load_dwordx4 v3, s[28:31], s75 offen sc1 lds
    buffer_load_dwordx4 v3, s[28:31], s75 offen offset:1024 sc1 lds
    buffer_load_dwordx4 v3, s[28:31], s75 offen offset:2048 sc1 lds
    buffer_load_dwordx4 v3, s[28:31], s75 offen offset:3072 sc1 lds
L_tn_34:
L_td_35:
L_hd_33:
    s_barrier
    s_cmp_lg_u32 s78, 0
    s_cbranch_scc1 L_tn_36
    s_mov_b32 s75, 0x40000
L_sp_38:
    s_load_dwordx8 s[84:91], s[24:25], s74 glc
    s_waitcnt lgkmcnt(0)
    s_xor_b64 s[84:85], s[84:85], s[10:11]
    s_xor_b64 s[86:87], s[86:87], s[10:11]
    s_or_b64 s[84:85], s[84:85], s[86:87]
    s_xor_b64 s[88:89], s[88:89], s[10:11]
    s_or_b64 s[84:85], s[84:85], s[88:89]
    s_xor_b64 s[90:91], s[90:91], s[10:11]
    s_or_b64 s[84:85], s[84:85], s[90:91]
    s_cbranch_scc0 L_sd_39
    s_sub_u32 s75, s75, 1
    s_cbranch_scc0 L_sp_38
L_sd_39:
    s_mov_b32 s78, 1
    s_add_u32 s76, s57, 1
    s_and_b32 s76, s76, 3
    s_lshl_b32 s75, s76, 15
    s_add_u32 s75, s75, s69
    s_add_u32 s75, s75, 16384
    s_add_u32 m0, s67, 49152
    s_nop 0
    buffer_load_dwordx4 v3, s[28:31], s75 offen sc1 lds
    buffer_load_dwordx4 v3, s[28:31], s75 offen offset:1024 sc1 lds
    buffer_load_dwordx4 v3, s[28:31], s75 offen offset:2048 sc1 lds
    buffer_load_dwordx4 v3, s[28:31], s75 offen offset:3072 sc1 lds
    s_add_u32 s75, s75, 4096
    s_add_u32 m0, s67, 53248
    s_nop 0
    buffer_load_dwordx4 v3, s[28:31], s75 offen sc1 lds
    buffer_load_dwordx4 v3, s[28:31], s75 offen offset:1024 sc1 lds
    buffer_load_dwordx4 v3, s[28:31], s75 offen offset:2048 sc1 lds
    buffer_load_dwordx4 v3, s[28:31], s75 offen offset:3072 sc1 lds
    s_add_u32 s76, s57, 2
    s_and_b32 s76, s76, 3
    s_lshl_b32 s75, s76, 15
    s_add_u32 s75, s75, s69
    s_add_u32 s75, s75, 16384
    s_add_u32 m0, s67, 0
    s_nop 0
    buffer_load_dwordx4 v3, s[28:31], s75 offen sc1 lds
    buffer_load_dwordx4 v3, s[28:31], s75 offen offset:1024 sc1 lds
    buffer_load_dwordx4 v3, s[28:31], s75 offen offset:2048 sc1 lds
    buffer_load_dwordx4 v3, s[28:31], s75 offen offset:3072 sc1 lds
    s_add_u32 s75, s75, 4096
    s_add_u32 m0, s67, 4096
    s_nop 0
    buffer_load_dwordx4 v3, s[28:31], s75 offen sc1 lds
    buffer_load_dwordx4 v3, s[28:31], s75 offen offset:1024 sc1 lds
    buffer_load_dwordx4 v3, s[28:31], s75 offen offset:2048 sc1 lds
    buffer_load_dwordx4 v3, s[28:31], s75 offen offset:3072 sc1 lds
L_tn_36:
    s_add_u32 s76, s57, 3
    s_and_b32 s76, s76, 3
    s_lshl_b32 s75, s76, 15
    s_add_u32 s75, s75, s69
    s_add_u32 s75, s75, 16384
    s_add_u32 m0, s67, 16384
    s_nop 0
    buffer_load_dwordx4 v3, s[28:31], s75 offen sc1 lds
    buffer_load_dwordx4 v3, s[28:31], s75 offen offset:1024 sc1 lds
    buffer_load_dwordx4 v3, s[28:31], s75 offen offset:2048 sc1 lds
    buffer_load_dwordx4 v3, s[28:31], s75 offen offset:3072 sc1 lds
    s_add_u32 s75, s75, 4096
    s_add_u32 m0, s67, 20480
    s_nop 0
    buffer_load_dwordx4 v3, s[28:31], s75 offen sc1 lds
    buffer_load_dwordx4 v3, s[28:31], s75 offen offset:1024 sc1 lds
    buffer_load_dwordx4 v3, s[28:31], s75 offen offset:2048 sc1 lds
    buffer_load_dwordx4 v3, s[28:31], s75 offen offset:3072 sc1 lds
L_td_37:
    s_waitcnt vmcnt(16)
    s_barrier
    s_and_b32 s75, s26, 3
    s_lshl_b32 s75, s75, 12
    s_add_u32 m0, s75, 147456
    s_add_u32 s75, s75, 32768
    buffer_load_dwordx4 v3, s[32:35], s75 offen lds
    buffer_load_dwordx4 v3, s[32:35], s75 offen offset:1024 lds
    buffer_load_dwordx4 v3, s[32:35], s75 offen offset:2048 lds
    buffer_load_dwordx4 v3, s[32:35], s75 offen offset:3072 lds
    s_mov_b32 s48, s18
    s_mov_b32 s49, s19
    s_mov_b32 s50, 1280
    s_mov_b32 s51, 0x20000
    v_lshlrev_b32 v246, 2, v0
    buffer_load_dwordx4 v[228:231], v3, s[36:39], s52 offen
    buffer_load_dword v244, v246, s[36:39], s52 offen offset:1024
    buffer_load_dwordx4 v[232:235], v3, s[48:51], 0 offen
    buffer_load_dword v245, v246, s[48:51], 0 offen offset:1024
    s_waitcnt vmcnt(16)
    s_barrier
    s_cmp_lg_u32 s64, 3
    s_cbranch_scc1 L_on_40
    ds_write_b128 v3, v[236:239] offset:57344
    ds_write_b128 v3, v[240:243] offset:58368
    s_waitcnt lgkmcnt(0)
L_on_40:
    s_waitcnt vmcnt(8)
    s_barrier
    s_waitcnt vmcnt(0)
    s_barrier
    ds_read_b128 v[236:239], v3 offset:57344
    ds_read_b128 v[240:243], v3 offset:58368
    s_waitcnt lgkmcnt(0)
    s_branch L_f3
L_comp:
    s_mov_b32 s23, 1
    s_and_b32 s64, s26, 1
    s_lshr_b32 s65, s26, 1
    s_lshl_b32 s70, s58, 2
    s_add_u32 s70, s70, s57
    s_mov_b32 s44, s14
    s_mov_b32 s45, s15
    s_mov_b32 s46, 3072
    s_mov_b32 s47, 0x20000
    s_lshl_b32 s73, s70, 8
    s_lshl_b32 s74, s65, 7
    s_add_u32 s73, s73, s74
    s_lshl_b32 s74, s64, 6
    v_lshl_add_u32 v4, v2, 3, s74
    v_xor_b32 v5, 64, v4
    buffer_load_dwordx2 v[160:161], v4, s[44:47], s73 offen offset:0
    buffer_load_dwordx2 v[162:163], v4, s[44:47], s73 offen offset:32
    buffer_load_dwordx2 v[164:165], v5, s[44:47], s73 offen offset:0
    buffer_load_dwordx2 v[166:167], v5, s[44:47], s73 offen offset:32
    v_and_b32 v4, 7, v0
    v_xor_b32 v4, v4, v2
    v_lshlrev_b32 v4, 4, v4
    v_lshl_add_u32 v4, v1, 7, v4
    s_lshl_b32 s73, s64, 13
    v_add_u32 v174, s73, v4
    v_xor_b32 v175, 64, v174
    v_lshrrev_b32 v6, 2, v1
    v_and_b32 v7, 3, v0
    v_lshl_add_u32 v4, v2, 3, v6
    v_lshlrev_b32 v4, 8, v4
    v_lshl_add_u32 v4, v7, 3, v4
    v_add_u32 v4, 65536, v4
    v_and_b32 v5, 1, v2
    v_lshl_or_b32 v5, v5, 2, v6
    s_lshl_b32 s73, s26, 1
    v_xor_b32 v5, s73, v5
    v_xor_b32 v176, 0, v5
    v_lshl_add_u32 v176, v176, 5, v4
    v_xor_b32 v177, 1, v5
    v_lshl_add_u32 v177, v177, 5, v4
    v_xor_b32 v178, 2, v5
    v_lshl_add_u32 v178, v178, 5, v4
    v_xor_b32 v179, 3, v5
    v_lshl_add_u32 v179, v179, 5, v4
    s_lshl_b32 s73, s64, 12
    s_add_u32 s73, s73, 32768
    v_add_u32 v180, s73, v3
    v_lshrrev_b32 v6, 2, v0
    v_mul_u32_u24 v4, 320, v6
    v_lshl_add_u32 v4, v7, 3, v4
    v_add_u32 v4, 106496, v4
    v_and_b32 v5, 1, v2
    s_mul_i32 s73, s65, 5
    v_xor_b32 v181, s73, v5
    v_lshl_add_u32 v181, v181, 5, v4
    s_add_u32 s73, s73, 1
    v_xor_b32 v182, s73, v5
    v_lshl_add_u32 v182, v182, 5, v4
    s_lshl_b32 s73, s26, 8
    s_add_u32 s73, s73, 149504
    v_lshl_add_u32 v183, v2, 4, s73
    v_xor_b32 v184, 256, v183
    s_lshl_b32 s73, s64, 10
    s_add_u32 s73, s73, 147456
    v_lshl_add_u32 v185, v1, 4, s73
    v_mov_b32 v187, 150528
    v_mov_b32 v168, 0xc0135761
    v_mov_b32 v170, 0xbdd2d3e8
    v_mov_b32 v172, 1.0
    v_mov_b32 v169, 0xc0135761
    v_mov_b32 v171, 0xbdd2d3e8
    v_mov_b32 v173, 1.0
    s_mul_i32 s71, s56, 12
    s_add_u32 s71, s71, s70
    s_lshl_b32 s71, s71, 15
    s_lshl_b32 s73, s65, 13
    s_mul_i32 s74, s64, 20480
    s_add_u32 s73, s73, s74
    s_add_u32 s71, s71, s73
    s_add_u32 s73, s73, 32768
    v_add_u32 v186, s73, v3
    v_xor_b32 v188, 16384, v186
    s_mul_i32 s73, s64, 11264
    s_lshl_b32 s74, s65, 16
    s_add_u32 s73, s73, s74
    v_mul_u32_u24 v189, 176, v1
    v_lshl_add_u32 v189, v2, 3, v189
    v_add_u32 v189, s73, v189
    v_add_u32 v6, 0, v0
    v_mul_u32_u24 v4, 26215, v6
    v_lshrrev_b32 v4, 18, v4
    v_mul_u32_u24 v5, 10, v4
    v_sub_u32 v5, v6, v5
    v_mul_u32_u24 v4, 176, v4
    v_lshl_add_u32 v4, v5, 4, v4
    v_add_u32 v190, s73, v4
    v_add_u32 v6, 64, v0
    v_mul_u32_u24 v4, 26215, v6
    v_lshrrev_b32 v4, 18, v4
    v_mul_u32_u24 v5, 10, v4
    v_sub_u32 v5, v6, v5
    v_mul_u32_u24 v4, 176, v4
    v_lshl_add_u32 v4, v5, 4, v4
    v_add_u32 v191, s73, v4
    v_add_u32 v6, 128, v0
    v_mul_u32_u24 v4, 26215, v6
    v_lshrrev_b32 v4, 18, v4
    v_mul_u32_u24 v5, 10, v4
    v_sub_u32 v5, v6, v5
    v_mul_u32_u24 v4, 176, v4
    v_lshl_add_u32 v4, v5, 4, v4
    v_add_u32 v192, s73, v4
    v_add_u32 v6, 192, v0
    v_mul_u32_u24 v4, 26215, v6
    v_lshrrev_b32 v4, 18, v4
    v_mul_u32_u24 v5, 10, v4
    v_sub_u32 v5, v6, v5
    v_mul_u32_u24 v4, 176, v4
    v_lshl_add_u32 v4, v5, 4, v4
    v_add_u32 v193, s73, v4
    v_add_u32 v6, 256, v0
    v_mul_u32_u24 v4, 26215, v6
    v_lshrrev_b32 v4, 18, v4
    v_mul_u32_u24 v5, 10, v4
    v_sub_u32 v5, v6, v5
    v_mul_u32_u24 v4, 176, v4
    v_lshl_add_u32 v4, v5, 4, v4
    v_add_u32 v194, s73, v4
    s_mul_i32 s72, s58, 2621440
    s_lshl_b32 s73, s57, 1
    s_add_u32 s73, s73, s65
    s_mul_i32 s73, s73, 327680
    s_add_u32 s72, s72, s73
    s_lshl_b32 s73, s56, 1
    s_add_u32 s73, s73, s64
    s_mul_i32 s73, s73, 10240
    s_add_u32 s72, s72, s73
    s_add_u32 s72, s72, 12582912
    s_lshl_b32 s62, s56, 1
    s_add_u32 s62, s62, s64
    s_lshl_b32 s62, s62, 7
    s_add_u32 s62, s62, s70
    s_lshl_b32 s62, s62, 1
    s_add_u32 s62, s62, s65
    s_lshl_b32 s62, s62, 3
    s_add_u32 s62, s62, 20637824
    s_mov_b32 s68, 1
    s_mov_b32 s66, 16384
    s_mov_b32 s67, 20480
    s_barrier
    ds_read_b64_tr_b16 v[120:121], v176 offset:0
    ds_read_b64_tr_b16 v[122:123], v176 offset:1024
    ds_read_b128 v[88:91], v174 offset:0
    ds_read_b128 v[92:95], v174 offset:2048
    ds_read_b128 v[96:99], v174 offset:4096
    ds_read_b128 v[100:103], v174 offset:6144
    ds_read_b64_tr_b16 v[124:125], v177 offset:0
    ds_read_b64_tr_b16 v[126:127], v177 offset:1024
    ds_read_b64_tr_b16 v[128:129], v178 offset:0
    ds_read_b64_tr_b16 v[130:131], v178 offset:1024
    ds_read_b64_tr_b16 v[132:133], v179 offset:0
    ds_read_b64_tr_b16 v[134:135], v179 offset:1024
    v_mov_b32 v136, 0x3f803f80
    v_mov_b32 v137, 0x3f803f80
    v_mov_b32 v138, 0x3f803f80
    v_mov_b32 v139, 0x3f803f80
    s_waitcnt lgkmcnt(6)
    v_mfma_f32_16x16x32_bf16 v[8:11], v[120:123], v[88:91], 0
    v_mfma_f32_16x16x32_bf16 v[12:15], v[120:123], v[92:95], 0
    v_mfma_f32_16x16x32_bf16 v[16:19], v[120:123], v[96:99], 0
    v_mfma_f32_16x16x32_bf16 v[20:23], v[120:123], v[100:103], 0
    s_waitcnt lgkmcnt(0)
    v_mfma_f32_16x16x32_bf16 v[72:75], v[120:123], v[136:139], 0
    ds_read_b64_tr_b16 v[140:141], v176 offset:8192
    v_mfma_f32_16x16x32_bf16 v[76:79], v[124:127], v[136:139], 0
    ds_read_b64_tr_b16 v[142:143], v176 offset:9216
    v_mfma_f32_16x16x32_bf16 v[24:27], v[124:127], v[88:91], 0
    ds_read_b128 v[104:107], v175 offset:0
    v_mfma_f32_16x16x32_bf16 v[28:31], v[124:127], v[92:95], 0
    ds_read_b128 v[108:111], v175 offset:2048
    v_mfma_f32_16x16x32_bf16 v[32:35], v[124:127], v[96:99], 0
    ds_read_b128 v[112:115], v175 offset:4096
    v_mfma_f32_16x16x32_bf16 v[36:39], v[124:127], v[100:103], 0
    ds_read_b128 v[116:119], v175 offset:6144
    v_mfma_f32_16x16x32_bf16 v[40:43], v[128:131], v[88:91], 0
    ds_read_b64_tr_b16 v[144:145], v177 offset:8192
    v_mfma_f32_16x16x32_bf16 v[44:47], v[128:131], v[92:95], 0
    ds_read_b64_tr_b16 v[146:147], v177 offset:9216
    v_mfma_f32_16x16x32_bf16 v[48:51], v[128:131], v[96:99], 0
    ds_read_b64_tr_b16 v[148:149], v178 offset:8192
    v_mfma_f32_16x16x32_bf16 v[52:55], v[128:131], v[100:103], 0
    ds_read_b64_tr_b16 v[150:151], v178 offset:9216
    v_mfma_f32_16x16x32_bf16 v[56:59], v[132:135], v[88:91], 0
    ds_read_b64_tr_b16 v[152:153], v179 offset:8192
    v_mfma_f32_16x16x32_bf16 v[60:63], v[132:135], v[92:95], 0
    ds_read_b64_tr_b16 v[154:155], v179 offset:9216
    v_mfma_f32_16x16x32_bf16 v[64:67], v[132:135], v[96:99], 0
    v_mfma_f32_16x16x32_bf16 v[68:71], v[132:135], v[100:103], 0
    s_branch L_gm_44
L_gl_42:
    s_waitcnt lgkmcnt(6)
    v_mfma_f32_16x16x32_bf16 v[8:11], v[120:123], v[88:91], v[8:11]
    s_add_u32 s68, s68, 1
    s_and_b32 s73, s68, 3
    v_mfma_f32_16x16x32_bf16 v[12:15], v[120:123], v[92:95], v[12:15]
    s_cselect_b32 s73, 1, -3
    s_lshl_b32 s66, s73, 14
    v_mfma_f32_16x16x32_bf16 v[16:19], v[120:123], v[96:99], v[16:19]
    s_mul_i32 s67, s73, 20480
    v_mfma_f32_16x16x32_bf16 v[20:23], v[120:123], v[100:103], v[20:23]
    s_waitcnt lgkmcnt(0)
    v_mfma_f32_16x16x32_bf16 v[72:75], v[120:123], v[136:139], v[72:75]
    ds_read_b64_tr_b16 v[140:141], v176 offset:8192
    v_mfma_f32_16x16x32_bf16 v[76:79], v[124:127], v[136:139], v[76:79]
    ds_read_b64_tr_b16 v[142:143], v176 offset:9216
    v_mfma_f32_16x16x32_bf16 v[24:27], v[124:127], v[88:91], v[24:27]
    ds_read_b128 v[104:107], v175 offset:0
    v_mfma_f32_16x16x32_bf16 v[28:31], v[124:127], v[92:95], v[28:31]
    ds_read_b128 v[108:111], v175 offset:2048
    v_mfma_f32_16x16x32_bf16 v[32:35], v[124:127], v[96:99], v[32:35]
    ds_read_b128 v[112:115], v175 offset:4096
    v_mfma_f32_16x16x32_bf16 v[36:39], v[124:127], v[100:103], v[36:39]
    ds_read_b128 v[116:119], v175 offset:6144
    v_mfma_f32_16x16x32_bf16 v[40:43], v[128:131], v[88:91], v[40:43]
    ds_read_b64_tr_b16 v[144:145], v177 offset:8192
    v_mfma_f32_16x16x32_bf16 v[44:47], v[128:131], v[92:95], v[44:47]
    ds_read_b64_tr_b16 v[146:147], v177 offset:9216
    v_mfma_f32_16x16x32_bf16 v[48:51], v[128:131], v[96:99], v[48:51]
    ds_read_b64_tr_b16 v[148:149], v178 offset:8192
    v_mfma_f32_16x16x32_bf16 v[52:55], v[128:131], v[100:103], v[52:55]
    ds_read_b64_tr_b16 v[150:151], v178 offset:9216
    v_mfma_f32_16x16x32_bf16 v[56:59], v[132:135], v[88:91], v[56:59]
    ds_read_b64_tr_b16 v[152:153], v179 offset:8192
    v_mfma_f32_16x16x32_bf16 v[60:63], v[132:135], v[92:95], v[60:63]
    ds_read_b64_tr_b16 v[154:155], v179 offset:9216
    v_mfma_f32_16x16x32_bf16 v[64:67], v[132:135], v[96:99], v[64:67]
    v_mfma_f32_16x16x32_bf16 v[68:71], v[132:135], v[100:103], v[68:71]
L_gm_44:
    s_waitcnt lgkmcnt(6)
    v_mfma_f32_16x16x32_bf16 v[8:11], v[140:143], v[104:107], v[8:11]
    v_add_u32 v174, s66, v174
    v_add_u32 v175, s66, v175
    v_mfma_f32_16x16x32_bf16 v[12:15], v[140:143], v[108:111], v[12:15]
    v_add_u32 v176, s67, v176
    v_add_u32 v177, s67, v177
    v_mfma_f32_16x16x32_bf16 v[16:19], v[140:143], v[112:115], v[16:19]
    v_add_u32 v178, s67, v178
    v_add_u32 v179, s67, v179
    s_cmp_eq_u32 s68, 10
    s_waitcnt lgkmcnt(0)
    v_mfma_f32_16x16x32_bf16 v[20:23], v[140:143], v[116:119], v[20:23]
    s_barrier
    s_cbranch_scc1 L_gx_43
    v_mfma_f32_16x16x32_bf16 v[72:75], v[140:143], v[136:139], v[72:75]
    ds_read_b64_tr_b16 v[120:121], v176 offset:0
    v_mfma_f32_16x16x32_bf16 v[76:79], v[144:147], v[136:139], v[76:79]
    ds_read_b64_tr_b16 v[122:123], v176 offset:1024
    v_mfma_f32_16x16x32_bf16 v[24:27], v[144:147], v[104:107], v[24:27]
    ds_read_b128 v[88:91], v174 offset:0
    v_mfma_f32_16x16x32_bf16 v[28:31], v[144:147], v[108:111], v[28:31]
    ds_read_b128 v[92:95], v174 offset:2048
    v_mfma_f32_16x16x32_bf16 v[32:35], v[144:147], v[112:115], v[32:35]
    ds_read_b128 v[96:99], v174 offset:4096
    v_mfma_f32_16x16x32_bf16 v[36:39], v[144:147], v[116:119], v[36:39]
    ds_read_b128 v[100:103], v174 offset:6144
    v_mfma_f32_16x16x32_bf16 v[40:43], v[148:151], v[104:107], v[40:43]
    ds_read_b64_tr_b16 v[124:125], v177 offset:0
    v_mfma_f32_16x16x32_bf16 v[44:47], v[148:151], v[108:111], v[44:47]
    ds_read_b64_tr_b16 v[126:127], v177 offset:1024
    v_mfma_f32_16x16x32_bf16 v[48:51], v[148:151], v[112:115], v[48:51]
    ds_read_b64_tr_b16 v[128:129], v178 offset:0
    v_mfma_f32_16x16x32_bf16 v[52:55], v[148:151], v[116:119], v[52:55]
    ds_read_b64_tr_b16 v[130:131], v178 offset:1024
    v_mfma_f32_16x16x32_bf16 v[56:59], v[152:155], v[104:107], v[56:59]
    ds_read_b64_tr_b16 v[132:133], v179 offset:0
    v_mfma_f32_16x16x32_bf16 v[60:63], v[152:155], v[108:111], v[60:63]
    ds_read_b64_tr_b16 v[134:135], v179 offset:1024
    v_mfma_f32_16x16x32_bf16 v[64:67], v[152:155], v[112:115], v[64:67]
    v_mfma_f32_16x16x32_bf16 v[68:71], v[152:155], v[116:119], v[68:71]
    s_branch L_gl_42
L_gx_43:
    v_mfma_f32_16x16x32_bf16 v[72:75], v[140:143], v[136:139], v[72:75]
    ds_read_b128 v[88:91], v185 offset:0
    v_mfma_f32_16x16x32_bf16 v[76:79], v[144:147], v[136:139], v[76:79]
    ds_read_b128 v[92:95], v185 offset:256
    v_mfma_f32_16x16x32_bf16 v[24:27], v[144:147], v[104:107], v[24:27]
    ds_read_b128 v[96:99], v185 offset:512
    v_mfma_f32_16x16x32_bf16 v[28:31], v[144:147], v[108:111], v[28:31]
    ds_read_b128 v[100:103], v185 offset:768
    v_mfma_f32_16x16x32_bf16 v[32:35], v[144:147], v[112:115], v[32:35]
    ds_read_b128 v[156:159], v187
    v_mfma_f32_16x16x32_bf16 v[36:39], v[144:147], v[116:119], v[36:39]
    s_waitcnt vmcnt(0)
    v_mfma_f32_16x16x32_bf16 v[40:43], v[148:151], v[104:107], v[40:43]
    ds_write_b128 v183, v[72:75] offset:0
    v_mfma_f32_16x16x32_bf16 v[44:47], v[148:151], v[108:111], v[44:47]
    ds_write_b128 v183, v[76:79] offset:64
    s_waitcnt lgkmcnt(0)
    s_barrier
    v_mfma_f32_16x16x32_bf16 v[48:51], v[148:151], v[112:115], v[48:51]
    ds_read_b128 v[80:83], v184 offset:0
    ds_read_b128 v[84:87], v184 offset:64
    v_lshlrev_b32 v120, 16, v160
    v_mfma_f32_16x16x32_bf16 v[52:55], v[148:151], v[116:119], v[52:55]
    v_and_b32 v121, 0xffff0000, v160
    v_lshlrev_b32 v122, 16, v161
    v_and_b32 v123, 0xffff0000, v161
    v_mfma_f32_16x16x32_bf16 v[56:59], v[152:155], v[104:107], v[56:59]
    v_lshlrev_b32 v124, 16, v162
    v_and_b32 v125, 0xffff0000, v162
    v_lshlrev_b32 v126, 16, v163
    v_mfma_f32_16x16x32_bf16 v[60:63], v[152:155], v[108:111], v[60:63]
    v_and_b32 v127, 0xffff0000, v163
    v_lshlrev_b32 v128, 16, v164
    v_and_b32 v129, 0xffff0000, v164
    v_mfma_f32_16x16x32_bf16 v[64:67], v[152:155], v[112:115], v[64:67]
    v_lshlrev_b32 v130, 16, v165
    v_and_b32 v131, 0xffff0000, v165
    v_lshlrev_b32 v132, 16, v166
    v_mfma_f32_16x16x32_bf16 v[68:71], v[152:155], v[116:119], v[68:71]
    v_and_b32 v133, 0xffff0000, v166
    v_lshlrev_b32 v134, 16, v167
    v_and_b32 v135, 0xffff0000, v167
    v_readfirstlane_b32 s10, v156
    v_readfirstlane_b32 s11, v157
    s_waitcnt lgkmcnt(0)
    s_xor_b32 s73, s71, 16384
    s_cmp_lg_u32 s64, 0
    s_cbranch_scc1 L_e1_46
L_e0_45:
    v_pk_fma_f32 v[104:105], v[72:73], v[90:91], v[120:121]
    v_pk_fma_f32 v[106:107], v[74:75], v[90:91], v[122:123]
    v_pk_fma_f32 v[108:109], v[76:77], v[90:91], v[124:125]
    v_pk_fma_f32 v[110:111], v[78:79], v[90:91], v[126:127]
    v_pk_fma_f32 v[112:113], v[72:73], v[94:95], v[120:121]
    v_pk_fma_f32 v[114:115], v[74:75], v[94:95], v[122:123]
    v_pk_fma_f32 v[116:117], v[76:77], v[94:95], v[124:125]
    v_pk_fma_f32 v[118:119], v[78:79], v[94:95], v[126:127]
    v_pk_fma_f32 v[8:9], v[8:9], v[88:89], v[104:105]
    v_pk_fma_f32 v[10:11], v[10:11], v[88:89], v[106:107]
    v_pk_fma_f32 v[24:25], v[24:25], v[88:89], v[108:109]
    v_pk_fma_f32 v[26:27], v[26:27], v[88:89], v[110:111]
    v_pk_fma_f32 v[12:13], v[12:13], v[92:93], v[112:113]
    v_pk_fma_f32 v[14:15], v[14:15], v[92:93], v[114:115]
    v_pk_fma_f32 v[28:29], v[28:29], v[92:93], v[116:117]
    v_pk_fma_f32 v[30:31], v[30:31], v[92:93], v[118:119]
    v_pk_mul_f32 v[104:105], v[8:9], v[8:9]
    v_pk_mul_f32 v[106:107], v[10:11], v[10:11]
    v_pk_mul_f32 v[108:109], v[24:25], v[24:25]
    v_pk_mul_f32 v[110:111], v[26:27], v[26:27]
    v_pk_mul_f32 v[112:113], v[12:13], v[12:13]
    v_pk_mul_f32 v[114:115], v[14:15], v[14:15]
    v_pk_mul_f32 v[116:117], v[28:29], v[28:29]
    v_pk_mul_f32 v[118:119], v[30:31], v[30:31]
    v_pk_fma_f32 v[104:105], v[104:105], v[170:171], v[168:169]
    v_pk_fma_f32 v[106:107], v[106:107], v[170:171], v[168:169]
    v_pk_fma_f32 v[108:109], v[108:109], v[170:171], v[168:169]
    v_pk_fma_f32 v[110:111], v[110:111], v[170:171], v[168:169]
    v_pk_fma_f32 v[112:113], v[112:113], v[170:171], v[168:169]
    v_pk_fma_f32 v[114:115], v[114:115], v[170:171], v[168:169]
    v_pk_fma_f32 v[116:117], v[116:117], v[170:171], v[168:169]
    v_pk_fma_f32 v[118:119], v[118:119], v[170:171], v[168:169]
    v_pk_mul_f32 v[140:141], v[8:9], v[104:105]
    v_pk_mul_f32 v[142:143], v[10:11], v[106:107]
    v_pk_mul_f32 v[144:145], v[24:25], v[108:109]
    v_pk_mul_f32 v[146:147], v[26:27], v[110:111]
    v_pk_mul_f32 v[148:149], v[12:13], v[112:113]
    v_pk_mul_f32 v[150:151], v[14:15], v[114:115]
    v_pk_mul_f32 v[152:153], v[28:29], v[116:117]
    v_pk_mul_f32 v[154:155], v[30:31], v[118:119]
    v_exp_f32 v140, v140
    v_exp_f32 v141, v141
    v_exp_f32 v142, v142
    v_exp_f32 v143, v143
    v_exp_f32 v144, v144
    v_exp_f32 v145, v145
    v_exp_f32 v146, v146
    v_exp_f32 v147, v147
    v_exp_f32 v148, v148
    v_exp_f32 v149, v149
    v_exp_f32 v150, v150
    v_exp_f32 v151, v151
    v_exp_f32 v152, v152
    v_exp_f32 v153, v153
    v_exp_f32 v154, v154
    v_exp_f32 v155, v155
    v_pk_add_f32 v[140:141], v[140:141], v[172:173]
    v_pk_add_f32 v[142:143], v[142:143], v[172:173]
    v_pk_add_f32 v[144:145], v[144:145], v[172:173]
    v_pk_add_f32 v[146:147], v[146:147], v[172:173]
    v_pk_add_f32 v[148:149], v[148:149], v[172:173]
    v_pk_add_f32 v[150:151], v[150:151], v[172:173]
    v_pk_add_f32 v[152:153], v[152:153], v[172:173]
    v_pk_add_f32 v[154:155], v[154:155], v[172:173]
    v_rcp_f32 v140, v140
    v_rcp_f32 v141, v141
    v_rcp_f32 v142, v142
    v_rcp_f32 v143, v143
    v_rcp_f32 v144, v144
    v_rcp_f32 v145, v145
    v_rcp_f32 v146, v146
    v_rcp_f32 v147, v147
    v_rcp_f32 v148, v148
    v_rcp_f32 v149, v149
    v_rcp_f32 v150, v150
    v_rcp_f32 v151, v151
    v_rcp_f32 v152, v152
    v_rcp_f32 v153, v153
    v_rcp_f32 v154, v154
    v_rcp_f32 v155, v155
    v_pk_mul_f32 v[8:9], v[8:9], v[140:141]
    v_pk_mul_f32 v[10:11], v[10:11], v[142:143]
    v_pk_mul_f32 v[24:25], v[24:25], v[144:145]
    v_pk_mul_f32 v[26:27], v[26:27], v[146:147]
    v_pk_mul_f32 v[12:13], v[12:13], v[148:149]
    v_pk_mul_f32 v[14:15], v[14:15], v[150:151]
    v_pk_mul_f32 v[28:29], v[28:29], v[152:153]
    v_pk_mul_f32 v[30:31], v[30:31], v[154:155]
    v_cvt_pk_bf16_f32 v8, v8, v9
    v_cvt_pk_bf16_f32 v9, v10, v11
    v_cvt_pk_bf16_f32 v10, v24, v25
    v_cvt_pk_bf16_f32 v11, v26, v27
    v_cvt_pk_bf16_f32 v12, v12, v13
    v_cvt_pk_bf16_f32 v13, v14, v15
    v_cvt_pk_bf16_f32 v14, v28, v29
    v_cvt_pk_bf16_f32 v15, v30, v31
    buffer_store_dwordx4 v[8:11], v3, s[28:31], s71 offen offset:0 sc1
    ds_write_b128 v186, v[8:11] offset:0
    buffer_store_dwordx4 v[12:15], v3, s[28:31], s71 offen offset:1024 sc1
    ds_write_b128 v186, v[12:15] offset:1024
    s_cmp_eq_u32 s64, 0
    s_cbranch_scc1 L_ha_48
    s_waitcnt vmcnt(2)
    s_barrier
L_ha_48:
    v_pk_fma_f32 v[104:105], v[72:73], v[98:99], v[120:121]
    v_pk_fma_f32 v[106:107], v[74:75], v[98:99], v[122:123]
    v_pk_fma_f32 v[108:109], v[76:77], v[98:99], v[124:125]
    v_pk_fma_f32 v[110:111], v[78:79], v[98:99], v[126:127]
    v_pk_fma_f32 v[112:113], v[72:73], v[102:103], v[120:121]
    v_pk_fma_f32 v[114:115], v[74:75], v[102:103], v[122:123]
    v_pk_fma_f32 v[116:117], v[76:77], v[102:103], v[124:125]
    v_pk_fma_f32 v[118:119], v[78:79], v[102:103], v[126:127]
    v_pk_fma_f32 v[16:17], v[16:17], v[96:97], v[104:105]
    v_pk_fma_f32 v[18:19], v[18:19], v[96:97], v[106:107]
    v_pk_fma_f32 v[32:33], v[32:33], v[96:97], v[108:109]
    v_pk_fma_f32 v[34:35], v[34:35], v[96:97], v[110:111]
    v_pk_fma_f32 v[20:21], v[20:21], v[100:101], v[112:113]
    v_pk_fma_f32 v[22:23], v[22:23], v[100:101], v[114:115]
    v_pk_fma_f32 v[36:37], v[36:37], v[100:101], v[116:117]
    v_pk_fma_f32 v[38:39], v[38:39], v[100:101], v[118:119]
    v_pk_mul_f32 v[104:105], v[16:17], v[16:17]
    v_pk_mul_f32 v[106:107], v[18:19], v[18:19]
    v_pk_mul_f32 v[108:109], v[32:33], v[32:33]
    v_pk_mul_f32 v[110:111], v[34:35], v[34:35]
    v_pk_mul_f32 v[112:113], v[20:21], v[20:21]
    v_pk_mul_f32 v[114:115], v[22:23], v[22:23]
    v_pk_mul_f32 v[116:117], v[36:37], v[36:37]
    v_pk_mul_f32 v[118:119], v[38:39], v[38:39]
    v_pk_fma_f32 v[104:105], v[104:105], v[170:171], v[168:169]
    v_pk_fma_f32 v[106:107], v[106:107], v[170:171], v[168:169]
    v_pk_fma_f32 v[108:109], v[108:109], v[170:171], v[168:169]
    v_pk_fma_f32 v[110:111], v[110:111], v[170:171], v[168:169]
    v_pk_fma_f32 v[112:113], v[112:113], v[170:171], v[168:169]
    v_pk_fma_f32 v[114:115], v[114:115], v[170:171], v[168:169]
    v_pk_fma_f32 v[116:117], v[116:117], v[170:171], v[168:169]
    v_pk_fma_f32 v[118:119], v[118:119], v[170:171], v[168:169]
    v_pk_mul_f32 v[140:141], v[16:17], v[104:105]
    v_pk_mul_f32 v[142:143], v[18:19], v[106:107]
    v_pk_mul_f32 v[144:145], v[32:33], v[108:109]
    v_pk_mul_f32 v[146:147], v[34:35], v[110:111]
    v_pk_mul_f32 v[148:149], v[20:21], v[112:113]
    v_pk_mul_f32 v[150:151], v[22:23], v[114:115]
    v_pk_mul_f32 v[152:153], v[36:37], v[116:117]
    v_pk_mul_f32 v[154:155], v[38:39], v[118:119]
    v_exp_f32 v140, v140
    v_exp_f32 v141, v141
    v_exp_f32 v142, v142
    v_exp_f32 v143, v143
    v_exp_f32 v144, v144
    v_exp_f32 v145, v145
    v_exp_f32 v146, v146
    v_exp_f32 v147, v147
    v_exp_f32 v148, v148
    v_exp_f32 v149, v149
    v_exp_f32 v150, v150
    v_exp_f32 v151, v151
    v_exp_f32 v152, v152
    v_exp_f32 v153, v153
    v_exp_f32 v154, v154
    v_exp_f32 v155, v155
    v_pk_add_f32 v[140:141], v[140:141], v[172:173]
    v_pk_add_f32 v[142:143], v[142:143], v[172:173]
    v_pk_add_f32 v[144:145], v[144:145], v[172:173]
    v_pk_add_f32 v[146:147], v[146:147], v[172:173]
    v_pk_add_f32 v[148:149], v[148:149], v[172:173]
    v_pk_add_f32 v[150:151], v[150:151], v[172:173]
    v_pk_add_f32 v[152:153], v[152:153], v[172:173]
    v_pk_add_f32 v[154:155], v[154:155], v[172:173]
    v_rcp_f32 v140, v140
    v_rcp_f32 v141, v141
    v_rcp_f32 v142, v142
    v_rcp_f32 v143, v143
    v_rcp_f32 v144, v144
    v_rcp_f32 v145, v145
    v_rcp_f32 v146, v146
    v_rcp_f32 v147, v147
    v_rcp_f32 v148, v148
    v_rcp_f32 v149, v149
    v_rcp_f32 v150, v150
    v_rcp_f32 v151, v151
    v_rcp_f32 v152, v152
    v_rcp_f32 v153, v153
    v_rcp_f32 v154, v154
    v_rcp_f32 v155, v155
    v_pk_mul_f32 v[16:17], v[16:17], v[140:141]
    v_pk_mul_f32 v[18:19], v[18:19], v[142:143]
    v_pk_mul_f32 v[32:33], v[32:33], v[144:145]
    v_pk_mul_f32 v[34:35], v[34:35], v[146:147]
    v_pk_mul_f32 v[20:21], v[20:21], v[148:149]
    v_pk_mul_f32 v[22:23], v[22:23], v[150:151]
    v_pk_mul_f32 v[36:37], v[36:37], v[152:153]
    v_pk_mul_f32 v[38:39], v[38:39], v[154:155]
    v_cvt_pk_bf16_f32 v16, v16, v17
    v_cvt_pk_bf16_f32 v17, v18, v19
    v_cvt_pk_bf16_f32 v18, v32, v33
    v_cvt_pk_bf16_f32 v19, v34, v35
    v_cvt_pk_bf16_f32 v20, v20, v21
    v_cvt_pk_bf16_f32 v21, v22, v23
    v_cvt_pk_bf16_f32 v22, v36, v37
    v_cvt_pk_bf16_f32 v23, v38, v39
    buffer_store_dwordx4 v[16:19], v3, s[28:31], s71 offen offset:2048 sc1
    ds_write_b128 v186, v[16:19] offset:2048
    buffer_store_dwordx4 v[20:23], v3, s[28:31], s71 offen offset:3072 sc1
    ds_write_b128 v186, v[20:23] offset:3072
    s_cmp_lg_u32 s64, 0
    s_cbranch_scc1 L_ee_47
L_e1_46:
    v_pk_fma_f32 v[104:105], v[80:81], v[90:91], v[128:129]
    v_pk_fma_f32 v[106:107], v[82:83], v[90:91], v[130:131]
    v_pk_fma_f32 v[108:109], v[84:85], v[90:91], v[132:133]
    v_pk_fma_f32 v[110:111], v[86:87], v[90:91], v[134:135]
    v_pk_fma_f32 v[112:113], v[80:81], v[94:95], v[128:129]
    v_pk_fma_f32 v[114:115], v[82:83], v[94:95], v[130:131]
    v_pk_fma_f32 v[116:117], v[84:85], v[94:95], v[132:133]
    v_pk_fma_f32 v[118:119], v[86:87], v[94:95], v[134:135]
    v_pk_fma_f32 v[40:41], v[40:41], v[88:89], v[104:105]
    v_pk_fma_f32 v[42:43], v[42:43], v[88:89], v[106:107]
    v_pk_fma_f32 v[56:57], v[56:57], v[88:89], v[108:109]
    v_pk_fma_f32 v[58:59], v[58:59], v[88:89], v[110:111]
    v_pk_fma_f32 v[44:45], v[44:45], v[92:93], v[112:113]
    v_pk_fma_f32 v[46:47], v[46:47], v[92:93], v[114:115]
    v_pk_fma_f32 v[60:61], v[60:61], v[92:93], v[116:117]
    v_pk_fma_f32 v[62:63], v[62:63], v[92:93], v[118:119]
    v_pk_mul_f32 v[104:105], v[40:41], v[40:41]
    v_pk_mul_f32 v[106:107], v[42:43], v[42:43]
    v_pk_mul_f32 v[108:109], v[56:57], v[56:57]
    v_pk_mul_f32 v[110:111], v[58:59], v[58:59]
    v_pk_mul_f32 v[112:113], v[44:45], v[44:45]
    v_pk_mul_f32 v[114:115], v[46:47], v[46:47]
    v_pk_mul_f32 v[116:117], v[60:61], v[60:61]
    v_pk_mul_f32 v[118:119], v[62:63], v[62:63]
    v_pk_fma_f32 v[104:105], v[104:105], v[170:171], v[168:169]
    v_pk_fma_f32 v[106:107], v[106:107], v[170:171], v[168:169]
    v_pk_fma_f32 v[108:109], v[108:109], v[170:171], v[168:169]
    v_pk_fma_f32 v[110:111], v[110:111], v[170:171], v[168:169]
    v_pk_fma_f32 v[112:113], v[112:113], v[170:171], v[168:169]
    v_pk_fma_f32 v[114:115], v[114:115], v[170:171], v[168:169]
    v_pk_fma_f32 v[116:117], v[116:117], v[170:171], v[168:169]
    v_pk_fma_f32 v[118:119], v[118:119], v[170:171], v[168:169]
    v_pk_mul_f32 v[140:141], v[40:41], v[104:105]
    v_pk_mul_f32 v[142:143], v[42:43], v[106:107]
    v_pk_mul_f32 v[144:145], v[56:57], v[108:109]
    v_pk_mul_f32 v[146:147], v[58:59], v[110:111]
    v_pk_mul_f32 v[148:149], v[44:45], v[112:113]
    v_pk_mul_f32 v[150:151], v[46:47], v[114:115]
    v_pk_mul_f32 v[152:153], v[60:61], v[116:117]
    v_pk_mul_f32 v[154:155], v[62:63], v[118:119]
    v_exp_f32 v140, v140
    v_exp_f32 v141, v141
    v_exp_f32 v142, v142
    v_exp_f32 v143, v143
    v_exp_f32 v144, v144
    v_exp_f32 v145, v145
    v_exp_f32 v146, v146
    v_exp_f32 v147, v147
    v_exp_f32 v148, v148
    v_exp_f32 v149, v149
    v_exp_f32 v150, v150
    v_exp_f32 v151, v151
    v_exp_f32 v152, v152
    v_exp_f32 v153, v153
    v_exp_f32 v154, v154
    v_exp_f32 v155, v155
    v_pk_add_f32 v[140:141], v[140:141], v[172:173]
    v_pk_add_f32 v[142:143], v[142:143], v[172:173]
    v_pk_add_f32 v[144:145], v[144:145], v[172:173]
    v_pk_add_f32 v[146:147], v[146:147], v[172:173]
    v_pk_add_f32 v[148:149], v[148:149], v[172:173]
    v_pk_add_f32 v[150:151], v[150:151], v[172:173]
    v_pk_add_f32 v[152:153], v[152:153], v[172:173]
    v_pk_add_f32 v[154:155], v[154:155], v[172:173]
    v_rcp_f32 v140, v140
    v_rcp_f32 v141, v141
    v_rcp_f32 v142, v142
    v_rcp_f32 v143, v143
    v_rcp_f32 v144, v144
    v_rcp_f32 v145, v145
    v_rcp_f32 v146, v146
    v_rcp_f32 v147, v147
    v_rcp_f32 v148, v148
    v_rcp_f32 v149, v149
    v_rcp_f32 v150, v150
    v_rcp_f32 v151, v151
    v_rcp_f32 v152, v152
    v_rcp_f32 v153, v153
    v_rcp_f32 v154, v154
    v_rcp_f32 v155, v155
    v_pk_mul_f32 v[40:41], v[40:41], v[140:141]
    v_pk_mul_f32 v[42:43], v[42:43], v[142:143]
    v_pk_mul_f32 v[56:57], v[56:57], v[144:145]
    v_pk_mul_f32 v[58:59], v[58:59], v[146:147]
    v_pk_mul_f32 v[44:45], v[44:45], v[148:149]
    v_pk_mul_f32 v[46:47], v[46:47], v[150:151]
    v_pk_mul_f32 v[60:61], v[60:61], v[152:153]
    v_pk_mul_f32 v[62:63], v[62:63], v[154:155]
    v_cvt_pk_bf16_f32 v40, v40, v41
    v_cvt_pk_bf16_f32 v41, v42, v43
    v_cvt_pk_bf16_f32 v42, v56, v57
    v_cvt_pk_bf16_f32 v43, v58, v59
    v_cvt_pk_bf16_f32 v44, v44, v45
    v_cvt_pk_bf16_f32 v45, v46, v47
    v_cvt_pk_bf16_f32 v46, v60, v61
    v_cvt_pk_bf16_f32 v47, v62, v63
    buffer_store_dwordx4 v[40:43], v3, s[28:31], s73 offen offset:0 sc1
    ds_write_b128 v188, v[40:43] offset:0
    buffer_store_dwordx4 v[44:47], v3, s[28:31], s73 offen offset:1024 sc1
    ds_write_b128 v188, v[44:47] offset:1024
    s_cmp_eq_u32 s64, 1
    s_cbranch_scc1 L_ha_49
    s_waitcnt vmcnt(2)
    s_barrier
L_ha_49:
    v_pk_fma_f32 v[104:105], v[80:81], v[98:99], v[128:129]
    v_pk_fma_f32 v[106:107], v[82:83], v[98:99], v[130:131]
    v_pk_fma_f32 v[108:109], v[84:85], v[98:99], v[132:133]
    v_pk_fma_f32 v[110:111], v[86:87], v[98:99], v[134:135]
    v_pk_fma_f32 v[112:113], v[80:81], v[102:103], v[128:129]
    v_pk_fma_f32 v[114:115], v[82:83], v[102:103], v[130:131]
    v_pk_fma_f32 v[116:117], v[84:85], v[102:103], v[132:133]
    v_pk_fma_f32 v[118:119], v[86:87], v[102:103], v[134:135]
    v_pk_fma_f32 v[48:49], v[48:49], v[96:97], v[104:105]
    v_pk_fma_f32 v[50:51], v[50:51], v[96:97], v[106:107]
    v_pk_fma_f32 v[64:65], v[64:65], v[96:97], v[108:109]
    v_pk_fma_f32 v[66:67], v[66:67], v[96:97], v[110:111]
    v_pk_fma_f32 v[52:53], v[52:53], v[100:101], v[112:113]
    v_pk_fma_f32 v[54:55], v[54:55], v[100:101], v[114:115]
    v_pk_fma_f32 v[68:69], v[68:69], v[100:101], v[116:117]
    v_pk_fma_f32 v[70:71], v[70:71], v[100:101], v[118:119]
    v_pk_mul_f32 v[104:105], v[48:49], v[48:49]
    v_pk_mul_f32 v[106:107], v[50:51], v[50:51]
    v_pk_mul_f32 v[108:109], v[64:65], v[64:65]
    v_pk_mul_f32 v[110:111], v[66:67], v[66:67]
    v_pk_mul_f32 v[112:113], v[52:53], v[52:53]
    v_pk_mul_f32 v[114:115], v[54:55], v[54:55]
    v_pk_mul_f32 v[116:117], v[68:69], v[68:69]
    v_pk_mul_f32 v[118:119], v[70:71], v[70:71]
    v_pk_fma_f32 v[104:105], v[104:105], v[170:171], v[168:169]
    v_pk_fma_f32 v[106:107], v[106:107], v[170:171], v[168:169]
    v_pk_fma_f32 v[108:109], v[108:109], v[170:171], v[168:169]
    v_pk_fma_f32 v[110:111], v[110:111], v[170:171], v[168:169]
    v_pk_fma_f32 v[112:113], v[112:113], v[170:171], v[168:169]
    v_pk_fma_f32 v[114:115], v[114:115], v[170:171], v[168:169]
    v_pk_fma_f32 v[116:117], v[116:117], v[170:171], v[168:169]
    v_pk_fma_f32 v[118:119], v[118:119], v[170:171], v[168:169]
    v_pk_mul_f32 v[140:141], v[48:49], v[104:105]
    v_pk_mul_f32 v[142:143], v[50:51], v[106:107]
    v_pk_mul_f32 v[144:145], v[64:65], v[108:109]
    v_pk_mul_f32 v[146:147], v[66:67], v[110:111]
    v_pk_mul_f32 v[148:149], v[52:53], v[112:113]
    v_pk_mul_f32 v[150:151], v[54:55], v[114:115]
    v_pk_mul_f32 v[152:153], v[68:69], v[116:117]
    v_pk_mul_f32 v[154:155], v[70:71], v[118:119]
    v_exp_f32 v140, v140
    v_exp_f32 v141, v141
    v_exp_f32 v142, v142
    v_exp_f32 v143, v143
    v_exp_f32 v144, v144
    v_exp_f32 v145, v145
    v_exp_f32 v146, v146
    v_exp_f32 v147, v147
    v_exp_f32 v148, v148
    v_exp_f32 v149, v149
    v_exp_f32 v150, v150
    v_exp_f32 v151, v151
    v_exp_f32 v152, v152
    v_exp_f32 v153, v153
    v_exp_f32 v154, v154
    v_exp_f32 v155, v155
    v_pk_add_f32 v[140:141], v[140:141], v[172:173]
    v_pk_add_f32 v[142:143], v[142:143], v[172:173]
    v_pk_add_f32 v[144:145], v[144:145], v[172:173]
    v_pk_add_f32 v[146:147], v[146:147], v[172:173]
    v_pk_add_f32 v[148:149], v[148:149], v[172:173]
    v_pk_add_f32 v[150:151], v[150:151], v[172:173]
    v_pk_add_f32 v[152:153], v[152:153], v[172:173]
    v_pk_add_f32 v[154:155], v[154:155], v[172:173]
    v_rcp_f32 v140, v140
    v_rcp_f32 v141, v141
    v_rcp_f32 v142, v142
    v_rcp_f32 v143, v143
    v_rcp_f32 v144, v144
    v_rcp_f32 v145, v145
    v_rcp_f32 v146, v146
    v_rcp_f32 v147, v147
    v_rcp_f32 v148, v148
    v_rcp_f32 v149, v149
    v_rcp_f32 v150, v150
    v_rcp_f32 v151, v151
    v_rcp_f32 v152, v152
    v_rcp_f32 v153, v153
    v_rcp_f32 v154, v154
    v_rcp_f32 v155, v155
    v_pk_mul_f32 v[48:49], v[48:49], v[140:141]
    v_pk_mul_f32 v[50:51], v[50:51], v[142:143]
    v_pk_mul_f32 v[64:65], v[64:65], v[144:145]
    v_pk_mul_f32 v[66:67], v[66:67], v[146:147]
    v_pk_mul_f32 v[52:53], v[52:53], v[148:149]
    v_pk_mul_f32 v[54:55], v[54:55], v[150:151]
    v_pk_mul_f32 v[68:69], v[68:69], v[152:153]
    v_pk_mul_f32 v[70:71], v[70:71], v[154:155]
    v_cvt_pk_bf16_f32 v48, v48, v49
    v_cvt_pk_bf16_f32 v49, v50, v51
    v_cvt_pk_bf16_f32 v50, v64, v65
    v_cvt_pk_bf16_f32 v51, v66, v67
    v_cvt_pk_bf16_f32 v52, v52, v53
    v_cvt_pk_bf16_f32 v53, v54, v55
    v_cvt_pk_bf16_f32 v54, v68, v69
    v_cvt_pk_bf16_f32 v55, v70, v71
    buffer_store_dwordx4 v[48:51], v3, s[28:31], s73 offen offset:2048 sc1
    ds_write_b128 v188, v[48:51] offset:2048
    buffer_store_dwordx4 v[52:55], v3, s[28:31], s73 offen offset:3072 sc1
    ds_write_b128 v188, v[52:55] offset:3072
    s_cmp_lg_u32 s64, 0
    s_cbranch_scc1 L_e0_45
L_ee_47:
    s_waitcnt lgkmcnt(0)
    s_mov_b32 s68, 11
    s_mov_b32 s66, 16384
    s_mov_b32 s67, 20480
    s_barrier
    ds_read_b64_tr_b16 v[120:121], v181 offset:0
    ds_read_b64_tr_b16 v[122:123], v181 offset:5120
    ds_read_b128 v[88:91], v180 offset:0
    ds_read_b128 v[92:95], v180 offset:1024
    ds_read_b128 v[96:99], v180 offset:2048
    ds_read_b128 v[100:103], v180 offset:3072
    ds_read_b64_tr_b16 v[124:125], v182 offset:0
    ds_read_b64_tr_b16 v[126:127], v182 offset:5120
    ds_read_b64_tr_b16 v[128:129], v181 offset:64
    ds_read_b64_tr_b16 v[130:131], v181 offset:5184
    ds_read_b64_tr_b16 v[132:133], v182 offset:64
    ds_read_b64_tr_b16 v[134:135], v182 offset:5184
    ds_read_b64_tr_b16 v[136:137], v181 offset:128
    ds_read_b64_tr_b16 v[138:139], v181 offset:5248
    s_waitcnt lgkmcnt(8)
    v_mfma_f32_16x16x32_bf16 v[8:11], v[120:123], v[88:91], 0
    v_mfma_f32_16x16x32_bf16 v[12:15], v[120:123], v[92:95], 0
    v_mfma_f32_16x16x32_bf16 v[16:19], v[120:123], v[96:99], 0
    v_mfma_f32_16x16x32_bf16 v[20:23], v[120:123], v[100:103], 0
    s_waitcnt lgkmcnt(0)
    v_mfma_f32_16x16x32_bf16 v[24:27], v[124:127], v[88:91], 0
    ds_read_b64_tr_b16 v[140:141], v181 offset:10240
    v_mfma_f32_16x16x32_bf16 v[28:31], v[124:127], v[92:95], 0
    ds_read_b64_tr_b16 v[142:143], v181 offset:15360
    v_mfma_f32_16x16x32_bf16 v[32:35], v[124:127], v[96:99], 0
    ds_read_b128 v[104:107], v180 offset:8192
    v_mfma_f32_16x16x32_bf16 v[36:39], v[124:127], v[100:103], 0
    ds_read_b128 v[108:111], v180 offset:9216
    v_mfma_f32_16x16x32_bf16 v[40:43], v[128:131], v[88:91], 0
    ds_read_b128 v[112:115], v180 offset:10240
    v_mfma_f32_16x16x32_bf16 v[44:47], v[128:131], v[92:95], 0
    ds_read_b128 v[116:119], v180 offset:11264
    v_mfma_f32_16x16x32_bf16 v[48:51], v[128:131], v[96:99], 0
    ds_read_b64_tr_b16 v[144:145], v182 offset:10240
    v_mfma_f32_16x16x32_bf16 v[52:55], v[128:131], v[100:103], 0
    ds_read_b64_tr_b16 v[146:147], v182 offset:15360
    v_mfma_f32_16x16x32_bf16 v[56:59], v[132:135], v[88:91], 0
    ds_read_b64_tr_b16 v[148:149], v181 offset:10304
    v_mfma_f32_16x16x32_bf16 v[60:63], v[132:135], v[92:95], 0
    ds_read_b64_tr_b16 v[150:151], v181 offset:15424
    v_mfma_f32_16x16x32_bf16 v[64:67], v[132:135], v[96:99], 0
    ds_read_b64_tr_b16 v[152:153], v182 offset:10304
    v_mfma_f32_16x16x32_bf16 v[68:71], v[132:135], v[100:103], 0
    ds_read_b64_tr_b16 v[154:155], v182 offset:15424
    v_mfma_f32_16x16x32_bf16 v[72:75], v[136:139], v[88:91], 0
    ds_read_b64_tr_b16 v[156:157], v181 offset:10368
    v_mfma_f32_16x16x32_bf16 v[76:79], v[136:139], v[92:95], 0
    ds_read_b64_tr_b16 v[158:159], v181 offset:15488
    v_mfma_f32_16x16x32_bf16 v[80:83], v[136:139], v[96:99], 0
    v_mfma_f32_16x16x32_bf16 v[84:87], v[136:139], v[100:103], 0
    s_waitcnt vmcnt(0)
    s_branch L_gm_52
L_gl_50:
    s_waitcnt lgkmcnt(8)
    v_mfma_f32_16x16x32_bf16 v[8:11], v[120:123], v[88:91], v[8:11]
    s_add_u32 s68, s68, 1
    s_and_b32 s73, s68, 3
    v_mfma_f32_16x16x32_bf16 v[12:15], v[120:123], v[92:95], v[12:15]
    s_cselect_b32 s73, 1, -3
    s_lshl_b32 s66, s73, 14
    v_mfma_f32_16x16x32_bf16 v[16:19], v[120:123], v[96:99], v[16:19]
    s_mul_i32 s67, s73, 20480
    v_mfma_f32_16x16x32_bf16 v[20:23], v[120:123], v[100:103], v[20:23]
    s_waitcnt lgkmcnt(0)
    v_mfma_f32_16x16x32_bf16 v[24:27], v[124:127], v[88:91], v[24:27]
    ds_read_b64_tr_b16 v[140:141], v181 offset:10240
    v_mfma_f32_16x16x32_bf16 v[28:31], v[124:127], v[92:95], v[28:31]
    ds_read_b64_tr_b16 v[142:143], v181 offset:15360
    v_mfma_f32_16x16x32_bf16 v[32:35], v[124:127], v[96:99], v[32:35]
    ds_read_b128 v[104:107], v180 offset:8192
    v_mfma_f32_16x16x32_bf16 v[36:39], v[124:127], v[100:103], v[36:39]
    ds_read_b128 v[108:111], v180 offset:9216
    v_mfma_f32_16x16x32_bf16 v[40:43], v[128:131], v[88:91], v[40:43]
    ds_read_b128 v[112:115], v180 offset:10240
    v_mfma_f32_16x16x32_bf16 v[44:47], v[128:131], v[92:95], v[44:47]
    ds_read_b128 v[116:119], v180 offset:11264
    v_mfma_f32_16x16x32_bf16 v[48:51], v[128:131], v[96:99], v[48:51]
    ds_read_b64_tr_b16 v[144:145], v182 offset:10240
    v_mfma_f32_16x16x32_bf16 v[52:55], v[128:131], v[100:103], v[52:55]
    ds_read_b64_tr_b16 v[146:147], v182 offset:15360
    v_mfma_f32_16x16x32_bf16 v[56:59], v[132:135], v[88:91], v[56:59]
    ds_read_b64_tr_b16 v[148:149], v181 offset:10304
    v_mfma_f32_16x16x32_bf16 v[60:63], v[132:135], v[92:95], v[60:63]
    ds_read_b64_tr_b16 v[150:151], v181 offset:15424
    v_mfma_f32_16x16x32_bf16 v[64:67], v[132:135], v[96:99], v[64:67]
    ds_read_b64_tr_b16 v[152:153], v182 offset:10304
    v_mfma_f32_16x16x32_bf16 v[68:71], v[132:135], v[100:103], v[68:71]
    ds_read_b64_tr_b16 v[154:155], v182 offset:15424
    v_mfma_f32_16x16x32_bf16 v[72:75], v[136:139], v[88:91], v[72:75]
    ds_read_b64_tr_b16 v[156:157], v181 offset:10368
    v_mfma_f32_16x16x32_bf16 v[76:79], v[136:139], v[92:95], v[76:79]
    ds_read_b64_tr_b16 v[158:159], v181 offset:15488
    v_mfma_f32_16x16x32_bf16 v[80:83], v[136:139], v[96:99], v[80:83]
    v_mfma_f32_16x16x32_bf16 v[84:87], v[136:139], v[100:103], v[84:87]
L_gm_52:
    s_waitcnt lgkmcnt(8)
    v_mfma_f32_16x16x32_bf16 v[8:11], v[140:143], v[104:107], v[8:11]
    v_add_u32 v180, s66, v180
    v_add_u32 v181, s67, v181
    v_mfma_f32_16x16x32_bf16 v[12:15], v[140:143], v[108:111], v[12:15]
    v_add_u32 v182, s67, v182
    s_cmp_eq_u32 s68, 18
    v_mfma_f32_16x16x32_bf16 v[16:19], v[140:143], v[112:115], v[16:19]
    s_waitcnt lgkmcnt(0)
    v_mfma_f32_16x16x32_bf16 v[20:23], v[140:143], v[116:119], v[20:23]
    s_barrier
    s_cbranch_scc1 L_gx_51
    v_mfma_f32_16x16x32_bf16 v[24:27], v[144:147], v[104:107], v[24:27]
    ds_read_b64_tr_b16 v[120:121], v181 offset:0
    v_mfma_f32_16x16x32_bf16 v[28:31], v[144:147], v[108:111], v[28:31]
    ds_read_b64_tr_b16 v[122:123], v181 offset:5120
    v_mfma_f32_16x16x32_bf16 v[32:35], v[144:147], v[112:115], v[32:35]
    ds_read_b128 v[88:91], v180 offset:0
    v_mfma_f32_16x16x32_bf16 v[36:39], v[144:147], v[116:119], v[36:39]
    ds_read_b128 v[92:95], v180 offset:1024
    v_mfma_f32_16x16x32_bf16 v[40:43], v[148:151], v[104:107], v[40:43]
    ds_read_b128 v[96:99], v180 offset:2048
    v_mfma_f32_16x16x32_bf16 v[44:47], v[148:151], v[108:111], v[44:47]
    ds_read_b128 v[100:103], v180 offset:3072
    v_mfma_f32_16x16x32_bf16 v[48:51], v[148:151], v[112:115], v[48:51]
    ds_read_b64_tr_b16 v[124:125], v182 offset:0
    v_mfma_f32_16x16x32_bf16 v[52:55], v[148:151], v[116:119], v[52:55]
    ds_read_b64_tr_b16 v[126:127], v182 offset:5120
    v_mfma_f32_16x16x32_bf16 v[56:59], v[152:155], v[104:107], v[56:59]
    ds_read_b64_tr_b16 v[128:129], v181 offset:64
    v_mfma_f32_16x16x32_bf16 v[60:63], v[152:155], v[108:111], v[60:63]
    ds_read_b64_tr_b16 v[130:131], v181 offset:5184
    v_mfma_f32_16x16x32_bf16 v[64:67], v[152:155], v[112:115], v[64:67]
    ds_read_b64_tr_b16 v[132:133], v182 offset:64
    v_mfma_f32_16x16x32_bf16 v[68:71], v[152:155], v[116:119], v[68:71]
    ds_read_b64_tr_b16 v[134:135], v182 offset:5184
    v_mfma_f32_16x16x32_bf16 v[72:75], v[156:159], v[104:107], v[72:75]
    ds_read_b64_tr_b16 v[136:137], v181 offset:128
    v_mfma_f32_16x16x32_bf16 v[76:79], v[156:159], v[108:111], v[76:79]
    ds_read_b64_tr_b16 v[138:139], v181 offset:5248
    v_mfma_f32_16x16x32_bf16 v[80:83], v[156:159], v[112:115], v[80:83]
    v_mfma_f32_16x16x32_bf16 v[84:87], v[156:159], v[116:119], v[84:87]
    s_branch L_gl_50
L_gx_51:
    s_mov_b32 s48, s18
    s_mov_b32 s49, s19
    s_mov_b32 s50, 1280
    s_mov_b32 s51, 0x20000
    v_lshlrev_b32 v246, 2, v0
    buffer_load_dwordx4 v[228:231], v3, s[36:39], s52 offen
    buffer_load_dword v244, v246, s[36:39], s52 offen offset:1024
    buffer_load_dwordx4 v[232:235], v3, s[48:51], 0 offen
    buffer_load_dword v245, v246, s[48:51], 0 offen offset:1024
    ds_read_b128 v[236:239], v3 offset:57344
    ds_read_b128 v[240:243], v3 offset:58368
    s_add_u32 s73, s72, 4096
    s_add_u32 s74, s72, 8192
    v_mfma_f32_16x16x32_bf16 v[24:27], v[144:147], v[104:107], v[24:27]
    v_mfma_f32_16x16x32_bf16 v[40:43], v[148:151], v[104:107], v[40:43]
    v_mfma_f32_16x16x32_bf16 v[56:59], v[152:155], v[104:107], v[56:59]
    v_mfma_f32_16x16x32_bf16 v[72:75], v[156:159], v[104:107], v[72:75]
    v_mfma_f32_16x16x32_bf16 v[28:31], v[144:147], v[108:111], v[28:31]
    v_mfma_f32_16x16x32_bf16 v[44:47], v[148:151], v[108:111], v[44:47]
    v_mfma_f32_16x16x32_bf16 v[60:63], v[152:155], v[108:111], v[60:63]
    v_mfma_f32_16x16x32_bf16 v[76:79], v[156:159], v[108:111], v[76:79]
    v_mfma_f32_16x16x32_bf16 v[32:35], v[144:147], v[112:115], v[32:35]
    v_cvt_pk_bf16_f32 v88, v8, v9
    v_cvt_pk_bf16_f32 v89, v10, v11
    ds_write_b64 v189, v[88:89] offset:0
    v_cvt_pk_bf16_f32 v90, v24, v25
    v_mfma_f32_16x16x32_bf16 v[48:51], v[148:151], v[112:115], v[48:51]
    v_cvt_pk_bf16_f32 v91, v26, v27
    ds_write_b64 v189, v[90:91] offset:32
    v_cvt_pk_bf16_f32 v92, v40, v41
    v_cvt_pk_bf16_f32 v93, v42, v43
    v_mfma_f32_16x16x32_bf16 v[64:67], v[152:155], v[112:115], v[64:67]
    ds_write_b64 v189, v[92:93] offset:64
    v_cvt_pk_bf16_f32 v94, v56, v57
    v_cvt_pk_bf16_f32 v95, v58, v59
    ds_write_b64 v189, v[94:95] offset:96
    v_mfma_f32_16x16x32_bf16 v[80:83], v[156:159], v[112:115], v[80:83]
    v_cvt_pk_bf16_f32 v96, v72, v73
    v_cvt_pk_bf16_f32 v97, v74, v75
    ds_write_b64 v189, v[96:97] offset:128
    v_mfma_f32_16x16x32_bf16 v[36:39], v[144:147], v[116:119], v[36:39]
    v_cvt_pk_bf16_f32 v120, v12, v13
    v_cvt_pk_bf16_f32 v121, v14, v15
    ds_write_b64 v189, v[120:121] offset:2816
    v_cvt_pk_bf16_f32 v122, v28, v29
    v_mfma_f32_16x16x32_bf16 v[52:55], v[148:151], v[116:119], v[52:55]
    v_cvt_pk_bf16_f32 v123, v30, v31
    ds_write_b64 v189, v[122:123] offset:2848
    v_cvt_pk_bf16_f32 v124, v44, v45
    v_cvt_pk_bf16_f32 v125, v46, v47
    v_mfma_f32_16x16x32_bf16 v[68:71], v[152:155], v[116:119], v[68:71]
    ds_write_b64 v189, v[124:125] offset:2880
    v_cvt_pk_bf16_f32 v126, v60, v61
    v_cvt_pk_bf16_f32 v127, v62, v63
    ds_write_b64 v189, v[126:127] offset:2912
    v_mfma_f32_16x16x32_bf16 v[84:87], v[156:159], v[116:119], v[84:87]
    v_cvt_pk_bf16_f32 v128, v76, v77
    v_cvt_pk_bf16_f32 v129, v78, v79
    ds_write_b64 v189, v[128:129] offset:2944
    ds_read_b128 v[8:11], v190
    ds_read_b128 v[24:27], v191
    ds_read_b128 v[40:43], v192
    ds_read_b128 v[56:59], v193
    ds_read_b128 v[72:75], v194
    s_waitcnt lgkmcnt(5)
    v_cvt_pk_bf16_f32 v88, v16, v17
    v_cvt_pk_bf16_f32 v89, v18, v19
    ds_write_b64 v189, v[88:89] offset:5632
    v_cvt_pk_bf16_f32 v90, v32, v33
    v_cvt_pk_bf16_f32 v91, v34, v35
    ds_write_b64 v189, v[90:91] offset:5664
    v_cvt_pk_bf16_f32 v92, v48, v49
    v_cvt_pk_bf16_f32 v93, v50, v51
    ds_write_b64 v189, v[92:93] offset:5696
    v_cvt_pk_bf16_f32 v94, v64, v65
    v_cvt_pk_bf16_f32 v95, v66, v67
    ds_write_b64 v189, v[94:95] offset:5728
    v_cvt_pk_bf16_f32 v96, v80, v81
    v_cvt_pk_bf16_f32 v97, v82, v83
    ds_write_b64 v189, v[96:97] offset:5760
    s_waitcnt lgkmcnt(9)
    buffer_store_dwordx4 v[8:11], v3, s[28:31], s72 offen offset:0 sc1
    s_waitcnt lgkmcnt(8)
    buffer_store_dwordx4 v[24:27], v3, s[28:31], s72 offen offset:1024 sc1
    s_waitcnt lgkmcnt(7)
    buffer_store_dwordx4 v[40:43], v3, s[28:31], s72 offen offset:2048 sc1
    s_waitcnt lgkmcnt(6)
    buffer_store_dwordx4 v[56:59], v3, s[28:31], s72 offen offset:3072 sc1
    s_waitcnt lgkmcnt(5)
    buffer_store_dwordx4 v[72:75], v3, s[28:31], s73 offen offset:0 sc1
    v_cvt_pk_bf16_f32 v120, v20, v21
    v_cvt_pk_bf16_f32 v121, v22, v23
    ds_write_b64 v189, v[120:121] offset:8448
    v_cvt_pk_bf16_f32 v122, v36, v37
    v_cvt_pk_bf16_f32 v123, v38, v39
    ds_write_b64 v189, v[122:123] offset:8480
    v_cvt_pk_bf16_f32 v124, v52, v53
    v_cvt_pk_bf16_f32 v125, v54, v55
    ds_write_b64 v189, v[124:125] offset:8512
    v_cvt_pk_bf16_f32 v126, v68, v69
    v_cvt_pk_bf16_f32 v127, v70, v71
    ds_write_b64 v189, v[126:127] offset:8544
    v_cvt_pk_bf16_f32 v128, v84, v85
    v_cvt_pk_bf16_f32 v129, v86, v87
    ds_write_b64 v189, v[128:129] offset:8576
    ds_read_b128 v[12:15], v190 offset:5632
    ds_read_b128 v[28:31], v191 offset:5632
    ds_read_b128 v[44:47], v192 offset:5632
    ds_read_b128 v[60:63], v193 offset:5632
    ds_read_b128 v[76:79], v194 offset:5632
    s_waitcnt lgkmcnt(4)
    buffer_store_dwordx4 v[12:15], v3, s[28:31], s73 offen offset:1024 sc1
    s_waitcnt lgkmcnt(3)
    buffer_store_dwordx4 v[28:31], v3, s[28:31], s73 offen offset:2048 sc1
    s_waitcnt lgkmcnt(2)
    buffer_store_dwordx4 v[44:47], v3, s[28:31], s73 offen offset:3072 sc1
    s_waitcnt lgkmcnt(1)
    buffer_store_dwordx4 v[60:63], v3, s[28:31], s74 offen offset:0 sc1
    s_waitcnt lgkmcnt(0)
    buffer_store_dwordx4 v[76:79], v3, s[28:31], s74 offen offset:1024 sc1
    s_branch L_f3
L_f3:
    s_setprio 0
    s_mov_b32 s12, s52
    s_mov_b32 s13, s60
    s_mov_b32 s14, s62
    v_add_u32 v7, 147456, v3
    ds_read_b128 v[144:147], v7 offset:14336
    ds_read_b128 v[148:151], v7 offset:15360
    ds_read_b128 v[132:135], v7 offset:11264
    ds_read_b128 v[140:143], v7 offset:13312
    ds_read_b128 v[128:131], v7 offset:10240
    ds_read_b128 v[136:139], v7 offset:12288
    ds_read_b128 v[88:91], v7 offset:0
    ds_read_b128 v[92:95], v7 offset:1024
    ds_read_b128 v[96:99], v7 offset:2048
    ds_read_b128 v[100:103], v7 offset:3072
    ds_read_b128 v[104:107], v7 offset:4096
    ds_read_b128 v[108:111], v7 offset:5120
    ds_read_b128 v[112:115], v7 offset:6144
    ds_read_b128 v[116:119], v7 offset:7168
    v_mov_b32 v180, 1.0
    v_mov_b32 v181, 1.0
    s_lshl_b32 s16, s13, 2
    s_add_u32 s16, s16, s61
    s_lshl_b32 s15, s16, 3
    s_add_u32 s15, s15, s26
    s_mul_i32 s15, s15, 160
    s_add_u32 s15, s15, 12582912
    s_lshl_b32 s16, s16, 8
    s_add_u32 s16, s16, 20637824
    s_cmp_lt_u32 s26, 4
    s_cbranch_scc1 L_nv_53
    s_cmp_lg_u32 s22, 0
    s_cbranch_scc1 L_nv_53
    s_lshl_b32 s6, s13, 10
    s_and_b32 s4, s26, 3
    s_lshl_b32 s4, s4, 8
    s_add_u32 s6, s6, s4
    s_add_u32 s6, s6, 20572288
    s_mov_b32 s4, 0x40000
L_bp_55:
    s_add_u32 s8, s24, s6
    s_addc_u32 s9, s25, 0
    s_load_dwordx16 s[32:47], s[8:9], 0 glc
    s_load_dwordx16 s[48:63], s[8:9], 64 glc
    s_load_dwordx16 s[64:79], s[8:9], 128 glc
    s_load_dwordx16 s[84:99], s[8:9], 192 glc
L_bc_56:
    s_waitcnt lgkmcnt(0)
    s_mov_b64 vcc, s[32:33]
    s_and_b64 vcc, vcc, s[34:35]
    s_or_b64 s[32:33], s[32:33], s[34:35]
    s_and_b64 vcc, vcc, s[36:37]
    s_or_b64 s[32:33], s[32:33], s[36:37]
    s_and_b64 vcc, vcc, s[38:39]
    s_or_b64 s[32:33], s[32:33], s[38:39]
    s_and_b64 vcc, vcc, s[40:41]
    s_or_b64 s[32:33], s[32:33], s[40:41]
    s_and_b64 vcc, vcc, s[42:43]
    s_or_b64 s[32:33], s[32:33], s[42:43]
    s_and_b64 vcc, vcc, s[44:45]
    s_or_b64 s[32:33], s[32:33], s[44:45]
    s_and_b64 vcc, vcc, s[46:47]
    s_or_b64 s[32:33], s[32:33], s[46:47]
    s_and_b64 vcc, vcc, s[48:49]
    s_or_b64 s[32:33], s[32:33], s[48:49]
    s_and_b64 vcc, vcc, s[50:51]
    s_or_b64 s[32:33], s[32:33], s[50:51]
    s_and_b64 vcc, vcc, s[52:53]
    s_or_b64 s[32:33], s[32:33], s[52:53]
    s_and_b64 vcc, vcc, s[54:55]
    s_or_b64 s[32:33], s[32:33], s[54:55]
    s_and_b64 vcc, vcc, s[56:57]
    s_or_b64 s[32:33], s[32:33], s[56:57]
    s_and_b64 vcc, vcc, s[58:59]
    s_or_b64 s[32:33], s[32:33], s[58:59]
    s_and_b64 vcc, vcc, s[60:61]
    s_or_b64 s[32:33], s[32:33], s[60:61]
    s_and_b64 vcc, vcc, s[62:63]
    s_or_b64 s[32:33], s[32:33], s[62:63]
    s_and_b64 vcc, vcc, s[64:65]
    s_or_b64 s[32:33], s[32:33], s[64:65]
    s_and_b64 vcc, vcc, s[66:67]
    s_or_b64 s[32:33], s[32:33], s[66:67]
    s_and_b64 vcc, vcc, s[68:69]
    s_or_b64 s[32:33], s[32:33], s[68:69]
    s_and_b64 vcc, vcc, s[70:71]
    s_or_b64 s[32:33], s[32:33], s[70:71]
    s_and_b64 vcc, vcc, s[72:73]
    s_or_b64 s[32:33], s[32:33], s[72:73]
    s_and_b64 vcc, vcc, s[74:75]
    s_or_b64 s[32:33], s[32:33], s[74:75]
    s_and_b64 vcc, vcc, s[76:77]
    s_or_b64 s[32:33], s[32:33], s[76:77]
    s_and_b64 vcc, vcc, s[78:79]
    s_or_b64 s[32:33], s[32:33], s[78:79]
    s_and_b64 vcc, vcc, s[84:85]
    s_or_b64 s[32:33], s[32:33], s[84:85]
    s_and_b64 vcc, vcc, s[86:87]
    s_or_b64 s[32:33], s[32:33], s[86:87]
    s_and_b64 vcc, vcc, s[88:89]
    s_or_b64 s[32:33], s[32:33], s[88:89]
    s_and_b64 vcc, vcc, s[90:91]
    s_or_b64 s[32:33], s[32:33], s[90:91]
    s_and_b64 vcc, vcc, s[92:93]
    s_or_b64 s[32:33], s[32:33], s[92:93]
    s_and_b64 vcc, vcc, s[94:95]
    s_or_b64 s[32:33], s[32:33], s[94:95]
    s_and_b64 vcc, vcc, s[96:97]
    s_or_b64 s[32:33], s[32:33], s[96:97]
    s_and_b64 vcc, vcc, s[98:99]
    s_or_b64 s[32:33], s[32:33], s[98:99]
    s_xor_b64 vcc, vcc, s[10:11]
    s_xor_b64 s[32:33], s[32:33], s[10:11]
    s_or_b64 vcc, vcc, s[32:33]
    s_cbranch_scc0 L_bq_57
    s_sleep 8
    s_sub_u32 s4, s4, 1
    s_cbranch_scc0 L_bp_55
L_bq_57:
    s_and_b32 s4, s26, 3
    s_mul_i32 s5, s13, 49152
    s_mul_i32 s4, s4, 12288
    s_add_u32 s5, s5, s4
    s_cmp_ge_u32 s26, 6
    s_cselect_b32 s6, 49152, 0
    s_add_u32 s4, s4, s6
    s_add_u32 m0, s4, 32768
    s_add_u32 s6, s5, 9437184
    buffer_load_dwordx4 v3, s[28:31], s6 offen sc1 lds
    buffer_load_dwordx4 v3, s[28:31], s6 offen offset:1024 sc1 lds
    buffer_load_dwordx4 v3, s[28:31], s6 offen offset:2048 sc1 lds
    buffer_load_dwordx4 v3, s[28:31], s6 offen offset:3072 sc1 lds
    s_add_u32 m0, s4, 36864
    s_add_u32 s6, s5, 9441280
    buffer_load_dwordx4 v3, s[28:31], s6 offen sc1 lds
    buffer_load_dwordx4 v3, s[28:31], s6 offen offset:1024 sc1 lds
    buffer_load_dwordx4 v3, s[28:31], s6 offen offset:2048 sc1 lds
    buffer_load_dwordx4 v3, s[28:31], s6 offen offset:3072 sc1 lds
    s_add_u32 m0, s4, 40960
    s_add_u32 s6, s5, 9445376
    buffer_load_dwordx4 v3, s[28:31], s6 offen sc1 lds
    buffer_load_dwordx4 v3, s[28:31], s6 offen offset:1024 sc1 lds
    buffer_load_dwordx4 v3, s[28:31], s6 offen offset:2048 sc1 lds
    buffer_load_dwordx4 v3, s[28:31], s6 offen offset:3072 sc1 lds
L_nv_53:
    s_waitcnt lgkmcnt(10)
    ds_read_b128 v[120:123], v7 offset:8192
    ds_read_b128 v[124:127], v7 offset:9216
    v_xor_b32 v152, 0x80000000, v132
    v_xor_b32 v153, 0x80000000, v133
    v_xor_b32 v154, 0x80000000, v134
    v_xor_b32 v155, 0x80000000, v135
    v_xor_b32 v156, 0x80000000, v140
    v_xor_b32 v157, 0x80000000, v141
    v_xor_b32 v158, 0x80000000, v142
    v_xor_b32 v159, 0x80000000, v143
    s_add_u32 s4, s26, 0
    s_min_u32 s4, s4, 20
    s_cmp_ge_u32 s4, 12
    s_cselect_b32 s5, 73344, 0
    s_lshl_b32 s4, s4, 5
    s_add_u32 s5, s5, s4
    s_add_u32 s5, s5, 32768
    s_and_b32 s6, s5, 0x60
    s_andn2_b32 s5, s5, 0x60
    v_xor_b32 v184, s6, v146
    v_add_u32 v184, s5, v184
    s_lshl_b32 s4, s4, 1
    s_add_u32 s4, s4, 65536
    v_add_u32 v187, s4, v147
    s_add_u32 s4, s26, 8
    s_min_u32 s4, s4, 20
    s_cmp_ge_u32 s4, 12
    s_cselect_b32 s5, 73344, 0
    s_lshl_b32 s4, s4, 5
    s_add_u32 s5, s5, s4
    s_add_u32 s5, s5, 32768
    s_and_b32 s6, s5, 0x60
    s_andn2_b32 s5, s5, 0x60
    v_xor_b32 v185, s6, v146
    v_add_u32 v185, s5, v185
    s_lshl_b32 s4, s4, 1
    s_add_u32 s4, s4, 65536
    v_add_u32 v188, s4, v147
    s_add_u32 s4, s26, 16
    s_min_u32 s4, s4, 20
    s_cmp_ge_u32 s4, 12
    s_cselect_b32 s5, 73344, 0
    s_lshl_b32 s4, s4, 5
    s_add_u32 s5, s5, s4
    s_add_u32 s5, s5, 32768
    s_and_b32 s6, s5, 0x60
    s_andn2_b32 s5, s5, 0x60
    v_xor_b32 v186, s6, v146
    v_add_u32 v186, s5, v186
    s_lshl_b32 s4, s4, 1
    s_add_u32 s4, s4, 65536
    s_cmp_ge_u32 s26, 4
    s_cselect_b64 vcc, -1, 0
    v_cndmask_b32 v147, v147, v148, vcc
    v_add_u32 v189, s4, v147
    s_mul_i32 s4, s26, 1376
    s_add_u32 s4, s4, 65536
    v_add_u32 v190, s4, v149
    s_add_u32 s4, s4, 1040
    v_sub_u32 v191, s4, v149
    s_lshl_b32 s4, s26, 11
    s_add_u32 s4, s4, 76544
    v_add_u32 v192, s4, v150
    v_xor_b32 v182, 32, v192
    v_lshlrev_b32 v4, 1, v0
    v_and_b32 v4, 0x30, v4
    v_xor_b32 v4, v4, v3
    v_add_u32 v193, s4, v4
    v_lshrrev_b32 v4, 1, v0
    v_and_b32 v4, 0x10, v4
    v_xor_b32 v4, v4, v246
    v_add_u32 v194, s4, v4
    s_cmp_lg_u32 s23, 1
    s_cbranch_scc1 L_wa_58
    s_waitcnt vmcnt(5)
    v_mov_b32 v4, s10
    v_mov_b32 v5, s11
    v_lshlrev_b32 v6, 8, v0
    s_mov_b64 exec, 15
    buffer_store_dwordx2 v[4:5], v6, s[28:31], s14 offen sc1
    s_mov_b64 exec, -1
    s_add_u32 s14, s14, 1024
    s_waitcnt vmcnt(1)
    v_mov_b32 v4, s10
    v_mov_b32 v5, s11
    v_lshlrev_b32 v6, 8, v0
    s_mov_b64 exec, 15
    buffer_store_dwordx2 v[4:5], v6, s[28:31], s14 offen sc1
    s_mov_b64 exec, -1
    s_branch L_wb_59
L_wa_58:
    s_cmp_lg_u32 s26, 4
    s_cbranch_scc1 L_w4_60
    s_add_u32 s8, s24, s16
    s_addc_u32 s9, s25, 0
    s_load_dwordx16 s[32:47], s[8:9], 0 glc
    s_load_dwordx16 s[48:63], s[8:9], 64 glc
    s_load_dwordx16 s[64:79], s[8:9], 128 glc
    s_waitcnt lgkmcnt(0)
    s_mov_b64 vcc, s[32:33]
    s_and_b64 vcc, vcc, s[34:35]
    s_or_b64 s[32:33], s[32:33], s[34:35]
    s_and_b64 vcc, vcc, s[36:37]
    s_or_b64 s[32:33], s[32:33], s[36:37]
    s_and_b64 vcc, vcc, s[38:39]
    s_or_b64 s[32:33], s[32:33], s[38:39]
    s_and_b64 vcc, vcc, s[40:41]
    s_or_b64 s[32:33], s[32:33], s[40:41]
    s_and_b64 vcc, vcc, s[42:43]
    s_or_b64 s[32:33], s[32:33], s[42:43]
    s_and_b64 vcc, vcc, s[44:45]
    s_or_b64 s[32:33], s[32:33], s[44:45]
    s_and_b64 vcc, vcc, s[46:47]
    s_or_b64 s[32:33], s[32:33], s[46:47]
    s_and_b64 vcc, vcc, s[48:49]
    s_or_b64 s[32:33], s[32:33], s[48:49]
    s_and_b64 vcc, vcc, s[50:51]
    s_or_b64 s[32:33], s[32:33], s[50:51]
    s_and_b64 vcc, vcc, s[52:53]
    s_or_b64 s[32:33], s[32:33], s[52:53]
    s_and_b64 vcc, vcc, s[54:55]
    s_or_b64 s[32:33], s[32:33], s[54:55]
    s_and_b64 vcc, vcc, s[56:57]
    s_or_b64 s[32:33], s[32:33], s[56:57]
    s_and_b64 vcc, vcc, s[58:59]
    s_or_b64 s[32:33], s[32:33], s[58:59]
    s_and_b64 vcc, vcc, s[60:61]
    s_or_b64 s[32:33], s[32:33], s[60:61]
    s_and_b64 vcc, vcc, s[62:63]
    s_or_b64 s[32:33], s[32:33], s[62:63]
    s_and_b64 vcc, vcc, s[64:65]
    s_or_b64 s[32:33], s[32:33], s[64:65]
    s_and_b64 vcc, vcc, s[66:67]
    s_or_b64 s[32:33], s[32:33], s[66:67]
    s_and_b64 vcc, vcc, s[68:69]
    s_or_b64 s[32:33], s[32:33], s[68:69]
    s_and_b64 vcc, vcc, s[70:71]
    s_or_b64 s[32:33], s[32:33], s[70:71]
    s_and_b64 vcc, vcc, s[72:73]
    s_or_b64 s[32:33], s[32:33], s[72:73]
    s_and_b64 vcc, vcc, s[74:75]
    s_or_b64 s[32:33], s[32:33], s[74:75]
    s_and_b64 vcc, vcc, s[76:77]
    s_or_b64 s[32:33], s[32:33], s[76:77]
    s_and_b64 vcc, vcc, s[78:79]
    s_or_b64 s[32:33], s[32:33], s[78:79]
    s_xor_b64 vcc, vcc, s[10:11]
    s_xor_b64 s[32:33], s[32:33], s[10:11]
    s_or_b64 vcc, vcc, s[32:33]
    s_cselect_b32 s4, 0, 1
    v_mov_b32 v4, s4
    v_mov_b32 v5, 59392
    ds_write_b32 v5, v4
L_w4_60:
    s_waitcnt vmcnt(0)
L_wb_59:
    v_mov_b32 v5, 59392
    s_waitcnt lgkmcnt(0)
    s_barrier
    ds_read_b32 v4, v5
    ds_read_b64_tr_b16 v[8:9], v184 offset:0
    ds_read_b64_tr_b16 v[10:11], v184 offset:6144
    ds_read_b64_tr_b16 v[12:13], v184 offset:12288
    ds_read_b64_tr_b16 v[14:15], v184 offset:18432
    ds_read_b64_tr_b16 v[16:17], v185 offset:0
    ds_read_b64_tr_b16 v[18:19], v185 offset:6144
    ds_read_b64_tr_b16 v[20:21], v185 offset:12288
    ds_read_b64_tr_b16 v[22:23], v185 offset:18432
    ds_read_b64_tr_b16 v[24:25], v186 offset:0
    ds_read_b64_tr_b16 v[26:27], v186 offset:6144
    ds_read_b64_tr_b16 v[28:29], v186 offset:12288
    ds_read_b64_tr_b16 v[30:31], v186 offset:18432
    v_lshlrev_b32 v160, 16, v232
    v_and_b32 v161, 0xffff0000, v232
    v_lshlrev_b32 v162, 16, v233
    v_and_b32 v163, 0xffff0000, v233
    v_lshlrev_b32 v164, 16, v234
    v_and_b32 v165, 0xffff0000, v234
    v_lshlrev_b32 v166, 16, v235
    v_and_b32 v167, 0xffff0000, v235
    v_lshlrev_b32 v168, 16, v245
    v_and_b32 v169, 0xffff0000, v245
    s_waitcnt lgkmcnt(12)
    v_readfirstlane_b32 s17, v4
    s_nop 0
    s_cmp_eq_u32 s17, 0
    s_cbranch_scc1 L_nh_61
    s_add_u32 s4, s15, 0
    buffer_load_dwordx4 v[52:55], v144, s[28:31], s4 offen sc1
    buffer_load_dword v64, v145, s[28:31], s4 offen sc1
    s_add_u32 s4, s15, 2621440
    buffer_load_dwordx4 v[56:59], v144, s[28:31], s4 offen sc1
    buffer_load_dword v65, v145, s[28:31], s4 offen sc1
    s_add_u32 s4, s15, 5242880
    buffer_load_dwordx4 v[60:63], v144, s[28:31], s4 offen sc1
    buffer_load_dword v66, v145, s[28:31], s4 offen sc1
L_nh_61:
    s_waitcnt lgkmcnt(8)
    v_mfma_f32_16x16x32_bf16 v[32:35], v[236:239], v[8:11], 0
    v_mfma_f32_16x16x32_bf16 v[32:35], v[240:243], v[12:15], v[32:35]
    s_waitcnt lgkmcnt(4)
    v_mfma_f32_16x16x32_bf16 v[36:39], v[236:239], v[16:19], 0
    v_mfma_f32_16x16x32_bf16 v[36:39], v[240:243], v[20:23], v[36:39]
    s_waitcnt lgkmcnt(0)
    v_mfma_f32_16x16x32_bf16 v[40:43], v[236:239], v[24:27], 0
    v_mfma_f32_16x16x32_bf16 v[40:43], v[240:243], v[28:31], v[40:43]
    v_lshlrev_b32 v170, 16, v228
    v_and_b32 v171, 0xffff0000, v228
    v_lshlrev_b32 v172, 16, v229
    v_and_b32 v173, 0xffff0000, v229
    v_lshlrev_b32 v174, 16, v230
    v_and_b32 v175, 0xffff0000, v230
    v_lshlrev_b32 v176, 16, v231
    v_and_b32 v177, 0xffff0000, v231
    v_lshlrev_b32 v178, 16, v244
    v_and_b32 v179, 0xffff0000, v244
    v_cvt_pk_bf16_f32 v32, v32, v33
    v_cvt_pk_bf16_f32 v33, v34, v35
    ds_write_b32 v187, v32
    ds_write_b32 v187, v33 offset:1376
    v_cvt_pk_bf16_f32 v36, v36, v37
    v_cvt_pk_bf16_f32 v37, v38, v39
    ds_write_b32 v188, v36
    ds_write_b32 v188, v37 offset:1376
    v_cvt_pk_bf16_f32 v40, v40, v41
    v_cvt_pk_bf16_f32 v41, v42, v43
    ds_write_b32 v189, v40
    ds_write_b32 v189, v41 offset:1376
    s_waitcnt lgkmcnt(0)
    s_barrier
    ds_read2_b32 v[8:9], v190 offset0:0 offset1:20
    ds_read2_b32 v[10:11], v190 offset0:40 offset1:60
    ds_read2_b32 v[12:13], v191 offset0:60 offset1:40
    ds_read2_b32 v[14:15], v191 offset0:20 offset1:0
    s_waitcnt lgkmcnt(0)
    s_cmp_lg_u32 s17, 0
    s_cbranch_scc1 L_ni_62
    s_add_u32 s8, s24, s16
    s_addc_u32 s9, s25, 0
    s_load_dwordx16 s[32:47], s[8:9], 0 glc
    s_load_dwordx16 s[48:63], s[8:9], 64 glc
    s_load_dwordx16 s[64:79], s[8:9], 128 glc
L_ni_62:
    v_mfma_f32_16x16x32_bf16 v[32:35], v[8:11], v[88:91], 0
    v_mfma_f32_16x16x32_bf16 v[36:39], v[8:11], v[96:99], 0
    v_mfma_f32_16x16x32_bf16 v[32:35], v[12:15], v[92:95], v[32:35]
    v_mfma_f32_16x16x32_bf16 v[36:39], v[12:15], v[100:103], v[36:39]
    v_mfma_f32_16x16x32_bf16 v[40:43], v[8:11], v[104:107], 0
    v_mfma_f32_16x16x32_bf16 v[44:47], v[8:11], v[112:115], 0
    v_mfma_f32_16x16x32_bf16 v[40:43], v[12:15], v[108:111], v[40:43]
    v_mfma_f32_16x16x32_bf16 v[44:47], v[12:15], v[116:119], v[44:47]
    s_nop 3
    v_pk_mul_f32 v[48:49], v[36:37], v[132:133]
    v_pk_mul_f32 v[50:51], v[32:33], v[152:153]
    v_pk_fma_f32 v[32:33], v[32:33], v[128:129], v[48:49]
    v_pk_fma_f32 v[36:37], v[36:37], v[128:129], v[50:51]
    v_pk_mul_f32 v[48:49], v[38:39], v[134:135]
    v_pk_mul_f32 v[50:51], v[34:35], v[154:155]
    v_pk_fma_f32 v[34:35], v[34:35], v[130:131], v[48:49]
    v_pk_fma_f32 v[38:39], v[38:39], v[130:131], v[50:51]
    v_cvt_pk_bf16_f32 v24, v32, v33
    v_cvt_pk_bf16_f32 v25, v34, v35
    v_cvt_pk_bf16_f32 v26, v36, v37
    v_cvt_pk_bf16_f32 v27, v38, v39
    s_nop 1
    v_mfma_f32_16x16x32_bf16 v[32:35], v[24:27], v[120:123], 0
    v_mfma_f32_16x16x32_bf16 v[36:39], v[24:27], v[124:127], 0
    v_pk_mul_f32 v[48:49], v[44:45], v[140:141]
    v_pk_mul_f32 v[50:51], v[40:41], v[156:157]
    v_pk_fma_f32 v[40:41], v[40:41], v[136:137], v[48:49]
    v_pk_fma_f32 v[44:45], v[44:45], v[136:137], v[50:51]
    v_pk_mul_f32 v[48:49], v[46:47], v[142:143]
    v_pk_mul_f32 v[50:51], v[42:43], v[158:159]
    v_pk_fma_f32 v[42:43], v[42:43], v[138:139], v[48:49]
    v_pk_fma_f32 v[46:47], v[46:47], v[138:139], v[50:51]
    v_cvt_pk_bf16_f32 v28, v40, v41
    v_cvt_pk_bf16_f32 v29, v42, v43
    v_cvt_pk_bf16_f32 v30, v44, v45
    v_cvt_pk_bf16_f32 v31, v46, v47
    s_nop 1
    v_mfma_f32_16x16x32_bf16 v[40:43], v[28:31], v[120:123], 0
    v_mfma_f32_16x16x32_bf16 v[44:47], v[28:31], v[124:127], 0
    v_cvt_pk_bf16_f32 v32, v32, v33
    v_cvt_pk_bf16_f32 v33, v34, v35
    ds_write_b64 v192, v[32:33] offset:0
    v_cvt_pk_bf16_f32 v36, v36, v37
    v_cvt_pk_bf16_f32 v37, v38, v39
    ds_write_b64 v192, v[36:37] offset:1024
    s_nop 0
    v_cvt_pk_bf16_f32 v40, v40, v41
    v_cvt_pk_bf16_f32 v41, v42, v43
    ds_write_b64 v182, v[40:41] offset:0
    v_cvt_pk_bf16_f32 v44, v44, v45
    v_cvt_pk_bf16_f32 v45, v46, v47
    ds_write_b64 v182, v[44:45] offset:1024
    s_cmp_lg_u32 s17, 0
    s_cbranch_scc1 L_hp_63
    s_mov_b32 s4, 0x40000
    s_branch L_bc_65
L_bp_64:
    s_add_u32 s8, s24, s16
    s_addc_u32 s9, s25, 0
    s_load_dwordx16 s[32:47], s[8:9], 0 glc
    s_load_dwordx16 s[48:63], s[8:9], 64 glc
    s_load_dwordx16 s[64:79], s[8:9], 128 glc
L_bc_65:
    s_waitcnt lgkmcnt(0)
    s_mov_b64 vcc, s[32:33]
    s_and_b64 vcc, vcc, s[34:35]
    s_or_b64 s[32:33], s[32:33], s[34:35]
    s_and_b64 vcc, vcc, s[36:37]
    s_or_b64 s[32:33], s[32:33], s[36:37]
    s_and_b64 vcc, vcc, s[38:39]
    s_or_b64 s[32:33], s[32:33], s[38:39]
    s_and_b64 vcc, vcc, s[40:41]
    s_or_b64 s[32:33], s[32:33], s[40:41]
    s_and_b64 vcc, vcc, s[42:43]
    s_or_b64 s[32:33], s[32:33], s[42:43]
    s_and_b64 vcc, vcc, s[44:45]
    s_or_b64 s[32:33], s[32:33], s[44:45]
    s_and_b64 vcc, vcc, s[46:47]
    s_or_b64 s[32:33], s[32:33], s[46:47]
    s_and_b64 vcc, vcc, s[48:49]
    s_or_b64 s[32:33], s[32:33], s[48:49]
    s_and_b64 vcc, vcc, s[50:51]
    s_or_b64 s[32:33], s[32:33], s[50:51]
    s_and_b64 vcc, vcc, s[52:53]
    s_or_b64 s[32:33], s[32:33], s[52:53]
    s_and_b64 vcc, vcc, s[54:55]
    s_or_b64 s[32:33], s[32:33], s[54:55]
    s_and_b64 vcc, vcc, s[56:57]
    s_or_b64 s[32:33], s[32:33], s[56:57]
    s_and_b64 vcc, vcc, s[58:59]
    s_or_b64 s[32:33], s[32:33], s[58:59]
    s_and_b64 vcc, vcc, s[60:61]
    s_or_b64 s[32:33], s[32:33], s[60:61]
    s_and_b64 vcc, vcc, s[62:63]
    s_or_b64 s[32:33], s[32:33], s[62:63]
    s_and_b64 vcc, vcc, s[64:65]
    s_or_b64 s[32:33], s[32:33], s[64:65]
    s_and_b64 vcc, vcc, s[66:67]
    s_or_b64 s[32:33], s[32:33], s[66:67]
    s_and_b64 vcc, vcc, s[68:69]
    s_or_b64 s[32:33], s[32:33], s[68:69]
    s_and_b64 vcc, vcc, s[70:71]
    s_or_b64 s[32:33], s[32:33], s[70:71]
    s_and_b64 vcc, vcc, s[72:73]
    s_or_b64 s[32:33], s[32:33], s[72:73]
    s_and_b64 vcc, vcc, s[74:75]
    s_or_b64 s[32:33], s[32:33], s[74:75]
    s_and_b64 vcc, vcc, s[76:77]
    s_or_b64 s[32:33], s[32:33], s[76:77]
    s_and_b64 vcc, vcc, s[78:79]
    s_or_b64 s[32:33], s[32:33], s[78:79]
    s_xor_b64 vcc, vcc, s[10:11]
    s_xor_b64 s[32:33], s[32:33], s[10:11]
    s_or_b64 vcc, vcc, s[32:33]
    s_cbranch_scc0 L_bq_66
    s_sleep 6
    s_sub_u32 s4, s4, 1
    s_cbranch_scc0 L_bp_64
L_bq_66:
    s_add_u32 s4, s15, 0
    buffer_load_dwordx4 v[52:55], v144, s[28:31], s4 offen sc1
    buffer_load_dword v64, v145, s[28:31], s4 offen sc1
    s_add_u32 s4, s15, 2621440
    buffer_load_dwordx4 v[56:59], v144, s[28:31], s4 offen sc1
    buffer_load_dword v65, v145, s[28:31], s4 offen sc1
    s_add_u32 s4, s15, 5242880
    buffer_load_dwordx4 v[60:63], v144, s[28:31], s4 offen sc1
    buffer_load_dword v66, v145, s[28:31], s4 offen sc1
L_hp_63:
    s_waitcnt lgkmcnt(0)
    ds_read_b128 v[232:235], v193
    ds_read_b32 v245, v194 offset:1024
    s_mov_b32 s48, s20
    s_mov_b32 s49, s21
    s_mov_b32 s50, 2621440
    s_mov_b32 s51, 0x20000
    s_waitcnt vmcnt(4)
    v_lshlrev_b32 v68, 16, v52
    v_and_b32 v69, 0xffff0000, v52
    v_lshlrev_b32 v70, 16, v53
    v_and_b32 v71, 0xffff0000, v53
    v_lshlrev_b32 v72, 16, v54
    v_and_b32 v73, 0xffff0000, v54
    v_lshlrev_b32 v74, 16, v55
    v_and_b32 v75, 0xffff0000, v55
    v_lshlrev_b32 v76, 16, v64
    v_and_b32 v77, 0xffff0000, v64
    v_pk_add_f32 v[160:161], v[160:161], v[68:69]
    v_pk_add_f32 v[162:163], v[162:163], v[70:71]
    v_pk_add_f32 v[164:165], v[164:165], v[72:73]
    v_pk_add_f32 v[166:167], v[166:167], v[74:75]
    v_pk_add_f32 v[168:169], v[168:169], v[76:77]
    s_waitcnt vmcnt(2)
    v_lshlrev_b32 v68, 16, v56
    v_and_b32 v69, 0xffff0000, v56
    v_lshlrev_b32 v70, 16, v57
    v_and_b32 v71, 0xffff0000, v57
    v_lshlrev_b32 v72, 16, v58
    v_and_b32 v73, 0xffff0000, v58
    v_lshlrev_b32 v74, 16, v59
    v_and_b32 v75, 0xffff0000, v59
    v_lshlrev_b32 v76, 16, v65
    v_and_b32 v77, 0xffff0000, v65
    v_pk_add_f32 v[160:161], v[160:161], v[68:69]
    v_pk_add_f32 v[162:163], v[162:163], v[70:71]
    v_pk_add_f32 v[164:165], v[164:165], v[72:73]
    v_pk_add_f32 v[166:167], v[166:167], v[74:75]
    v_pk_add_f32 v[168:169], v[168:169], v[76:77]
    s_waitcnt vmcnt(0)
    v_lshlrev_b32 v68, 16, v60
    v_and_b32 v69, 0xffff0000, v60
    v_lshlrev_b32 v70, 16, v61
    v_and_b32 v71, 0xffff0000, v61
    v_lshlrev_b32 v72, 16, v62
    v_and_b32 v73, 0xffff0000, v62
    v_lshlrev_b32 v74, 16, v63
    v_and_b32 v75, 0xffff0000, v63
    v_lshlrev_b32 v76, 16, v66
    v_and_b32 v77, 0xffff0000, v66
    v_pk_add_f32 v[160:161], v[160:161], v[68:69]
    v_pk_add_f32 v[162:163], v[162:163], v[70:71]
    v_pk_add_f32 v[164:165], v[164:165], v[72:73]
    v_pk_add_f32 v[166:167], v[166:167], v[74:75]
    v_pk_add_f32 v[168:169], v[168:169], v[76:77]
    v_mul_f32 v68, 0xbfb8aa3b, v160
    v_mul_f32 v69, 0xbfb8aa3b, v161
    v_mul_f32 v70, 0xbfb8aa3b, v162
    v_mul_f32 v71, 0xbfb8aa3b, v163
    v_mul_f32 v72, 0xbfb8aa3b, v164
    v_mul_f32 v73, 0xbfb8aa3b, v165
    v_mul_f32 v74, 0xbfb8aa3b, v166
    v_mul_f32 v75, 0xbfb8aa3b, v167
    v_mul_f32 v76, 0xbfb8aa3b, v168
    v_mul_f32 v77, 0xbfb8aa3b, v169
    v_exp_f32 v68, v68
    v_exp_f32 v69, v69
    v_exp_f32 v70, v70
    v_exp_f32 v71, v71
    v_exp_f32 v72, v72
    v_exp_f32 v73, v73
    v_exp_f32 v74, v74
    v_exp_f32 v75, v75
    v_exp_f32 v76, v76
    v_exp_f32 v77, v77
    s_waitcnt lgkmcnt(0)
    v_lshlrev_b32 v16, 16, v232
    v_and_b32 v17, 0xffff0000, v232
    v_lshlrev_b32 v18, 16, v233
    v_and_b32 v19, 0xffff0000, v233
    v_lshlrev_b32 v20, 16, v234
    v_and_b32 v21, 0xffff0000, v234
    v_lshlrev_b32 v22, 16, v235
    v_and_b32 v23, 0xffff0000, v235
    v_lshlrev_b32 v24, 16, v245
    v_and_b32 v25, 0xffff0000, v245
    v_pk_add_f32 v[68:69], v[68:69], v[180:181]
    v_pk_add_f32 v[70:71], v[70:71], v[180:181]
    v_pk_add_f32 v[72:73], v[72:73], v[180:181]
    v_pk_add_f32 v[74:75], v[74:75], v[180:181]
    v_pk_add_f32 v[76:77], v[76:77], v[180:181]
    v_pk_mul_f32 v[160:161], v[160:161], v[16:17]
    v_pk_mul_f32 v[162:163], v[162:163], v[18:19]
    v_pk_mul_f32 v[164:165], v[164:165], v[20:21]
    v_pk_mul_f32 v[166:167], v[166:167], v[22:23]
    v_pk_mul_f32 v[168:169], v[168:169], v[24:25]
    v_rcp_f32 v68, v68
    v_rcp_f32 v69, v69
    v_rcp_f32 v70, v70
    v_rcp_f32 v71, v71
    v_rcp_f32 v72, v72
    v_rcp_f32 v73, v73
    v_rcp_f32 v74, v74
    v_rcp_f32 v75, v75
    v_rcp_f32 v76, v76
    v_rcp_f32 v77, v77
    v_pk_fma_f32 v[160:161], v[160:161], v[68:69], v[170:171]
    v_pk_fma_f32 v[162:163], v[162:163], v[70:71], v[172:173]
    v_pk_fma_f32 v[164:165], v[164:165], v[72:73], v[174:175]
    v_pk_fma_f32 v[166:167], v[166:167], v[74:75], v[176:177]
    v_pk_fma_f32 v[168:169], v[168:169], v[76:77], v[178:179]
    v_cvt_pk_bf16_f32 v56, v160, v161
    v_cvt_pk_bf16_f32 v57, v162, v163
    v_cvt_pk_bf16_f32 v58, v164, v165
    v_cvt_pk_bf16_f32 v59, v166, v167
    v_cvt_pk_bf16_f32 v65, v168, v169
    buffer_store_dwordx4 v[56:59], v3, s[48:51], s12 offen sc1
    buffer_store_dword v65, v246, s[48:51], s12 offen offset:1024 sc1
L_exit:
    s_endpgm
.section .rodata,"a"
.p2align 6
.amdhsa_kernel recurrent_scan__spectral_gfnet__mixer_channel_mlp__prompt_kernel
  .amdhsa_next_free_vgpr 256
  .amdhsa_next_free_sgpr 100
  .amdhsa_accum_offset 256
  .amdhsa_group_segment_fixed_size 0
  .amdhsa_kernarg_size 88
  .amdhsa_user_sgpr_count 2
  .amdhsa_user_sgpr_kernarg_segment_ptr 1
  .amdhsa_system_sgpr_workgroup_id_x 1
  .amdhsa_float_denorm_mode_32 3
.end_amdhsa_kernel
.p2align 8
.type ctab,@object
ctab:
.long 0x3f803f80,0x3f803f80,0x3f803f80,0x3f803f80,0x3f733f80,0x3f163f4f,0x3f163e9e,0x3f733f4f
.long 0x3f4f3f80,0xbe9e3e9e,0xbe9ebf4f,0x3f4f3e9e,0x3f163f80,0xbf73be9e,0xbf73bf4f,0x3f16be9e
.long 0x3e9e3f80,0xbf4fbf4f,0xbf4f3e9e,0x3e9ebf4f,0x248d3f80,0xa554bf80,0x248d3f80,0xa554bf80
.long 0xbe9e3f80,0x3f4fbf4f,0x3f4f3e9e,0xbe9ebf4f,0xbf163f80,0x3f73be9e,0x3f73bf4f,0xbf16be9e
.long 0xbf4f3f80,0x3e9e3e9e,0x3e9ebf4f,0xbf4f3e9e,0xbf733f80,0xbf163f4f,0xbf163e9e,0xbf733f4f
.long 0xbf803f80,0xbf803f80,0xbf803f80,0xbf803f80,0xbf733f80,0xbf163f4f,0xbf163e9e,0xbf733f4f
.long 0xbf4f3f80,0x3e9e3e9e,0x3e9ebf4f,0xbf4f3e9e,0xbf163f80,0x3f73be9e,0x3f73bf4f,0xbf16be9e
.long 0xbe9e3f80,0x3f4fbf4f,0x3f4f3e9e,0xbe9ebf4f,0xa5543f80,0x248dbf80,0xa5543f80,0x248dbf80
.long 0x3f803f80,0x3f803f80,0x0,0x0,0x248d3e9e,0xbf16be9e,0x0,0x0
.long 0xbf80bf4f,0xbe9ebf4f,0x0,0x0,0xa554bf4f,0x3f733f4f,0x0,0x0
.long 0x3f803e9e,0xbf4f3e9e,0x0,0x0,0x248d3f80,0xa554bf80,0x0,0x0
.long 0xbf803e9e,0x3f4f3e9e,0x0,0x0,0xa554bf4f,0xbf733f4f,0x0,0x0
.long 0x3f80bf4f,0x3e9ebf4f,0x0,0x0,0x248d3e9e,0x3f16be9e,0x0,0x0
.long 0xbf803f80,0xbf803f80,0x0,0x0,0xa5543e9e,0x3f16be9e,0x0,0x0
.long 0x3f80bf4f,0x3e9ebf4f,0x0,0x0,0x248dbf4f,0xbf733f4f,0x0,0x0
.long 0xbf803e9e,0x3f4f3e9e,0x0,0x0,0xa5543f80,0x248dbf80,0x0,0x0
.long 0x3f803f80,0x3f803f80,0x0,0x0,0xbf73bf4f,0xbf73bf80,0x0,0x0
.long 0x3f4f3e9e,0x3f4f3f80,0x0,0x0,0xbf163e9e,0xbf16bf80,0x0,0x0
.long 0x3e9ebf4f,0x3e9e3f80,0x0,0x0,0x248d3f80,0xa554bf80,0x0,0x0
.long 0xbe9ebf4f,0xbe9e3f80,0x0,0x0,0x3f163e9e,0x3f16bf80,0x0,0x0
.long 0xbf4f3e9e,0xbf4f3f80,0x0,0x0,0x3f73bf4f,0x3f73bf80,0x0,0x0
.long 0xbf803f80,0xbf803f80,0x0,0x0,0x3f73bf4f,0x3f73bf80,0x0,0x0
.long 0xbf4f3e9e,0xbf4f3f80,0x0,0x0,0x3f163e9e,0x3f16bf80,0x0,0x0
.long 0xbe9ebf4f,0xbe9e3f80,0x0,0x0,0xa5543f80,0x248dbf80,0x0,0x0
.long 0x3f803f80,0x3f803f80,0x0,0x0,0xbf16bf4f,0xa554be9e,0x0,0x0
.long 0xbe9e3e9e,0xbf80bf4f,0x0,0x0,0x3f733e9e,0x248d3f4f,0x0,0x0
.long 0xbf4fbf4f,0x3f803e9e,0x0,0x0,0x248d3f80,0xa554bf80,0x0,0x0
.long 0x3f4fbf4f,0xbf803e9e,0x0,0x0,0xbf733e9e,0x248d3f4f,0x0,0x0
.long 0x3e9e3e9e,0x3f80bf4f,0x0,0x0,0x3f16bf4f,0xa554be9e,0x0,0x0
.long 0xbf803f80,0xbf803f80,0x0,0x0,0x3f16bf4f,0x248dbe9e,0x0,0x0
.long 0x3e9e3e9e,0x3f80bf4f,0x0,0x0,0xbf733e9e,0xa5543f4f,0x0,0x0
.long 0x3f4fbf4f,0xbf803e9e,0x0,0x0,0xa5543f80,0x248dbf80,0x0,0x0
.long 0x80008000,0x80008000,0x80008000,0x80008000,0xbe9e8000,0xbf4fbf16,0x3f4f3f73,0x3e9e3f16
.long 0xbf168000,0xbf73bf73,0x3f733f16,0x3f163f73,0xbf4f8000,0xbe9ebf73,0x3e9ebf16,0x3f4f3f73
.long 0xbf738000,0x3f16bf16,0xbf16bf73,0x3f733f16,0xbf808000,0x3f80a50d,0xbf808000,0x3f80a50d
.long 0xbf738000,0x3f163f16,0xbf163f73,0x3f73bf16,0xbf4f8000,0xbe9e3f73,0x3e9e3f16,0x3f4fbf73
.long 0xbf168000,0xbf733f73,0x3f73bf16,0x3f16bf73,0xbe9e8000,0xbf4f3f16,0x3f4fbf73,0x3e9ebf16
.long 0xa50d8000,0xa50d8000,0xa50d8000,0xa50d8000,0x3e9e8000,0x3f4fbf16,0xbf4f3f73,0xbe9e3f16
.long 0x3f168000,0x3f73bf73,0xbf733f16,0xbf163f73,0x3f4f8000,0x3e9ebf73,0xbe9ebf16,0xbf4f3f73
.long 0x3f738000,0xbf16bf16,0x3f16bf73,0xbf733f16,0x3f808000,0xbf80a50d,0x3f808000,0xbf80a50d
.long 0x80008000,0x80008000,0x0,0x0,0xbf80bf73,0xbf4fbf73,0x0,0x0
.long 0xa50dbf16,0x3f733f16,0x0,0x0,0x3f803f16,0xbe9e3f16,0x0,0x0
.long 0x80003f73,0xbf16bf73,0x0,0x0,0xbf808000,0x3f80a50d,0x0,0x0
.long 0xa50dbf73,0xbf163f73,0x0,0x0,0x3f80bf16,0xbe9ebf16,0x0,0x0
.long 0x80003f16,0x3f73bf16,0x0,0x0,0xbf803f73,0xbf4f3f73,0x0,0x0
.long 0xa50d8000,0xa50d8000,0x0,0x0,0x3f80bf73,0x3f4fbf73,0x0,0x0
.long 0x8000bf16,0xbf733f16,0x0,0x0,0xbf803f16,0x3e9e3f16,0x0,0x0
.long 0xa50d3f73,0x3f16bf73,0x0,0x0,0x3f808000,0xbf80a50d,0x0,0x0
.long 0x80008000,0x80008000,0x0,0x0,0xbe9ebf16,0x3e9ea50d,0x0,0x0
.long 0x3f163f73,0xbf168000,0x0,0x0,0xbf4fbf73,0x3f4fa50d,0x0,0x0
.long 0x3f733f16,0xbf738000,0x0,0x0,0xbf808000,0x3f80a50d,0x0,0x0
.long 0x3f73bf16,0xbf738000,0x0,0x0,0xbf4f3f73,0x3f4fa50d,0x0,0x0
.long 0x3f16bf73,0xbf168000,0x0,0x0,0xbe9e3f16,0x3e9ea50d,0x0,0x0
.long 0xa50d8000,0xa50d8000,0x0,0x0,0x3e9ebf16,0xbe9ea50d,0x0,0x0
.long 0xbf163f73,0x3f168000,0x0,0x0,0x3f4fbf73,0xbf4fa50d,0x0,0x0
.long 0xbf733f16,0x3f738000,0x0,0x0,0x3f808000,0xbf80a50d,0x0,0x0
.long 0x80008000,0x80008000,0x0,0x0,0x3f4f3f16,0x3f803f73,0x0,0x0
.long 0xbf73bf73,0xa50dbf16,0x0,0x0,0x3e9e3f73,0xbf80bf16,0x0,0x0
.long 0x3f16bf16,0x80003f73,0x0,0x0,0xbf808000,0x3f80a50d,0x0,0x0
.long 0x3f163f16,0xa50dbf73,0x0,0x0,0x3e9ebf73,0xbf803f16,0x0,0x0
.long 0xbf733f73,0x80003f16,0x0,0x0,0x3f4fbf16,0x3f80bf73,0x0,0x0
.long 0xa50d8000,0xa50d8000,0x0,0x0,0xbf4f3f16,0xbf803f73,0x0,0x0
.long 0x3f73bf73,0x8000bf16,0x0,0x0,0xbe9e3f73,0x3f80bf16,0x0,0x0
.long 0xbf16bf16,0xa50d3f73,0x0,0x0,0x3f808000,0xbf80a50d,0x0,0x0
.long 0x3f803f80,0x3f803f80,0x3f803f80,0x3f803f80,0x3f7b3f80,0x3f553f6d,0xbf7bbf80,0xbf55bf6d
.long 0x3f6d3f80,0x3ec43f35,0x3f6d3f80,0x3ec43f35,0x3f553f80,0xbe483ec4,0xbf55bf80,0x3e48bec4
.long 0x3f353f80,0xbf35248d,0x3f353f80,0xbf35248d,0x3f0e3f80,0xbf7bbec4,0xbf0ebf80,0x3f7b3ec4
.long 0x3ec43f80,0xbf6dbf35,0x3ec43f80,0xbf6dbf35,0x3e483f80,0xbf0ebf6d,0xbe48bf80,0x3f0e3f6d
.long 0x248d3f80,0xa554bf80,0x248d3f80,0xa554bf80,0xbe483f80,0x3f0ebf6d,0x3e48bf80,0xbf0e3f6d
.long 0xbec43f80,0x3f6dbf35,0xbec43f80,0x3f6dbf35,0xbf0e3f80,0x3f7bbec4,0x3f0ebf80,0xbf7b3ec4
.long 0xbf353f80,0x3f35a554,0xbf353f80,0x3f35a554,0xbf553f80,0x3e483ec4,0x3f55bf80,0xbe48bec4
.long 0xbf6d3f80,0xbec43f35,0xbf6d3f80,0xbec43f35,0xbf7b3f80,0xbf553f6d,0x3f7bbf80,0x3f55bf6d
.long 0x3f803f80,0x3f803f80,0x3f803f80,0x3f803f80,0x3f0e3f35,0x3e483ec4,0xbf0ebf35,0xbe48bec4
.long 0xbec4248d,0xbf6dbf35,0xbec4248d,0xbf6dbf35,0xbf7bbf35,0xbf0ebf6d,0x3f7b3f35,0x3f0e3f6d
.long 0xbf35bf80,0x3f35a554,0xbf35bf80,0x3f35a554,0x3e48bf35,0x3f553f6d,0xbe483f35,0xbf55bf6d
.long 0x3f6da554,0xbec43f35,0x3f6da554,0xbec43f35,0x3f553f35,0xbf7bbec4,0xbf55bf35,0x3f7b3ec4
.long 0x248d3f80,0xa554bf80,0x248d3f80,0xa554bf80,0xbf553f35,0x3f7bbec4,0x3f55bf35,0xbf7b3ec4
.long 0xbf6d248d,0x3ec43f35,0xbf6d248d,0x3ec43f35,0xbe48bf35,0xbf553f6d,0x3e483f35,0x3f55bf6d
.long 0x3f35bf80,0xbf35248d,0x3f35bf80,0xbf35248d,0x3f7bbf35,0x3f0ebf6d,0xbf7b3f35,0xbf0e3f6d
.long 0x3ec4a554,0x3f6dbf35,0x3ec4a554,0x3f6dbf35,0xbf0e3f35,0xbe483ec4,0x3f0ebf35,0x3e48bec4
.long 0x3f803f80,0x3f803f80,0x3f803f80,0x3f803f80,0xbe48248d,0xbf0ebec4,0x3e48a554,0x3f0e3ec4
.long 0xbf6dbf80,0xbec4bf35,0xbf6dbf80,0xbec4bf35,0x3f0ea554,0x3f7b3f6d,0xbf0e248d,0xbf7bbf6d
.long 0x3f353f80,0xbf35248d,0x3f353f80,0xbf35248d,0xbf55248d,0xbe48bf6d,0x3f55a554,0x3e483f6d
.long 0xbec4bf80,0x3f6d3f35,0xbec4bf80,0x3f6d3f35,0x3f7ba554,0xbf553ec4,0xbf7b248d,0x3f55bec4
.long 0x248d3f80,0xa554bf80,0x248d3f80,0xa554bf80,0xbf7b248d,0x3f553ec4,0x3f7ba554,0xbf55bec4
.long 0x3ec4bf80,0xbf6d3f35,0x3ec4bf80,0xbf6d3f35,0x3f55a554,0x3e48bf6d,0xbf55248d,0xbe483f6d
.long 0xbf353f80,0x3f35a554,0xbf353f80,0x3f35a554,0xbf0e248d,0xbf7b3f6d,0x3f0ea554,0x3f7bbf6d
.long 0x3f6dbf80,0x3ec4bf35,0x3f6dbf80,0x3ec4bf35,0x3e48a554,0x3f0ebec4,0xbe48248d,0xbf0e3ec4
.long 0x3f803f80,0x3f803f80,0x3f803f80,0x3f803f80,0xbf55bf35,0xbf7bbf6d,0x3f553f35,0x3f7b3f6d
.long 0x3ec4a554,0x3f6d3f35,0x3ec4a554,0x3f6d3f35,0x3e483f35,0xbf55bec4,0xbe48bf35,0x3f553ec4
.long 0xbf35bf80,0x3f35a554,0xbf35bf80,0x3f35a554,0x3f7b3f35,0xbf0e3ec4,0xbf7bbf35,0x3f0ebec4
.long 0xbf6d248d,0x3ec4bf35,0xbf6d248d,0x3ec4bf35,0x3f0ebf35,0xbe483f6d,0xbf0e3f35,0x3e48bf6d
.long 0x248d3f80,0xa554bf80,0x248d3f80,0xa554bf80,0xbf0ebf35,0x3e483f6d,0x3f0e3f35,0xbe48bf6d
.long 0x3f6da554,0xbec4bf35,0x3f6da554,0xbec4bf35,0xbf7b3f35,0x3f0e3ec4,0x3f7bbf35,0xbf0ebec4
.long 0x3f35bf80,0xbf35248d,0x3f35bf80,0xbf35248d,0xbe483f35,0x3f55bec4,0x3e48bf35,0xbf553ec4
.long 0xbec4248d,0xbf6d3f35,0xbec4248d,0xbf6d3f35,0x3f55bf35,0x3f7bbf6d,0xbf553f35,0xbf7b3f6d
.long 0x0,0x0,0x0,0x0,0x3e480000,0x3f0e3ec4,0xbe48250d,0xbf0ebec4
.long 0x3ec40000,0x3f6d3f35,0x3ec40000,0x3f6d3f35,0x3f0e0000,0x3f7b3f6d,0xbf0e250d,0xbf7bbf6d
.long 0x3f350000,0x3f353f80,0x3f350000,0x3f353f80,0x3f550000,0x3e483f6d,0xbf55250d,0xbe48bf6d
.long 0x3f6d0000,0xbec43f35,0x3f6d0000,0xbec43f35,0x3f7b0000,0xbf553ec4,0xbf7b250d,0x3f55bec4
.long 0x3f800000,0xbf80250d,0x3f800000,0xbf80250d,0x3f7b0000,0xbf55bec4,0xbf7b250d,0x3f553ec4
.long 0x3f6d0000,0xbec4bf35,0x3f6d0000,0xbec4bf35,0x3f550000,0x3e48bf6d,0xbf55250d,0xbe483f6d
.long 0x3f350000,0x3f35bf80,0x3f350000,0x3f35bf80,0x3f0e0000,0x3f7bbf6d,0xbf0e250d,0xbf7b3f6d
.long 0x3ec40000,0x3f6dbf35,0x3ec40000,0x3f6dbf35,0x3e480000,0x3f0ebec4,0xbe48250d,0xbf0e3ec4
.long 0x0,0x0,0x0,0x0,0x3f553f35,0x3f7b3f6d,0xbf55bf35,0xbf7bbf6d
.long 0x3f6d3f80,0x3ec43f35,0x3f6d3f80,0x3ec43f35,0x3e483f35,0xbf55bec4,0xbe48bf35,0x3f553ec4
.long 0xbf35250d,0xbf35bf80,0xbf35250d,0xbf35bf80,0xbf7bbf35,0x3f0ebec4,0x3f7b3f35,0xbf0e3ec4
.long 0xbec4bf80,0x3f6d3f35,0xbec4bf80,0x3f6d3f35,0x3f0ebf35,0xbe483f6d,0xbf0e3f35,0x3e48bf6d
.long 0x3f800000,0xbf80250d,0x3f800000,0xbf80250d,0x3f0e3f35,0xbe48bf6d,0xbf0ebf35,0x3e483f6d
.long 0xbec43f80,0x3f6dbf35,0xbec43f80,0x3f6dbf35,0xbf7b3f35,0x3f0e3ec4,0x3f7bbf35,0xbf0ebec4
.long 0xbf35250d,0xbf353f80,0xbf35250d,0xbf353f80,0x3e48bf35,0xbf553ec4,0xbe483f35,0x3f55bec4
.long 0x3f6dbf80,0x3ec4bf35,0x3f6dbf80,0x3ec4bf35,0x3f55bf35,0x3f7bbf6d,0xbf553f35,0xbf7b3f6d
.long 0x0,0x0,0x0,0x0,0x3f7b3f80,0x3f553f6d,0xbf7bbf80,0xbf55bf6d
.long 0xbec4250d,0xbf6dbf35,0xbec4250d,0xbf6dbf35,0xbf55bf80,0x3e48bec4,0x3f553f80,0xbe483ec4
.long 0x3f350000,0x3f353f80,0x3f350000,0x3f353f80,0x3f0e3f80,0xbf7bbec4,0xbf0ebf80,0x3f7b3ec4
.long 0xbf6d250d,0x3ec4bf35,0xbf6d250d,0x3ec4bf35,0xbe48bf80,0x3f0e3f6d,0x3e483f80,0xbf0ebf6d
.long 0x3f800000,0xbf80250d,0x3f800000,0xbf80250d,0xbe483f80,0x3f0ebf6d,0x3e48bf80,0xbf0e3f6d
.long 0xbf6d250d,0x3ec43f35,0xbf6d250d,0x3ec43f35,0x3f0ebf80,0xbf7b3ec4,0xbf0e3f80,0x3f7bbec4
.long 0x3f350000,0x3f35bf80,0x3f350000,0x3f35bf80,0xbf553f80,0x3e483ec4,0x3f55bf80,0xbe48bec4
.long 0xbec4250d,0xbf6d3f35,0xbec4250d,0xbf6d3f35,0x3f7bbf80,0x3f55bf6d,0xbf7b3f80,0xbf553f6d
.long 0x0,0x0,0x0,0x0,0x3f0e3f35,0x3e483ec4,0xbf0ebf35,0xbe48bec4
.long 0xbf6dbf80,0xbec4bf35,0xbf6dbf80,0xbec4bf35,0x3f7b3f35,0x3f0e3f6d,0xbf7bbf35,0xbf0ebf6d
.long 0xbf35250d,0xbf35bf80,0xbf35250d,0xbf35bf80,0x3e48bf35,0x3f553f6d,0xbe483f35,0xbf55bf6d
.long 0x3ec43f80,0xbf6dbf35,0x3ec43f80,0xbf6dbf35,0xbf55bf35,0x3f7b3ec4,0x3f553f35,0xbf7bbec4
.long 0x3f800000,0xbf80250d,0x3f800000,0xbf80250d,0xbf553f35,0x3f7bbec4,0x3f55bf35,0xbf7b3ec4
.long 0x3ec4bf80,0xbf6d3f35,0x3ec4bf80,0xbf6d3f35,0x3e483f35,0x3f55bf6d,0xbe48bf35,0xbf553f6d
.long 0xbf35250d,0xbf353f80,0xbf35250d,0xbf353f80,0x3f7bbf35,0x3f0ebf6d,0xbf7b3f35,0xbf0e3f6d
.long 0xbf6d3f80,0xbec43f35,0xbf6d3f80,0xbec43f35,0x3f0ebf35,0x3e48bec4,0xbf0e3f35,0xbe483ec4
.long 0x80008000,0x80008000,0x80008000,0x80008000,0xbe488000,0xbf0ebec4,0x3e48a50d,0x3f0e3ec4
.long 0xbec48000,0xbf6dbf35,0xbec48000,0xbf6dbf35,0xbf0e8000,0xbf7bbf6d,0x3f0ea50d,0x3f7b3f6d
.long 0xbf358000,0xbf35bf80,0xbf358000,0xbf35bf80,0xbf558000,0xbe48bf6d,0x3f55a50d,0x3e483f6d
.long 0xbf6d8000,0x3ec4bf35,0xbf6d8000,0x3ec4bf35,0xbf7b8000,0x3f55bec4,0x3f7ba50d,0xbf553ec4
.long 0xbf808000,0x3f80a50d,0xbf808000,0x3f80a50d,0xbf7b8000,0x3f553ec4,0x3f7ba50d,0xbf55bec4
.long 0xbf6d8000,0x3ec43f35,0xbf6d8000,0x3ec43f35,0xbf558000,0xbe483f6d,0x3f55a50d,0x3e48bf6d
.long 0xbf358000,0xbf353f80,0xbf358000,0xbf353f80,0xbf0e8000,0xbf7b3f6d,0x3f0ea50d,0x3f7bbf6d
.long 0xbec48000,0xbf6d3f35,0xbec48000,0xbf6d3f35,0xbe488000,0xbf0e3ec4,0x3e48a50d,0x3f0ebec4
.long 0x80008000,0x80008000,0x80008000,0x80008000,0xbf55bf35,0xbf7bbf6d,0x3f553f35,0x3f7b3f6d
.long 0xbf6dbf80,0xbec4bf35,0xbf6dbf80,0xbec4bf35,0xbe48bf35,0x3f553ec4,0x3e483f35,0xbf55bec4
.long 0x3f35a50d,0x3f353f80,0x3f35a50d,0x3f353f80,0x3f7b3f35,0xbf0e3ec4,0xbf7bbf35,0x3f0ebec4
.long 0x3ec43f80,0xbf6dbf35,0x3ec43f80,0xbf6dbf35,0xbf0e3f35,0x3e48bf6d,0x3f0ebf35,0xbe483f6d
.long 0xbf808000,0x3f80a50d,0xbf808000,0x3f80a50d,0xbf0ebf35,0x3e483f6d,0x3f0e3f35,0xbe48bf6d
.long 0x3ec4bf80,0xbf6d3f35,0x3ec4bf80,0xbf6d3f35,0x3f7bbf35,0xbf0ebec4,0xbf7b3f35,0x3f0e3ec4
.long 0x3f35a50d,0x3f35bf80,0x3f35a50d,0x3f35bf80,0xbe483f35,0x3f55bec4,0x3e48bf35,0xbf553ec4
.long 0xbf6d3f80,0xbec43f35,0xbf6d3f80,0xbec43f35,0xbf553f35,0xbf7b3f6d,0x3f55bf35,0x3f7bbf6d
.long 0x80008000,0x80008000,0x80008000,0x80008000,0xbf7bbf80,0xbf55bf6d,0x3f7b3f80,0x3f553f6d
.long 0x3ec4a50d,0x3f6d3f35,0x3ec4a50d,0x3f6d3f35,0x3f553f80,0xbe483ec4,0xbf55bf80,0x3e48bec4
.long 0xbf358000,0xbf35bf80,0xbf358000,0xbf35bf80,0xbf0ebf80,0x3f7b3ec4,0x3f0e3f80,0xbf7bbec4
.long 0x3f6da50d,0xbec43f35,0x3f6da50d,0xbec43f35,0x3e483f80,0xbf0ebf6d,0xbe48bf80,0x3f0e3f6d
.long 0xbf808000,0x3f80a50d,0xbf808000,0x3f80a50d,0x3e48bf80,0xbf0e3f6d,0xbe483f80,0x3f0ebf6d
.long 0x3f6da50d,0xbec4bf35,0x3f6da50d,0xbec4bf35,0xbf0e3f80,0x3f7bbec4,0x3f0ebf80,0xbf7b3ec4
.long 0xbf358000,0xbf353f80,0xbf358000,0xbf353f80,0x3f55bf80,0xbe48bec4,0xbf553f80,0x3e483ec4
.long 0x3ec4a50d,0x3f6dbf35,0x3ec4a50d,0x3f6dbf35,0xbf7b3f80,0xbf553f6d,0x3f7bbf80,0x3f55bf6d
.long 0x80008000,0x80008000,0x80008000,0x80008000,0xbf0ebf35,0xbe48bec4,0x3f0e3f35,0x3e483ec4
.long 0x3f6d3f80,0x3ec43f35,0x3f6d3f80,0x3ec43f35,0xbf7bbf35,0xbf0ebf6d,0x3f7b3f35,0x3f0e3f6d
.long 0x3f35a50d,0x3f353f80,0x3f35a50d,0x3f353f80,0xbe483f35,0xbf55bf6d,0x3e48bf35,0x3f553f6d
.long 0xbec4bf80,0x3f6d3f35,0xbec4bf80,0x3f6d3f35,0x3f553f35,0xbf7bbec4,0xbf55bf35,0x3f7b3ec4
.long 0xbf808000,0x3f80a50d,0xbf808000,0x3f80a50d,0x3f55bf35,0xbf7b3ec4,0xbf553f35,0x3f7bbec4
.long 0xbec43f80,0x3f6dbf35,0xbec43f80,0x3f6dbf35,0xbe48bf35,0xbf553f6d,0x3e483f35,0x3f55bf6d
.long 0x3f35a50d,0x3f35bf80,0x3f35a50d,0x3f35bf80,0xbf7b3f35,0xbf0e3f6d,0x3f7bbf35,0x3f0ebf6d
.long 0x3f6dbf80,0x3ec4bf35,0x3f6dbf80,0x3ec4bf35,0xbf0e3f35,0xbe483ec4,0x3f0ebf35,0x3e48bec4
.long 0x3f803f80,0x3f803f80,0x3f803f80,0x3f803f80,0x3f7b3f80,0x3f553f6d,0xbf7bbf80,0xbf55bf6d
.long 0x3f6d3f80,0x3ec43f35,0x3f6d3f80,0x3ec43f35,0x3f553f80,0xbe483ec4,0xbf55bf80,0x3e48bec4
.long 0x3f353f80,0xbf35248d,0x3f353f80,0xbf35248d,0x3f0e3f80,0xbf7bbec4,0xbf0ebf80,0x3f7b3ec4
.long 0x3ec43f80,0xbf6dbf35,0x3ec43f80,0xbf6dbf35,0x3e483f80,0xbf0ebf6d,0xbe48bf80,0x3f0e3f6d
.long 0x248d3f80,0xa554bf80,0x248d3f80,0xa554bf80,0xbe483f80,0x3f0ebf6d,0x3e48bf80,0xbf0e3f6d
.long 0xbec43f80,0x3f6dbf35,0xbec43f80,0x3f6dbf35,0xbf0e3f80,0x3f7bbec4,0x3f0ebf80,0xbf7b3ec4
.long 0xbf353f80,0x3f35a554,0xbf353f80,0x3f35a554,0xbf553f80,0x3e483ec4,0x3f55bf80,0xbe48bec4
.long 0xbf6d3f80,0xbec43f35,0xbf6d3f80,0xbec43f35,0xbf7b3f80,0xbf553f6d,0x3f7bbf80,0x3f55bf6d
.long 0x3f803f80,0x3f803f80,0x3f803f80,0x3f803f80,0x3f0e3f35,0x3e483ec4,0xbf0ebf35,0xbe48bec4
.long 0xbec4248d,0xbf6dbf35,0xbec4248d,0xbf6dbf35,0xbf7bbf35,0xbf0ebf6d,0x3f7b3f35,0x3f0e3f6d
.long 0xbf35bf80,0x3f35a554,0xbf35bf80,0x3f35a554,0x3e48bf35,0x3f553f6d,0xbe483f35,0xbf55bf6d
.long 0x3f6da554,0xbec43f35,0x3f6da554,0xbec43f35,0x3f553f35,0xbf7bbec4,0xbf55bf35,0x3f7b3ec4
.long 0x248d3f80,0xa554bf80,0x248d3f80,0xa554bf80,0xbf553f35,0x3f7bbec4,0x3f55bf35,0xbf7b3ec4
.long 0xbf6d248d,0x3ec43f35,0xbf6d248d,0x3ec43f35,0xbe48bf35,0xbf553f6d,0x3e483f35,0x3f55bf6d
.long 0x3f35bf80,0xbf35248d,0x3f35bf80,0xbf35248d,0x3f7bbf35,0x3f0ebf6d,0xbf7b3f35,0xbf0e3f6d
.long 0x3ec4a554,0x3f6dbf35,0x3ec4a554,0x3f6dbf35,0xbf0e3f35,0xbe483ec4,0x3f0ebf35,0x3e48bec4
.long 0x3f803f80,0x3f803f80,0x3f803f80,0x3f803f80,0xbe48248d,0xbf0ebec4,0x3e48a554,0x3f0e3ec4
.long 0xbf6dbf80,0xbec4bf35,0xbf6dbf80,0xbec4bf35,0x3f0ea554,0x3f7b3f6d,0xbf0e248d,0xbf7bbf6d
.long 0x3f353f80,0xbf35248d,0x3f353f80,0xbf35248d,0xbf55248d,0xbe48bf6d,0x3f55a554,0x3e483f6d
.long 0xbec4bf80,0x3f6d3f35,0xbec4bf80,0x3f6d3f35,0x3f7ba554,0xbf553ec4,0xbf7b248d,0x3f55bec4
.long 0x248d3f80,0xa554bf80,0x248d3f80,0xa554bf80,0xbf7b248d,0x3f553ec4,0x3f7ba554,0xbf55bec4
.long 0x3ec4bf80,0xbf6d3f35,0x3ec4bf80,0xbf6d3f35,0x3f55a554,0x3e48bf6d,0xbf55248d,0xbe483f6d
.long 0xbf353f80,0x3f35a554,0xbf353f80,0x3f35a554,0xbf0e248d,0xbf7b3f6d,0x3f0ea554,0x3f7bbf6d
.long 0x3f6dbf80,0x3ec4bf35,0x3f6dbf80,0x3ec4bf35,0x3e48a554,0x3f0ebec4,0xbe48248d,0xbf0e3ec4
.long 0x3f803f80,0x3f803f80,0x3f803f80,0x3f803f80,0xbf55bf35,0xbf7bbf6d,0x3f553f35,0x3f7b3f6d
.long 0x3ec4a554,0x3f6d3f35,0x3ec4a554,0x3f6d3f35,0x3e483f35,0xbf55bec4,0xbe48bf35,0x3f553ec4
.long 0xbf35bf80,0x3f35a554,0xbf35bf80,0x3f35a554,0x3f7b3f35,0xbf0e3ec4,0xbf7bbf35,0x3f0ebec4
.long 0xbf6d248d,0x3ec4bf35,0xbf6d248d,0x3ec4bf35,0x3f0ebf35,0xbe483f6d,0xbf0e3f35,0x3e48bf6d
.long 0x248d3f80,0xa554bf80,0x248d3f80,0xa554bf80,0xbf0ebf35,0x3e483f6d,0x3f0e3f35,0xbe48bf6d
.long 0x3f6da554,0xbec4bf35,0x3f6da554,0xbec4bf35,0xbf7b3f35,0x3f0e3ec4,0x3f7bbf35,0xbf0ebec4
.long 0x3f35bf80,0xbf35248d,0x3f35bf80,0xbf35248d,0xbe483f35,0x3f55bec4,0x3e48bf35,0xbf553ec4
.long 0xbec4248d,0xbf6d3f35,0xbec4248d,0xbf6d3f35,0x3f55bf35,0x3f7bbf6d,0xbf553f35,0xbf7b3f6d
.long 0xbf803f80,0xbf803f80,0xbf803f80,0xbf803f80,0xbf7b3f80,0xbf553f6d,0x3f7bbf80,0x3f55bf6d
.long 0xbf6d3f80,0xbec43f35,0xbf6d3f80,0xbec43f35,0xbf553f80,0x3e483ec4,0x3f55bf80,0xbe48bec4
.long 0xbf353f80,0x3f35248d,0xbf353f80,0x3f35248d,0xbf0e3f80,0x3f7bbec4,0x3f0ebf80,0xbf7b3ec4
.long 0xbec43f80,0x3f6dbf35,0xbec43f80,0x3f6dbf35,0xbe483f80,0x3f0ebf6d,0x3e48bf80,0xbf0e3f6d
.long 0xa5543f80,0x248dbf80,0xa5543f80,0x248dbf80,0x3e483f80,0xbf0ebf6d,0xbe48bf80,0x3f0e3f6d
.long 0x3ec43f80,0xbf6dbf35,0x3ec43f80,0xbf6dbf35,0x3f0e3f80,0xbf7bbec4,0xbf0ebf80,0x3f7b3ec4
.long 0x3f353f80,0xbf35a554,0x3f353f80,0xbf35a554,0x3f553f80,0xbe483ec4,0xbf55bf80,0x3e48bec4
.long 0x3f6d3f80,0x3ec43f35,0x3f6d3f80,0x3ec43f35,0x3f7b3f80,0x3f553f6d,0xbf7bbf80,0xbf55bf6d
.long 0xbf803f80,0xbf803f80,0xbf803f80,0xbf803f80,0xbf0e3f35,0xbe483ec4,0x3f0ebf35,0x3e48bec4
.long 0x3ec4248d,0x3f6dbf35,0x3ec4248d,0x3f6dbf35,0x3f7bbf35,0x3f0ebf6d,0xbf7b3f35,0xbf0e3f6d
.long 0x3f35bf80,0xbf35a554,0x3f35bf80,0xbf35a554,0xbe48bf35,0xbf553f6d,0x3e483f35,0x3f55bf6d
.long 0xbf6da554,0x3ec43f35,0xbf6da554,0x3ec43f35,0xbf553f35,0x3f7bbec4,0x3f55bf35,0xbf7b3ec4
.long 0xa5543f80,0x248dbf80,0xa5543f80,0x248dbf80,0x3f553f35,0xbf7bbec4,0xbf55bf35,0x3f7b3ec4
.long 0x3f6d248d,0xbec43f35,0x3f6d248d,0xbec43f35,0x3e48bf35,0x3f553f6d,0xbe483f35,0xbf55bf6d
.long 0xbf35bf80,0x3f35248d,0xbf35bf80,0x3f35248d,0xbf7bbf35,0xbf0ebf6d,0x3f7b3f35,0x3f0e3f6d
.long 0xbec4a554,0xbf6dbf35,0xbec4a554,0xbf6dbf35,0x3f0e3f35,0x3e483ec4,0xbf0ebf35,0xbe48bec4
.long 0xbf803f80,0xbf803f80,0xbf803f80,0xbf803f80,0x3e48248d,0x3f0ebec4,0xbe48a554,0xbf0e3ec4
.long 0x3f6dbf80,0x3ec4bf35,0x3f6dbf80,0x3ec4bf35,0xbf0ea554,0xbf7b3f6d,0x3f0e248d,0x3f7bbf6d
.long 0xbf353f80,0x3f35248d,0xbf353f80,0x3f35248d,0x3f55248d,0x3e48bf6d,0xbf55a554,0xbe483f6d
.long 0x3ec4bf80,0xbf6d3f35,0x3ec4bf80,0xbf6d3f35,0xbf7ba554,0x3f553ec4,0x3f7b248d,0xbf55bec4
.long 0xa5543f80,0x248dbf80,0xa5543f80,0x248dbf80,0x3f7b248d,0xbf553ec4,0xbf7ba554,0x3f55bec4
.long 0xbec4bf80,0x3f6d3f35,0xbec4bf80,0x3f6d3f35,0xbf55a554,0xbe48bf6d,0x3f55248d,0x3e483f6d
.long 0x3f353f80,0xbf35a554,0x3f353f80,0xbf35a554,0x3f0e248d,0x3f7b3f6d,0xbf0ea554,0xbf7bbf6d
.long 0xbf6dbf80,0xbec4bf35,0xbf6dbf80,0xbec4bf35,0xbe48a554,0xbf0ebec4,0x3e48248d,0x3f0e3ec4
.long 0xbf803f80,0xbf803f80,0xbf803f80,0xbf803f80,0x3f55bf35,0x3f7bbf6d,0xbf553f35,0xbf7b3f6d
.long 0xbec4a554,0xbf6d3f35,0xbec4a554,0xbf6d3f35,0xbe483f35,0x3f55bec4,0x3e48bf35,0xbf553ec4
.long 0x3f35bf80,0xbf35a554,0x3f35bf80,0xbf35a554,0xbf7b3f35,0x3f0e3ec4,0x3f7bbf35,0xbf0ebec4
.long 0x3f6d248d,0xbec4bf35,0x3f6d248d,0xbec4bf35,0xbf0ebf35,0x3e483f6d,0x3f0e3f35,0xbe48bf6d
.long 0xa5543f80,0x248dbf80,0xa5543f80,0x248dbf80,0x3f0ebf35,0xbe483f6d,0xbf0e3f35,0x3e48bf6d
.long 0xbf6da554,0x3ec4bf35,0xbf6da554,0x3ec4bf35,0x3f7b3f35,0xbf0e3ec4,0xbf7bbf35,0x3f0ebec4
.long 0xbf35bf80,0x3f35248d,0xbf35bf80,0x3f35248d,0x3e483f35,0xbf55bec4,0xbe48bf35,0x3f553ec4
.long 0x3ec4248d,0x3f6d3f35,0x3ec4248d,0x3f6d3f35,0xbf55bf35,0xbf7bbf6d,0x3f553f35,0x3f7b3f6d
.long 0x250d0000,0x250d0000,0x250d0000,0x250d0000,0xbe480000,0xbf0e3ec4,0x3e48250d,0x3f0ebec4
.long 0xbec40000,0xbf6d3f35,0xbec40000,0xbf6d3f35,0xbf0e0000,0xbf7b3f6d,0x3f0e250d,0x3f7bbf6d
.long 0xbf350000,0xbf353f80,0xbf350000,0xbf353f80,0xbf550000,0xbe483f6d,0x3f55250d,0x3e48bf6d
.long 0xbf6d0000,0x3ec43f35,0xbf6d0000,0x3ec43f35,0xbf7b0000,0x3f553ec4,0x3f7b250d,0xbf55bec4
.long 0xbf800000,0x3f80250d,0xbf800000,0x3f80250d,0xbf7b0000,0x3f55bec4,0x3f7b250d,0xbf553ec4
.long 0xbf6d0000,0x3ec4bf35,0xbf6d0000,0x3ec4bf35,0xbf550000,0xbe48bf6d,0x3f55250d,0x3e483f6d
.long 0xbf350000,0xbf35bf80,0xbf350000,0xbf35bf80,0xbf0e0000,0xbf7bbf6d,0x3f0e250d,0x3f7b3f6d
.long 0xbec40000,0xbf6dbf35,0xbec40000,0xbf6dbf35,0xbe480000,0xbf0ebec4,0x3e48250d,0x3f0e3ec4
.long 0x250d0000,0x250d0000,0x250d0000,0x250d0000,0xbf553f35,0xbf7b3f6d,0x3f55bf35,0x3f7bbf6d
.long 0xbf6d3f80,0xbec43f35,0xbf6d3f80,0xbec43f35,0xbe483f35,0x3f55bec4,0x3e48bf35,0xbf553ec4
.long 0x3f35250d,0x3f35bf80,0x3f35250d,0x3f35bf80,0x3f7bbf35,0xbf0ebec4,0xbf7b3f35,0x3f0e3ec4
.long 0x3ec4bf80,0xbf6d3f35,0x3ec4bf80,0xbf6d3f35,0xbf0ebf35,0x3e483f6d,0x3f0e3f35,0xbe48bf6d
.long 0xbf800000,0x3f80250d,0xbf800000,0x3f80250d,0xbf0e3f35,0x3e48bf6d,0x3f0ebf35,0xbe483f6d
.long 0x3ec43f80,0xbf6dbf35,0x3ec43f80,0xbf6dbf35,0x3f7b3f35,0xbf0e3ec4,0xbf7bbf35,0x3f0ebec4
.long 0x3f35250d,0x3f353f80,0x3f35250d,0x3f353f80,0xbe48bf35,0x3f553ec4,0x3e483f35,0xbf55bec4
.long 0xbf6dbf80,0xbec4bf35,0xbf6dbf80,0xbec4bf35,0xbf55bf35,0xbf7bbf6d,0x3f553f35,0x3f7b3f6d
.long 0x250d0000,0x250d0000,0x250d0000,0x250d0000,0xbf7b3f80,0xbf553f6d,0x3f7bbf80,0x3f55bf6d
.long 0x3ec4250d,0x3f6dbf35,0x3ec4250d,0x3f6dbf35,0x3f55bf80,0xbe48bec4,0xbf553f80,0x3e483ec4
.long 0xbf350000,0xbf353f80,0xbf350000,0xbf353f80,0xbf0e3f80,0x3f7bbec4,0x3f0ebf80,0xbf7b3ec4
.long 0x3f6d250d,0xbec4bf35,0x3f6d250d,0xbec4bf35,0x3e48bf80,0xbf0e3f6d,0xbe483f80,0x3f0ebf6d
.long 0xbf800000,0x3f80250d,0xbf800000,0x3f80250d,0x3e483f80,0xbf0ebf6d,0xbe48bf80,0x3f0e3f6d
.long 0x3f6d250d,0xbec43f35,0x3f6d250d,0xbec43f35,0xbf0ebf80,0x3f7b3ec4,0x3f0e3f80,0xbf7bbec4
.long 0xbf350000,0xbf35bf80,0xbf350000,0xbf35bf80,0x3f553f80,0xbe483ec4,0xbf55bf80,0x3e48bec4
.long 0x3ec4250d,0x3f6d3f35,0x3ec4250d,0x3f6d3f35,0xbf7bbf80,0xbf55bf6d,0x3f7b3f80,0x3f553f6d
.long 0x250d0000,0x250d0000,0x250d0000,0x250d0000,0xbf0e3f35,0xbe483ec4,0x3f0ebf35,0x3e48bec4
.long 0x3f6dbf80,0x3ec4bf35,0x3f6dbf80,0x3ec4bf35,0xbf7b3f35,0xbf0e3f6d,0x3f7bbf35,0x3f0ebf6d
.long 0x3f35250d,0x3f35bf80,0x3f35250d,0x3f35bf80,0xbe48bf35,0xbf553f6d,0x3e483f35,0x3f55bf6d
.long 0xbec43f80,0x3f6dbf35,0xbec43f80,0x3f6dbf35,0x3f55bf35,0xbf7b3ec4,0xbf553f35,0x3f7bbec4
.long 0xbf800000,0x3f80250d,0xbf800000,0x3f80250d,0x3f553f35,0xbf7bbec4,0xbf55bf35,0x3f7b3ec4
.long 0xbec4bf80,0x3f6d3f35,0xbec4bf80,0x3f6d3f35,0xbe483f35,0xbf55bf6d,0x3e48bf35,0x3f553f6d
.long 0x3f35250d,0x3f353f80,0x3f35250d,0x3f353f80,0xbf7bbf35,0xbf0ebf6d,0x3f7b3f35,0x3f0e3f6d
.long 0x3f6d3f80,0x3ec43f35,0x3f6d3f80,0x3ec43f35,0xbf0ebf35,0xbe48bec4,0x3f0e3f35,0x3e483ec4
.long 0x250d0000,0x250d0000,0x250d0000,0x250d0000,0xbe480000,0xbf0e3ec4,0x3e48250d,0x3f0ebec4
.long 0xbec40000,0xbf6d3f35,0xbec40000,0xbf6d3f35,0xbf0e0000,0xbf7b3f6d,0x3f0e250d,0x3f7bbf6d
.long 0xbf350000,0xbf353f80,0xbf350000,0xbf353f80,0xbf550000,0xbe483f6d,0x3f55250d,0x3e48bf6d
.long 0xbf6d0000,0x3ec43f35,0xbf6d0000,0x3ec43f35,0xbf7b0000,0x3f553ec4,0x3f7b250d,0xbf55bec4
.long 0xbf800000,0x3f80250d,0xbf800000,0x3f80250d,0xbf7b0000,0x3f55bec4,0x3f7b250d,0xbf553ec4
.long 0xbf6d0000,0x3ec4bf35,0xbf6d0000,0x3ec4bf35,0xbf550000,0xbe48bf6d,0x3f55250d,0x3e483f6d
.long 0xbf350000,0xbf35bf80,0xbf350000,0xbf35bf80,0xbf0e0000,0xbf7bbf6d,0x3f0e250d,0x3f7b3f6d
.long 0xbec40000,0xbf6dbf35,0xbec40000,0xbf6dbf35,0xbe480000,0xbf0ebec4,0x3e48250d,0x3f0e3ec4
.long 0x250d0000,0x250d0000,0x250d0000,0x250d0000,0xbf553f35,0xbf7b3f6d,0x3f55bf35,0x3f7bbf6d
.long 0xbf6d3f80,0xbec43f35,0xbf6d3f80,0xbec43f35,0xbe483f35,0x3f55bec4,0x3e48bf35,0xbf553ec4
.long 0x3f35250d,0x3f35bf80,0x3f35250d,0x3f35bf80,0x3f7bbf35,0xbf0ebec4,0xbf7b3f35,0x3f0e3ec4
.long 0x3ec4bf80,0xbf6d3f35,0x3ec4bf80,0xbf6d3f35,0xbf0ebf35,0x3e483f6d,0x3f0e3f35,0xbe48bf6d
.long 0xbf800000,0x3f80250d,0xbf800000,0x3f80250d,0xbf0e3f35,0x3e48bf6d,0x3f0ebf35,0xbe483f6d
.long 0x3ec43f80,0xbf6dbf35,0x3ec43f80,0xbf6dbf35,0x3f7b3f35,0xbf0e3ec4,0xbf7bbf35,0x3f0ebec4
.long 0x3f35250d,0x3f353f80,0x3f35250d,0x3f353f80,0xbe48bf35,0x3f553ec4,0x3e483f35,0xbf55bec4
.long 0xbf6dbf80,0xbec4bf35,0xbf6dbf80,0xbec4bf35,0xbf55bf35,0xbf7bbf6d,0x3f553f35,0x3f7b3f6d
.long 0x250d0000,0x250d0000,0x250d0000,0x250d0000,0xbf7b3f80,0xbf553f6d,0x3f7bbf80,0x3f55bf6d
.long 0x3ec4250d,0x3f6dbf35,0x3ec4250d,0x3f6dbf35,0x3f55bf80,0xbe48bec4,0xbf553f80,0x3e483ec4
.long 0xbf350000,0xbf353f80,0xbf350000,0xbf353f80,0xbf0e3f80,0x3f7bbec4,0x3f0ebf80,0xbf7b3ec4
.long 0x3f6d250d,0xbec4bf35,0x3f6d250d,0xbec4bf35,0x3e48bf80,0xbf0e3f6d,0xbe483f80,0x3f0ebf6d
.long 0xbf800000,0x3f80250d,0xbf800000,0x3f80250d,0x3e483f80,0xbf0ebf6d,0xbe48bf80,0x3f0e3f6d
.long 0x3f6d250d,0xbec43f35,0x3f6d250d,0xbec43f35,0xbf0ebf80,0x3f7b3ec4,0x3f0e3f80,0xbf7bbec4
.long 0xbf350000,0xbf35bf80,0xbf350000,0xbf35bf80,0x3f553f80,0xbe483ec4,0xbf55bf80,0x3e48bec4
.long 0x3ec4250d,0x3f6d3f35,0x3ec4250d,0x3f6d3f35,0xbf7bbf80,0xbf55bf6d,0x3f7b3f80,0x3f553f6d
.long 0x250d0000,0x250d0000,0x250d0000,0x250d0000,0xbf0e3f35,0xbe483ec4,0x3f0ebf35,0x3e48bec4
.long 0x3f6dbf80,0x3ec4bf35,0x3f6dbf80,0x3ec4bf35,0xbf7b3f35,0xbf0e3f6d,0x3f7bbf35,0x3f0ebf6d
.long 0x3f35250d,0x3f35bf80,0x3f35250d,0x3f35bf80,0xbe48bf35,0xbf553f6d,0x3e483f35,0x3f55bf6d
.long 0xbec43f80,0x3f6dbf35,0xbec43f80,0x3f6dbf35,0x3f55bf35,0xbf7b3ec4,0xbf553f35,0x3f7bbec4
.long 0xbf800000,0x3f80250d,0xbf800000,0x3f80250d,0x3f553f35,0xbf7bbec4,0xbf55bf35,0x3f7b3ec4
.long 0xbec4bf80,0x3f6d3f35,0xbec4bf80,0x3f6d3f35,0xbe483f35,0xbf55bf6d,0x3e48bf35,0x3f553f6d
.long 0x3f35250d,0x3f353f80,0x3f35250d,0x3f353f80,0xbf7bbf35,0xbf0ebf6d,0x3f7b3f35,0x3f0e3f6d
.long 0x3f6d3f80,0x3ec43f35,0x3f6d3f80,0x3ec43f35,0xbf0ebf35,0xbe48bec4,0x3f0e3f35,0x3e483ec4
.long 0x3f80bf80,0x3f80bf80,0x3f80bf80,0x3f80bf80,0x3f7bbf80,0x3f55bf6d,0xbf7b3f80,0xbf553f6d
.long 0x3f6dbf80,0x3ec4bf35,0x3f6dbf80,0x3ec4bf35,0x3f55bf80,0xbe48bec4,0xbf553f80,0x3e483ec4
.long 0x3f35bf80,0xbf35a48d,0x3f35bf80,0xbf35a48d,0x3f0ebf80,0xbf7b3ec4,0xbf0e3f80,0x3f7bbec4
.long 0x3ec4bf80,0xbf6d3f35,0x3ec4bf80,0xbf6d3f35,0x3e48bf80,0xbf0e3f6d,0xbe483f80,0x3f0ebf6d
.long 0x2554bf80,0xa48d3f80,0x2554bf80,0xa48d3f80,0xbe48bf80,0x3f0e3f6d,0x3e483f80,0xbf0ebf6d
.long 0xbec4bf80,0x3f6d3f35,0xbec4bf80,0x3f6d3f35,0xbf0ebf80,0x3f7b3ec4,0x3f0e3f80,0xbf7bbec4
.long 0xbf35bf80,0x3f352554,0xbf35bf80,0x3f352554,0xbf55bf80,0x3e48bec4,0x3f553f80,0xbe483ec4
.long 0xbf6dbf80,0xbec4bf35,0xbf6dbf80,0xbec4bf35,0xbf7bbf80,0xbf55bf6d,0x3f7b3f80,0x3f553f6d
.long 0x3f80bf80,0x3f80bf80,0x3f80bf80,0x3f80bf80,0x3f0ebf35,0x3e48bec4,0xbf0e3f35,0xbe483ec4
.long 0xbec4a48d,0xbf6d3f35,0xbec4a48d,0xbf6d3f35,0xbf7b3f35,0xbf0e3f6d,0x3f7bbf35,0x3f0ebf6d
.long 0xbf353f80,0x3f352554,0xbf353f80,0x3f352554,0x3e483f35,0x3f55bf6d,0xbe48bf35,0xbf553f6d
.long 0x3f6d2554,0xbec4bf35,0x3f6d2554,0xbec4bf35,0x3f55bf35,0xbf7b3ec4,0xbf553f35,0x3f7bbec4
.long 0x2554bf80,0xa48d3f80,0x2554bf80,0xa48d3f80,0xbf55bf35,0x3f7b3ec4,0x3f553f35,0xbf7bbec4
.long 0xbf6da48d,0x3ec4bf35,0xbf6da48d,0x3ec4bf35,0xbe483f35,0xbf55bf6d,0x3e48bf35,0x3f553f6d
.long 0x3f353f80,0xbf35a48d,0x3f353f80,0xbf35a48d,0x3f7b3f35,0x3f0e3f6d,0xbf7bbf35,0xbf0ebf6d
.long 0x3ec42554,0x3f6d3f35,0x3ec42554,0x3f6d3f35,0xbf0ebf35,0xbe48bec4,0x3f0e3f35,0x3e483ec4
.long 0x3f80bf80,0x3f80bf80,0x3f80bf80,0x3f80bf80,0xbe48a48d,0xbf0e3ec4,0x3e482554,0x3f0ebec4
.long 0xbf6d3f80,0xbec43f35,0xbf6d3f80,0xbec43f35,0x3f0e2554,0x3f7bbf6d,0xbf0ea48d,0xbf7b3f6d
.long 0x3f35bf80,0xbf35a48d,0x3f35bf80,0xbf35a48d,0xbf55a48d,0xbe483f6d,0x3f552554,0x3e48bf6d
.long 0xbec43f80,0x3f6dbf35,0xbec43f80,0x3f6dbf35,0x3f7b2554,0xbf55bec4,0xbf7ba48d,0x3f553ec4
.long 0x2554bf80,0xa48d3f80,0x2554bf80,0xa48d3f80,0xbf7ba48d,0x3f55bec4,0x3f7b2554,0xbf553ec4
.long 0x3ec43f80,0xbf6dbf35,0x3ec43f80,0xbf6dbf35,0x3f552554,0x3e483f6d,0xbf55a48d,0xbe48bf6d
.long 0xbf35bf80,0x3f352554,0xbf35bf80,0x3f352554,0xbf0ea48d,0xbf7bbf6d,0x3f0e2554,0x3f7b3f6d
.long 0x3f6d3f80,0x3ec43f35,0x3f6d3f80,0x3ec43f35,0x3e482554,0x3f0e3ec4,0xbe48a48d,0xbf0ebec4
.long 0x3f80bf80,0x3f80bf80,0x3f80bf80,0x3f80bf80,0xbf553f35,0xbf7b3f6d,0x3f55bf35,0x3f7bbf6d
.long 0x3ec42554,0x3f6dbf35,0x3ec42554,0x3f6dbf35,0x3e48bf35,0xbf553ec4,0xbe483f35,0x3f55bec4
.long 0xbf353f80,0x3f352554,0xbf353f80,0x3f352554,0x3f7bbf35,0xbf0ebec4,0xbf7b3f35,0x3f0e3ec4
.long 0xbf6da48d,0x3ec43f35,0xbf6da48d,0x3ec43f35,0x3f0e3f35,0xbe48bf6d,0xbf0ebf35,0x3e483f6d
.long 0x2554bf80,0xa48d3f80,0x2554bf80,0xa48d3f80,0xbf0e3f35,0x3e48bf6d,0x3f0ebf35,0xbe483f6d
.long 0x3f6d2554,0xbec43f35,0x3f6d2554,0xbec43f35,0xbf7bbf35,0x3f0ebec4,0x3f7b3f35,0xbf0e3ec4
.long 0x3f353f80,0xbf35a48d,0x3f353f80,0xbf35a48d,0xbe48bf35,0x3f553ec4,0x3e483f35,0xbf55bec4
.long 0xbec4a48d,0xbf6dbf35,0xbec4a48d,0xbf6dbf35,0x3f553f35,0x3f7b3f6d,0xbf55bf35,0xbf7bbf6d
.long 0x3f800000,0x3f800000,0x3f800000,0x3f800000,0x3f800000,0x3f7ffcd7,0x3f7ff35e,0x3f7fe394
.long 0x3f800000,0x3f7ff35e,0x3f7fcd79,0x3f7f8e56,0x3f800000,0x3f7fe394,0x3f7f8e56,0x3f7f0059
.long 0x3f800000,0x3f7fcd79,0x3f7f35f9,0x3f7e39bc,0x3f800000,0x3f7fb10f,0x3f7ec46d,0x3f7d3aac
.long 0x3f800000,0x3f7f8e56,0x3f7e39bc,0x3f7c0361,0x3f800000,0x3f7f654e,0x3f7d95f4,0x3f7a9421
.long 0x3f800000,0x3f7f35f9,0x3f7cd925,0x3f78ed3c,0x3f800000,0x3f7f0059,0x3f7c0361,0x3f770f11
.long 0x3f800000,0x3f7ec46d,0x3f7b14be,0x3f74fa0b,0x3f800000,0x3f7e8238,0x3f7a0d54,0x3f72ae9e
.long 0x3f800000,0x3f7e39bc,0x3f78ed3c,0x3f702d4f,0x3f800000,0x3f7deafa,0x3f77b493,0x3f6d76aa
.long 0x3f800000,0x3f7d95f4,0x3f766377,0x3f6a8b4b,0x3f800000,0x3f7d3aac,0x3f74fa0b,0x3f676bd8
.long 0x3f800000,0x3f800000,0x3f800000,0x3f800000,0x3f7fcd79,0x3f7fb10f,0x3f7f8e56,0x3f7f654e
.long 0x3f7f35f9,0x3f7ec46d,0x3f7e39bc,0x3f7d95f4,0x3f7e39bc,0x3f7d3aac,0x3f7c0361,0x3f7a9421
.long 0x3f7cd925,0x3f7b14be,0x3f78ed3c,0x3f766377,0x3f7b14be,0x3f7853f8,0x3f74fa0b,0x3f710908
.long 0x3f78ed3c,0x3f74fa0b,0x3f702d4f,0x3f6a8b4b,0x3f766377,0x3f710908,0x3f6a8b4b,0x3f62f219
.long 0x3f737871,0x3f6c835e,0x3f641901,0x3f5a46a0,0x3f702d4f,0x3f676bd8,0x3f5cdc29,0x3f50935b
.long 0x3f6c835e,0x3f61c598,0x3f54db31,0x3f45e403,0x3f687c12,0x3f5b941a,0x3f4c1d35,0x3f3a4582
.long 0x3f641901,0x3f54db31,0x3f42a9f7,0x3f2dc5e3,0x3f5f5be6,0x3f4d9f02,0x3f3889dc,0x3f207440
.long 0x3f5a46a0,0x3f45e403,0x3f2dc5e3,0x3f1260b2,0x3f54db31,0x3f3daef9,0x3f226799,0x3f039c3d
.long 0x3f800000,0x3f800000,0x3f800000,0x3f800000,0x3f7f35f9,0x3f7f0059,0x3f7ec46d,0x3f7e8238
.long 0x3f7cd925,0x3f7c0361,0x3f7b14be,0x3f7a0d54,0x3f78ed3c,0x3f770f11,0x3f74fa0b,0x3f72ae9e
.long 0x3f737871,0x3f702d4f,0x3f6c835e,0x3f687c12,0x3f6c835e,0x3f676bd8,0x3f61c598,0x3f5b941a
.long 0x3f641901,0x3f5cdc29,0x3f54db31,0x3f4c1d35,0x3f5a46a0,0x3f50935b,0x3f45e403,0x3f3a4582
.long 0x3f4f1bbd,0x3f42a9f7,0x3f3504f3,0x3f26423a,0x3f42a9f7,0x3f333bc6,0x3f226799,0x3f104f0e
.long 0x3f3504f3,0x3f226799,0x3f0e39da,0x3ef15aea,0x3f26423a,0x3f104f0e,0x3ef15aea,0x3ebf47d7
.long 0x3f167918,0x3efa2c90,0x3ec3ef15,0x3e8afa3e,0x3f05c277,0x3ed1c759,0x3e94a031,0x3e2a1c3f
.long 0x3ee87171,0x3ea7bf25,0x3e47c5c2,0x3d712283,0x3ec3ef15,0x3e78cfcc,0x3dc8bd36,0xbd48fb30
.long 0x3f800000,0x3f800000,0x3f800000,0x3f800000,0x3f7e39bc,0x3f7deafa,0x3f7d95f4,0x3f7d3aac
.long 0x3f78ed3c,0x3f77b493,0x3f766377,0x3f74fa0b,0x3f702d4f,0x3f6d76aa,0x3f6a8b4b,0x3f676bd8
.long 0x3f641901,0x3f5f5be6,0x3f5a46a0,0x3f54db31,0x3f54db31,0x3f4d9f02,0x3f45e403,0x3f3daef9
.long 0x3f42a9f7,0x3f3889dc,0x3f2dc5e3,0x3f226799,0x3f2dc5e3,0x3f207440,0x3f1260b2,0x3f039c3d
.long 0x3f167918,0x3f05c277,0x3ee87171,0x3ec3ef15,0x3efa2c90,0x3ed1c759,0x3ea7bf25,0x3e78cfcc
.long 0x3ec3ef15,0x3e94a031,0x3e47c5c2,0x3dc8bd36,0x3e8afa3e,0x3e2a1c3f,0x3d712283,0xbd48fb30
.long 0x3e20305b,0x3d20cee7,0xbda0af2a,0xbe47c5c2,0x3d20cee7,0xbdb4b86a,0xbe5b73dc,0xbeac7cd4
.long 0xbda0af2a,0xbe5b73dc,0xbeb13641,0xbef15aea,0xbe47c5c2,0xbeac7cd4,0xbef15aea,0xbf187fc0
.long 0x0,0x0,0x0,0x0,0x0,0x3c20d8d2,0x3ca0d6d6,0x3cf13d4c
.long 0x0,0x3ca0d6d6,0x3d20cee7,0x3d712283,0x0,0x3cf13d4c,0x3d712283,0x3db4b86a
.long 0x0,0x3d20cee7,0x3da0af2a,0x3df0b772,0x0,0x3d48fb30,0x3dc8bd36,0x3e164083
.long 0x0,0x3d712283,0x3df0b772,0x3e3403f1,0x0,0x3d8ca1f2,0x3e0c4cf7,0x3e519f65
.long 0x0,0x3da0af2a,0x3e20305b,0x3e6f0c4d,0x0,0x3db4b86a,0x3e3403f1,0x3e862210
.long 0x0,0x3dc8bd36,0x3e47c5c2,0x3e94a031,0x0,0x3ddcbd0d,0x3e5b73dc,0x3ea2fd52
.long 0x0,0x3df0b772,0x3e6f0c4d,0x3eb13641,0x0,0x3e0255f4,0x3e814693,0x3ebf47d7
.long 0x0,0x3e0c4cf7,0x3e8afa3e,0x3ecd2ef3,0x0,0x3e164083,0x3e94a031,0x3edae880
.long 0x0,0x0,0x0,0x0,0x3d20cee7,0x3d48fb30,0x3d712283,0x3d8ca1f2
.long 0x3da0af2a,0x3dc8bd36,0x3df0b772,0x3e0c4cf7,0x3df0b772,0x3e164083,0x3e3403f1,0x3e519f65
.long 0x3e20305b,0x3e47c5c2,0x3e6f0c4d,0x3e8afa3e,0x3e47c5c2,0x3e78cfcc,0x3e94a031,0x3eac7cd4
.long 0x3e6f0c4d,0x3e94a031,0x3eb13641,0x3ecd2ef3,0x3e8afa3e,0x3eac7cd4,0x3ecd2ef3,0x3eece91a
.long 0x3e9e377a,0x3ec3ef15,0x3ee87171,0x3f05c277,0x3eb13641,0x3edae880,0x3f0172c3,0x3f146eba
.long 0x3ec3ef15,0x3ef15aea,0x3f0e39da,0x3f226799,0x3ed65a92,0x3f039c3d,0x3f1a82a4,0x3f2f9c32
.long 0x3ee87171,0x3f0e39da,0x3f26423a,0x3f3bfc8f,0x3efa2c90,0x3f187fc0,0x3f316e2c,0x3f4779bc
.long 0x3f05c277,0x3f226799,0x3f3bfc8f,0x3f5205d4,0x3f0e39da,0x3f2beb4a,0x3f45e403,0x3f5b941a
.long 0x0,0x0,0x0,0x0,0x3da0af2a,0x3db4b86a,0x3dc8bd36,0x3ddcbd0d
.long 0x3e20305b,0x3e3403f1,0x3e47c5c2,0x3e5b73dc,0x3e6f0c4d,0x3e862210,0x3e94a031,0x3ea2fd52
.long 0x3e9e377a,0x3eb13641,0x3ec3ef15,0x3ed65a92,0x3ec3ef15,0x3edae880,0x3ef15aea,0x3f039c3d
.long 0x3ee87171,0x3f0172c3,0x3f0e39da,0x3f1a82a4,0x3f05c277,0x3f146eba,0x3f226799,0x3f2f9c32
.long 0x3f167918,0x3f26423a,0x3f3504f3,0x3f42a9f7,0x3f26423a,0x3f36c9a9,0x3f45e403,0x3f53731f
.long 0x3f3504f3,0x3f45e403,0x3f54db31,0x3f61c598,0x3f42a9f7,0x3f53731f,0x3f61c598,0x3f6d76aa
.long 0x3f4f1bbd,0x3f5f5be6,0x3f6c835e,0x3f766377,0x3f5a46a0,0x3f698690,0x3f74fa0b,0x3f7c7160
.long 0x3f641901,0x3f71decf,0x3f7b14be,0x3f7f8e56,0x3f6c835e,0x3f7853f8,0x3f7ec46d,0x3f7fb10f
.long 0x0,0x0,0x0,0x0,0x3df0b772,0x3e0255f4,0x3e0c4cf7,0x3e164083
.long 0x3e6f0c4d,0x3e814693,0x3e8afa3e,0x3e94a031,0x3eb13641,0x3ebf47d7,0x3ecd2ef3,0x3edae880
.long 0x3ee87171,0x3efa2c90,0x3f05c277,0x3f0e39da,0x3f0e39da,0x3f187fc0,0x3f226799,0x3f2beb4a
.long 0x3f26423a,0x3f316e2c,0x3f3bfc8f,0x3f45e403,0x3f3bfc8f,0x3f4779bc,0x3f5205d4,0x3f5b941a
.long 0x3f4f1bbd,0x3f5a46a0,0x3f641901,0x3f6c835e,0x3f5f5be6,0x3f698690,0x3f71decf,0x3f7853f8
.long 0x3f6c835e,0x3f74fa0b,0x3f7b14be,0x3f7ec46d,0x3f766377,0x3f7c7160,0x3f7f8e56,0x3f7fb10f
.long 0x3f7cd925,0x3f7fcd79,0x3f7f35f9,0x3f7b14be,0x3f7fcd79,0x3f7f0059,0x3f7a0d54,0x3f710908
.long 0x3f7f35f9,0x3f7a0d54,0x3f702d4f,0x3f61c598,0x3f7b14be,0x3f710908,0x3f61c598,0x3f4d9f02
.long 0x3f800000,0x3f800000,0x3f800000,0x3f800000,0x3f7cd925,0x3f7c7160,0x3f7c0361,0x3f7b8f2a
.long 0x3f737871,0x3f71decf,0x3f702d4f,0x3f6e641a,0x3f641901,0x3f609384,0x3f5cdc29,0x3f58f3c4
.long 0x3f4f1bbd,0x3f490a88,0x3f42a9f7,0x3f3bfc8f,0x3f3504f3,0x3f2beb4a,0x3f226799,0x3f187fc0
.long 0x3f167918,0x3f0a04f8,0x3efa2c90,0x3edf7108,0x3ee87171,0x3ec8917e,0x3ea7bf25,0x3e862210
.long 0x3e9e377a,0x3e6f0c4d,0x3e20305b,0x3da0af2a,0x3e20305b,0x3d8ca1f2,0xbca0d6d6,0xbddcbd0d
.long 0x248d3132,0xbdc8bd36,0xbe47c5c2,0xbe94a031,0xbe20305b,0xbe862210,0xbeba9be1,0xbeece91a
.long 0xbe9e377a,0xbed65a92,0xbf05c277,0xbf1e7cf1,0xbee87171,0xbf104f0e,0xbf2a0c73,0xbf4105b8
.long 0xbf167918,0xbf316e2c,0xbf490a88,0xbf5cdc29,0xbf3504f3,0xbf4d9f02,0xbf61c598,0xbf710908
.long 0x3f800000,0x3f800000,0x3f800000,0x3f800000,0x3f7b14be,0x3f7a9421,0x3f7a0d54,0x3f79805c
.long 0x3f6c835e,0x3f6a8b4b,0x3f687c12,0x3f6655e7,0x3f54db31,0x3f50935b,0x3f4c1d35,0x3f4779bc
.long 0x3f3504f3,0x3f2dc5e3,0x3f26423a,0x3f1e7cf1,0x3f0e39da,0x3f039c3d,0x3ef15aea,0x3edae880
.long 0x3ec3ef15,0x3ea7bf25,0x3e8afa3e,0x3e5b73dc,0x3e47c5c2,0x3e0255f4,0x3d712283,0xbc20d8d2
.long 0x248d3132,0xbda0af2a,0xbe20305b,0xbe6f0c4d,0xbe47c5c2,0xbe8fcefe,0xbeba9be1,0xbee3f40d
.long 0xbec3ef15,0xbef15aea,0xbf0e39da,0xbf226799,0xbf0e39da,0xbf2456f1,0xbf3889dc,0xbf4a965e
.long 0xbf3504f3,0xbf490a88,0xbf5a46a0,0xbf687c12,0xbf54db31,0xbf653a48,0xbf71decf,0xbf7a9421
.long 0xbf6c835e,0xbf77b493,0xbf7e39bc,0xbf7ff35e,0xbf7b14be,0xbf7fb10f,0xbf7ec46d,0xbf7853f8
.long 0x3f800000,0x3f800000,0x3f800000,0x3f800000,0x3f78ed3c,0x3f7853f8,0x3f77b493,0x3f770f11
.long 0x3f641901,0x3f61c598,0x3f5f5be6,0x3f5cdc29,0x3f42a9f7,0x3f3daef9,0x3f3889dc,0x3f333bc6
.long 0x3f167918,0x3f0e39da,0x3f05c277,0x3efa2c90,0x3ec3ef15,0x3eac7cd4,0x3e94a031,0x3e78cfcc
.long 0x3e20305b,0x3dc8bd36,0x3d20cee7,0xbca0d6d6,0xbda0af2a,0xbe164083,0xbe5b73dc,0xbe8fcefe
.long 0xbe9e377a,0xbec3ef15,0xbee87171,0xbf05c277,0xbf05c277,0xbf187fc0,0xbf2a0c73,0xbf3a4582
.long 0xbf3504f3,0xbf45e403,0xbf54db31,0xbf61c598,0xbf5a46a0,0xbf676bd8,0xbf71decf,0xbf79805c
.long 0xbf737871,0xbf7b14be,0xbf7f35f9,0xbf7fcd79,0xbf7f35f9,0xbf7fb10f,0xbf7c0361,0xbf743c41
.long 0xbf7cd925,0xbf74fa0b,0xbf687c12,0xbf579b8c,0xbf6c835e,0xbf5b941a,0xbf45e403,0xbf2beb4a
.long 0x3f800000,0x3f800000,0x3f800000,0x3f800000,0x3f766377,0x3f75b1c9,0x3f74fa0b,0x3f743c41
.long 0x3f5a46a0,0x3f579b8c,0x3f54db31,0x3f5205d4,0x3f2dc5e3,0x3f28296a,0x3f226799,0x3f1c81b9
.long 0x3ee87171,0x3ed65a92,0x3ec3ef15,0x3eb13641,0x3e47c5c2,0x3e164083,0x3dc8bd36,0x3d48fb30
.long 0xbda0af2a,0xbe0c4cf7,0xbe47c5c2,0xbe814693,0xbeb13641,0xbed1c759,0xbef15aea,0xbf07e565
.long 0xbf167918,0xbf26423a,0xbf3504f3,0xbf42a9f7,0xbf490a88,0xbf563e03,0xbf61c598,0xbf6b8a3d
.long 0xbf6c835e,0xbf74fa0b,0xbf7b14be,0xbf7ec46d,0xbf7e39bc,0xbf7ffcd7,0xbf7ec46d,0xbf7a9421
.long 0xbf7cd925,0xbf766377,0xbf6c835e,0xbf5f5be6,0xbf687c12,0xbf58f3c4,0xbf45e403,0xbf2f9c32
.long 0xbf42a9f7,0xbf2a0c73,0xbf0e39da,0xbedf7108,0xbf0e39da,0xbedae880,0xbe94a031,0xbe164083
.long 0x0,0x0,0x0,0x0,0x3e20305b,0x3e2a1c3f,0x3e3403f1,0x3e3de731
.long 0x3e9e377a,0x3ea7bf25,0x3eb13641,0x3eba9be1,0x3ee87171,0x3ef5c6c5,0x3f0172c3,0x3f07e565
.long 0x3f167918,0x3f1e7cf1,0x3f26423a,0x3f2dc5e3,0x3f3504f3,0x3f3daef9,0x3f45e403,0x3f4d9f02
.long 0x3f4f1bbd,0x3f579b8c,0x3f5f5be6,0x3f6655e7,0x3f641901,0x3f6b8a3d,0x3f71decf,0x3f770f11
.long 0x3f737871,0x3f78ed3c,0x3f7cd925,0x3f7f35f9,0x3f7cd925,0x3f7f654e,0x3f7ff35e,0x3f7e8238
.long 0x3f800000,0x3f7ec46d,0x3f7b14be,0x3f74fa0b,0x3f7cd925,0x3f770f11,0x3f6e641a,0x3f62f219
.long 0x3f737871,0x3f687c12,0x3f5a46a0,0x3f490a88,0x3f641901,0x3f53731f,0x3f3f5cb5,0x3f28296a
.long 0x3f4f1bbd,0x3f3889dc,0x3f1e7cf1,0x3f0172c3,0x3f3504f3,0x3f187fc0,0x3ef15aea,0x3eac7cd4
.long 0x0,0x0,0x0,0x0,0x3e47c5c2,0x3e519f65,0x3e5b73dc,0x3e6542e9
.long 0x3ec3ef15,0x3ecd2ef3,0x3ed65a92,0x3edf7108,0x3f0e39da,0x3f146eba,0x3f1a82a4,0x3f207440
.long 0x3f3504f3,0x3f3bfc8f,0x3f42a9f7,0x3f490a88,0x3f54db31,0x3f5b941a,0x3f61c598,0x3f676bd8
.long 0x3f6c835e,0x3f71decf,0x3f766377,0x3f7a0d54,0x3f7b14be,0x3f7deafa,0x3f7f8e56,0x3f7ffcd7
.long 0x3f800000,0x3f7f35f9,0x3f7cd925,0x3f78ed3c,0x3f7b14be,0x3f75b1c9,0x3f6e641a,0x3f653a48
.long 0x3f6c835e,0x3f61c598,0x3f54db31,0x3f45e403,0x3f54db31,0x3f444969,0x3f316e2c,0x3f1c81b9
.long 0x3f3504f3,0x3f1e7cf1,0x3f05c277,0x3ed65a92,0x3f0e39da,0x3ee3f40d,0x3ea7bf25,0x3e519f65
.long 0x3ec3ef15,0x3e814693,0x3df0b772,0xbca0d6d6,0x3e47c5c2,0x3d48fb30,0xbdc8bd36,0xbe78cfcc
.long 0x0,0x0,0x0,0x0,0x3e6f0c4d,0x3e78cfcc,0x3e814693,0x3e862210
.long 0x3ee87171,0x3ef15aea,0x3efa2c90,0x3f0172c3,0x3f26423a,0x3f2beb4a,0x3f316e2c,0x3f36c9a9
.long 0x3f4f1bbd,0x3f54db31,0x3f5a46a0,0x3f5f5be6,0x3f6c835e,0x3f710908,0x3f74fa0b,0x3f7853f8
.long 0x3f7cd925,0x3f7ec46d,0x3f7fcd79,0x3f7ff35e,0x3f7f35f9,0x3f7d3aac,0x3f7a0d54,0x3f75b1c9
.long 0x3f737871,0x3f6c835e,0x3f641901,0x3f5a46a0,0x3f5a46a0,0x3f4d9f02,0x3f3f5cb5,0x3f2f9c32
.long 0x3f3504f3,0x3f226799,0x3f0e39da,0x3ef15aea,0x3f05c277,0x3edae880,0x3ea7bf25,0x3e6542e9
.long 0x3e9e377a,0x3e47c5c2,0x3da0af2a,0xbd20cee7,0x3da0af2a,0xbd48fb30,0xbe3403f1,0xbe996dba
.long 0xbe20305b,0xbe94a031,0xbed65a92,0xbf0a04f8,0xbec3ef15,0xbf039c3d,0xbf226799,0xbf3daef9
.long 0x0,0x0,0x0,0x0,0x3e8afa3e,0x3e8fcefe,0x3e94a031,0x3e996dba
.long 0x3f05c277,0x3f0a04f8,0x3f0e39da,0x3f1260b2,0x3f3bfc8f,0x3f4105b8,0x3f45e403,0x3f4a965e
.long 0x3f641901,0x3f687c12,0x3f6c835e,0x3f702d4f,0x3f7b14be,0x3f7d3aac,0x3f7ec46d,0x3f7fb10f
.long 0x3f7f35f9,0x3f7d95f4,0x3f7b14be,0x3f77b493,0x3f702d4f,0x3f698690,0x3f61c598,0x3f58f3c4
.long 0x3f4f1bbd,0x3f42a9f7,0x3f3504f3,0x3f26423a,0x3f1e7cf1,0x3f0c2124,0x3ef15aea,0x3ec8917e
.long 0x3ec3ef15,0x3e94a031,0x3e47c5c2,0x3dc8bd36,0x3df0b772,0x3c20d8d2,0xbdc8bd36,0xbe519f65
.long 0xbe20305b,0xbe8afa3e,0xbec3ef15,0xbefa2c90,0xbed65a92,0xbf07e565,0xbf226799,0xbf3a4582
.long 0xbf26423a,0xbf3f5cb5,0xbf54db31,0xbf6655e7,0xbf54db31,0xbf676bd8,0xbf74fa0b,0xbf7d3aac
.long 0x0,0x0,0x0,0x0,0x0,0x0,0x0,0x0
.long 0x0,0x0,0x0,0x0,0x0,0x0,0x0,0x0
.long 0x0,0x0,0x0,0x0,0x0,0x0,0x0,0x0
.long 0x0,0x0,0x0,0x0,0x0,0x0,0x0,0x0
.long 0x0,0x0,0x0,0x0,0x0,0x0,0x0,0x0
.long 0x0,0x0,0x0,0x0,0x0,0x0,0x0,0x0
.long 0x0,0x0,0x0,0x0,0x0,0x0,0x0,0x0
.long 0x0,0x0,0x0,0x0,0x0,0x0,0x0,0x0
.long 0x0,0x0,0x0,0x0,0x0,0x0,0x0,0x0
.long 0x0,0x0,0x0,0x0,0x0,0x0,0x0,0x0
.long 0x0,0x0,0x0,0x0,0x0,0x0,0x0,0x0
.long 0x0,0x0,0x0,0x0,0x0,0x0,0x0,0x0
.long 0x0,0x0,0x0,0x0,0x0,0x0,0x0,0x0
.long 0x0,0x0,0x0,0x0,0x0,0x0,0x0,0x0
.long 0x0,0x0,0x0,0x0,0x0,0x0,0x0,0x0
.long 0x0,0x0,0x0,0x0,0x0,0x0,0x0,0x0
.long 0x0,0x0,0x0,0x0,0x0,0x0,0x0,0x0
.long 0x0,0x0,0x0,0x0,0x0,0x0,0x0,0x0
.long 0x0,0x0,0x0,0x0,0x0,0x0,0x0,0x0
.long 0x0,0x0,0x0,0x0,0x0,0x0,0x0,0x0
.long 0x0,0x0,0x0,0x0,0x0,0x0,0x0,0x0
.long 0x0,0x0,0x0,0x0,0x0,0x0,0x0,0x0
.long 0x0,0x0,0x0,0x0,0x0,0x0,0x0,0x0
.long 0x0,0x0,0x0,0x0,0x0,0x0,0x0,0x0
.long 0x0,0x0,0x0,0x0,0x0,0x0,0x0,0x0
.long 0x0,0x0,0x0,0x0,0x0,0x0,0x0,0x0
.long 0x0,0x0,0x0,0x0,0x0,0x0,0x0,0x0
.long 0x0,0x0,0x0,0x0,0x0,0x0,0x0,0x0
.long 0x0,0x0,0x0,0x0,0x0,0x0,0x0,0x0
.long 0x0,0x0,0x0,0x0,0x0,0x0,0x0,0x0
.long 0x0,0x0,0x0,0x0,0x0,0x0,0x0,0x0
.long 0x0,0x0,0x0,0x0,0x0,0x0,0x0,0x0
.long 0x0,0x0,0x0,0x0,0x0,0x0,0x0,0x0
.long 0x0,0x0,0x0,0x0,0x0,0x0,0x0,0x0
.long 0x0,0x0,0x0,0x0,0x0,0x0,0x0,0x0
.long 0x0,0x0,0x0,0x0,0x0,0x0,0x0,0x0
.long 0x0,0x0,0x0,0x0,0x0,0x0,0x0,0x0
.long 0x0,0x0,0x0,0x0,0x0,0x0,0x0,0x0
.long 0x0,0x0,0x0,0x0,0x0,0x0,0x0,0x0
.long 0x0,0x0,0x0,0x0,0x0,0x0,0x0,0x0
.long 0x0,0x0,0x0,0x0,0x0,0x0,0x0,0x0
.long 0x0,0x0,0x0,0x0,0x0,0x0,0x0,0x0
.long 0x0,0x0,0x0,0x0,0x0,0x0,0x0,0x0
.long 0x0,0x0,0x0,0x0,0x0,0x0,0x0,0x0
.long 0x0,0x0,0x0,0x0,0x0,0x0,0x0,0x0
.long 0x0,0x0,0x0,0x0,0x0,0x0,0x0,0x0
.long 0x0,0x0,0x0,0x0,0x0,0x0,0x0,0x0
.long 0x0,0x0,0x0,0x0,0x0,0x0,0x0,0x0
.long 0x0,0x0,0x0,0x0,0x0,0x0,0x0,0x0
.long 0x0,0x0,0x0,0x0,0x0,0x0,0x0,0x0
.long 0x0,0x0,0x0,0x0,0x0,0x0,0x0,0x0
.long 0x0,0x0,0x0,0x0,0x0,0x0,0x0,0x0
.long 0x0,0x0,0x0,0x0,0x0,0x0,0x0,0x0
.long 0x0,0x0,0x0,0x0,0x0,0x0,0x0,0x0
.long 0x0,0x0,0x0,0x0,0x0,0x0,0x0,0x0
.long 0x0,0x0,0x0,0x0,0x0,0x0,0x0,0x0
.long 0x0,0x0,0x0,0x0,0x0,0x0,0x0,0x0
.long 0x0,0x0,0x0,0x0,0x0,0x0,0x0,0x0
.long 0x0,0x0,0x0,0x0,0x0,0x0,0x0,0x0
.long 0x0,0x0,0x0,0x0,0x0,0x0,0x0,0x0
.long 0x0,0x0,0x0,0x0,0x0,0x0,0x0,0x0
.long 0x0,0x0,0x0,0x0,0x0,0x0,0x0,0x0
.long 0x0,0x0,0x0,0x0,0x0,0x0,0x0,0x0
.long 0x0,0x0,0x0,0x0,0x0,0x0,0x0,0x0
.long 0x3f803f80,0x3f803f80,0x3f803f80,0x3f803f80,0x3f7f3f80,0x3f753f7b,0xbdc9248d,0xbe95be48
.long 0x3f7b3f80,0x3f553f6d,0xbf7bbf80,0xbf55bf6d,0x3f753f80,0x3f223f55,0x3e95a554,0x3f463f0e
.long 0x3f6d3f80,0x3ec43f35,0x3f6d3f80,0x3ec43f35,0x3f623f80,0x3dc93f0e,0xbef1248d,0xbf7fbf55
.long 0x3f553f80,0xbe483ec4,0xbf55bf80,0x3e48bec4,0x3f463f80,0xbef13e48,0x3f22a554,0x3f623f7b
.long 0x3f353f80,0xbf35248d,0x3f353f80,0xbf35248d,0x3f223f80,0xbf62be48,0xbf46248d,0xbef1bf7b
.long 0x3f0e3f80,0xbf7bbec4,0xbf0ebf80,0x3f7b3ec4,0x3ef13f80,0xbf7fbf0e,0x3f62a554,0xbdc93f55
.long 0x3ec43f80,0xbf6dbf35,0x3ec43f80,0xbf6dbf35,0x3e953f80,0xbf46bf55,0xbf75248d,0x3f22bf0e
.long 0x3e483f80,0xbf0ebf6d,0xbe48bf80,0x3f0e3f6d,0x3dc93f80,0xbe95bf7b,0x3f7fa554,0xbf753e48
.long 0x3f803f80,0x3f803f80,0x3f803f80,0x3f803f80,0x3f623f6d,0x3f463f55,0xbef1bec4,0xbf22bf0e
.long 0x3f0e3f35,0x3e483ec4,0xbf0ebf35,0xbe48bec4,0x3dc93ec4,0xbef1be48,0x3f7f3f6d,0x3f623f7b
.long 0xbec4248d,0xbf6dbf35,0xbec4248d,0xbf6dbf35,0xbf46bec4,0xbf75bf7b,0xbf22bf6d,0x3e95be48
.long 0xbf7bbf35,0xbf0ebf6d,0x3f7b3f35,0x3f0e3f6d,0xbf75bf6d,0x3dc9bf0e,0xbe953ec4,0xbf7fbf55
.long 0xbf35bf80,0x3f35a554,0xbf35bf80,0x3f35a554,0xbe95bf6d,0x3f7f3f0e,0x3f753ec4,0x3dc93f55
.long 0x3e48bf35,0x3f553f6d,0xbe483f35,0xbf55bf6d,0x3f22bec4,0x3e953f7b,0xbf46bf6d,0x3f753e48
.long 0x3f6da554,0xbec43f35,0x3f6da554,0xbec43f35,0x3f7f3ec4,0xbf623e48,0xbdc93f6d,0xbef1bf7b
.long 0x3f553f35,0xbf7bbec4,0xbf55bf35,0x3f7b3ec4,0x3ef13f6d,0xbf22bf55,0x3f62bec4,0xbf463f0e
.long 0x3f803f80,0x3f803f80,0x3f803f80,0x3f803f80,0x3f223f35,0x3ef13f0e,0xbf46bf35,0xbf62bf55
.long 0xbe48248d,0xbf0ebec4,0x3e48a554,0x3f0e3ec4,0xbf62bf35,0xbf7fbf7b,0x3ef13f35,0xbdc93e48
.long 0xbf6dbf80,0xbec4bf35,0xbf6dbf80,0xbec4bf35,0xbe95bf35,0x3f223e48,0x3f753f35,0x3f463f7b
.long 0x3f0ea554,0x3f7b3f6d,0xbf0e248d,0xbf7bbf6d,0x3f7f3f35,0x3e953f55,0xbdc9bf35,0x3f753f0e
.long 0x3f353f80,0xbf35248d,0x3f353f80,0xbf35248d,0xbdc93f35,0xbf75bf55,0xbf7fbf35,0x3e95bf0e
.long 0xbf55248d,0xbe48bf6d,0x3f55a554,0x3e483f6d,0xbf75bf35,0x3f46be48,0xbe953f35,0xbf22bf7b
.long 0xbec4bf80,0x3f6d3f35,0xbec4bf80,0x3f6d3f35,0x3ef1bf35,0x3dc93f7b,0x3f623f35,0xbf7fbe48
.long 0x3f7ba554,0xbf553ec4,0xbf7b248d,0x3f55bec4,0x3f463f35,0xbf62bf0e,0x3f22bf35,0xbef13f55
.long 0x3f803f80,0x3f803f80,0x3f803f80,0x3f803f80,0x3e953ec4,0x3dc93e48,0xbf75bf6d,0xbf7fbf7b
.long 0xbf55bf35,0xbf7bbf6d,0x3f553f35,0x3f7b3f6d,0xbf46bf6d,0xbe95bf0e,0xbf22bec4,0xbf75bf55
.long 0x3ec4a554,0x3f6d3f35,0x3ec4a554,0x3f6d3f35,0x3f7f3f6d,0x3ef13f55,0xbdc93ec4,0xbf62bf0e
.long 0x3e483f35,0xbf55bec4,0xbe48bf35,0x3f553ec4,0xbf62bec4,0xbf22bf7b,0x3ef13f6d,0xbf46be48
.long 0xbf35bf80,0x3f35a554,0xbf35bf80,0x3f35a554,0x3ef1bec4,0x3f463f7b,0x3f623f6d,0xbf223e48
.long 0x3f7b3f35,0xbf0e3ec4,0xbf7bbf35,0x3f0ebec4,0x3dc93f6d,0xbf62bf55,0x3f7f3ec4,0xbef13f0e
.long 0xbf6d248d,0x3ec4bf35,0xbf6d248d,0x3ec4bf35,0xbf22bf6d,0x3f753f0e,0x3f46bec4,0xbe953f55
.long 0x3f0ebf35,0xbe483f6d,0xbf0e3f35,0x3e48bf6d,0x3f753ec4,0xbf7fbe48,0x3e95bf6d,0xbdc93f7b
.long 0x3f803f80,0x3f803f80,0x3f803f80,0x3f803f80,0xbf7fbf80,0xbf75bf7b,0x3dc9a554,0x3e953e48
.long 0x3f7b3f80,0x3f553f6d,0xbf7bbf80,0xbf55bf6d,0xbf75bf80,0xbf22bf55,0xbe95248d,0xbf46bf0e
.long 0x3f6d3f80,0x3ec43f35,0x3f6d3f80,0x3ec43f35,0xbf62bf80,0xbdc9bf0e,0x3ef1a554,0x3f7f3f55
.long 0x3f553f80,0xbe483ec4,0xbf55bf80,0x3e48bec4,0xbf46bf80,0x3ef1be48,0xbf22248d,0xbf62bf7b
.long 0x3f353f80,0xbf35248d,0x3f353f80,0xbf35248d,0xbf22bf80,0x3f623e48,0x3f46a554,0x3ef13f7b
.long 0x3f0e3f80,0xbf7bbec4,0xbf0ebf80,0x3f7b3ec4,0xbef1bf80,0x3f7f3f0e,0xbf62248d,0x3dc9bf55
.long 0x3ec43f80,0xbf6dbf35,0x3ec43f80,0xbf6dbf35,0xbe95bf80,0x3f463f55,0x3f75a554,0xbf223f0e
.long 0x3e483f80,0xbf0ebf6d,0xbe48bf80,0x3f0e3f6d,0xbdc9bf80,0x3e953f7b,0xbf7f248d,0x3f75be48
.long 0x3f803f80,0x3f803f80,0x3f803f80,0x3f803f80,0xbf62bf6d,0xbf46bf55,0x3ef13ec4,0x3f223f0e
.long 0x3f0e3f35,0x3e483ec4,0xbf0ebf35,0xbe48bec4,0xbdc9bec4,0x3ef13e48,0xbf7fbf6d,0xbf62bf7b
.long 0xbec4248d,0xbf6dbf35,0xbec4248d,0xbf6dbf35,0x3f463ec4,0x3f753f7b,0x3f223f6d,0xbe953e48
.long 0xbf7bbf35,0xbf0ebf6d,0x3f7b3f35,0x3f0e3f6d,0x3f753f6d,0xbdc93f0e,0x3e95bec4,0x3f7f3f55
.long 0xbf35bf80,0x3f35a554,0xbf35bf80,0x3f35a554,0x3e953f6d,0xbf7fbf0e,0xbf75bec4,0xbdc9bf55
.long 0x3e48bf35,0x3f553f6d,0xbe483f35,0xbf55bf6d,0xbf223ec4,0xbe95bf7b,0x3f463f6d,0xbf75be48
.long 0x3f6da554,0xbec43f35,0x3f6da554,0xbec43f35,0xbf7fbec4,0x3f62be48,0x3dc9bf6d,0x3ef13f7b
.long 0x3f553f35,0xbf7bbec4,0xbf55bf35,0x3f7b3ec4,0xbef1bf6d,0x3f223f55,0xbf623ec4,0x3f46bf0e
.long 0x3f803f80,0x3f803f80,0x3f803f80,0x3f803f80,0xbf22bf35,0xbef1bf0e,0x3f463f35,0x3f623f55
.long 0xbe48248d,0xbf0ebec4,0x3e48a554,0x3f0e3ec4,0x3f623f35,0x3f7f3f7b,0xbef1bf35,0x3dc9be48
.long 0xbf6dbf80,0xbec4bf35,0xbf6dbf80,0xbec4bf35,0x3e953f35,0xbf22be48,0xbf75bf35,0xbf46bf7b
.long 0x3f0ea554,0x3f7b3f6d,0xbf0e248d,0xbf7bbf6d,0xbf7fbf35,0xbe95bf55,0x3dc93f35,0xbf75bf0e
.long 0x3f353f80,0xbf35248d,0x3f353f80,0xbf35248d,0x3dc9bf35,0x3f753f55,0x3f7f3f35,0xbe953f0e
.long 0xbf55248d,0xbe48bf6d,0x3f55a554,0x3e483f6d,0x3f753f35,0xbf463e48,0x3e95bf35,0x3f223f7b
.long 0xbec4bf80,0x3f6d3f35,0xbec4bf80,0x3f6d3f35,0xbef13f35,0xbdc9bf7b,0xbf62bf35,0x3f7f3e48
.long 0x3f7ba554,0xbf553ec4,0xbf7b248d,0x3f55bec4,0xbf46bf35,0x3f623f0e,0xbf223f35,0x3ef1bf55
.long 0x3f803f80,0x3f803f80,0x3f803f80,0x3f803f80,0xbe95bec4,0xbdc9be48,0x3f753f6d,0x3f7f3f7b
.long 0xbf55bf35,0xbf7bbf6d,0x3f553f35,0x3f7b3f6d,0x3f463f6d,0x3e953f0e,0x3f223ec4,0x3f753f55
.long 0x3ec4a554,0x3f6d3f35,0x3ec4a554,0x3f6d3f35,0xbf7fbf6d,0xbef1bf55,0x3dc9bec4,0x3f623f0e
.long 0x3e483f35,0xbf55bec4,0xbe48bf35,0x3f553ec4,0x3f623ec4,0x3f223f7b,0xbef1bf6d,0x3f463e48
.long 0xbf35bf80,0x3f35a554,0xbf35bf80,0x3f35a554,0xbef13ec4,0xbf46bf7b,0xbf62bf6d,0x3f22be48
.long 0x3f7b3f35,0xbf0e3ec4,0xbf7bbf35,0x3f0ebec4,0xbdc9bf6d,0x3f623f55,0xbf7fbec4,0x3ef1bf0e
.long 0xbf6d248d,0x3ec4bf35,0xbf6d248d,0x3ec4bf35,0x3f223f6d,0xbf75bf0e,0xbf463ec4,0x3e95bf55
.long 0x3f0ebf35,0xbe483f6d,0xbf0e3f35,0x3e48bf6d,0xbf75bec4,0x3f7f3e48,0xbe953f6d,0x3dc9bf7b
.long 0x248d3f80,0xa554bf80,0x248d3f80,0xa554bf80,0xbdc93f80,0x3e95bf7b,0xbf7f248d,0x3f753e48
.long 0xbe483f80,0x3f0ebf6d,0x3e48bf80,0xbf0e3f6d,0xbe953f80,0x3f46bf55,0x3f75a554,0xbf22bf0e
.long 0xbec43f80,0x3f6dbf35,0xbec43f80,0x3f6dbf35,0xbef13f80,0x3f7fbf0e,0xbf62248d,0x3dc93f55
.long 0xbf0e3f80,0x3f7bbec4,0x3f0ebf80,0xbf7b3ec4,0xbf223f80,0x3f62be48,0x3f46a554,0x3ef1bf7b
.long 0xbf353f80,0x3f35a554,0xbf353f80,0x3f35a554,0xbf463f80,0x3ef13e48,0xbf22248d,0xbf623f7b
.long 0xbf553f80,0x3e483ec4,0x3f55bf80,0xbe48bec4,0xbf623f80,0xbdc93f0e,0x3ef1a554,0x3f7fbf55
.long 0xbf6d3f80,0xbec43f35,0xbf6d3f80,0xbec43f35,0xbf753f80,0xbf223f55,0xbe95248d,0xbf463f0e
.long 0xbf7b3f80,0xbf553f6d,0x3f7bbf80,0x3f55bf6d,0xbf7f3f80,0xbf753f7b,0x3dc9a554,0x3e95be48
.long 0x248d3f80,0xa554bf80,0x248d3f80,0xa554bf80,0xbef13f6d,0x3f22bf55,0xbf62bec4,0x3f463f0e
.long 0xbf553f35,0x3f7bbec4,0x3f55bf35,0xbf7b3ec4,0xbf7f3ec4,0x3f623e48,0x3dc93f6d,0x3ef1bf7b
.long 0xbf6d248d,0x3ec43f35,0xbf6d248d,0x3ec43f35,0xbf22bec4,0xbe953f7b,0x3f46bf6d,0xbf753e48
.long 0xbe48bf35,0xbf553f6d,0x3e483f35,0x3f55bf6d,0x3e95bf6d,0xbf7f3f0e,0xbf753ec4,0xbdc93f55
.long 0x3f35bf80,0xbf35248d,0x3f35bf80,0xbf35248d,0x3f75bf6d,0xbdc9bf0e,0x3e953ec4,0x3f7fbf55
.long 0x3f7bbf35,0x3f0ebf6d,0xbf7b3f35,0xbf0e3f6d,0x3f46bec4,0x3f75bf7b,0x3f22bf6d,0xbe95be48
.long 0x3ec4a554,0x3f6dbf35,0x3ec4a554,0x3f6dbf35,0xbdc93ec4,0x3ef1be48,0xbf7f3f6d,0xbf623f7b
.long 0xbf0e3f35,0xbe483ec4,0x3f0ebf35,0x3e48bec4,0xbf623f6d,0xbf463f55,0x3ef1bec4,0x3f22bf0e
.long 0x248d3f80,0xa554bf80,0x248d3f80,0xa554bf80,0xbf463f35,0x3f62bf0e,0xbf22bf35,0x3ef13f55
.long 0xbf7b248d,0x3f553ec4,0x3f7ba554,0xbf55bec4,0xbef1bf35,0xbdc93f7b,0xbf623f35,0x3f7fbe48
.long 0x3ec4bf80,0xbf6d3f35,0x3ec4bf80,0xbf6d3f35,0x3f75bf35,0xbf46be48,0x3e953f35,0x3f22bf7b
.long 0x3f55a554,0x3e48bf6d,0xbf55248d,0xbe483f6d,0x3dc93f35,0x3f75bf55,0x3f7fbf35,0xbe95bf0e
.long 0xbf353f80,0x3f35a554,0xbf353f80,0x3f35a554,0xbf7f3f35,0xbe953f55,0x3dc9bf35,0xbf753f0e
.long 0xbf0e248d,0xbf7b3f6d,0x3f0ea554,0x3f7bbf6d,0x3e95bf35,0xbf223e48,0xbf753f35,0xbf463f7b
.long 0x3f6dbf80,0x3ec4bf35,0x3f6dbf80,0x3ec4bf35,0x3f62bf35,0x3f7fbf7b,0xbef13f35,0x3dc93e48
.long 0x3e48a554,0x3f0ebec4,0xbe48248d,0xbf0e3ec4,0xbf223f35,0xbef13f0e,0x3f46bf35,0x3f62bf55
.long 0x248d3f80,0xa554bf80,0x248d3f80,0xa554bf80,0xbf753ec4,0x3f7fbe48,0xbe95bf6d,0x3dc93f7b
.long 0xbf0ebf35,0x3e483f6d,0x3f0e3f35,0xbe48bf6d,0x3f22bf6d,0xbf753f0e,0xbf46bec4,0x3e953f55
.long 0x3f6da554,0xbec4bf35,0x3f6da554,0xbec4bf35,0xbdc93f6d,0x3f62bf55,0xbf7f3ec4,0x3ef13f0e
.long 0xbf7b3f35,0x3f0e3ec4,0x3f7bbf35,0xbf0ebec4,0xbef1bec4,0xbf463f7b,0xbf623f6d,0x3f223e48
.long 0x3f35bf80,0xbf35248d,0x3f35bf80,0xbf35248d,0x3f62bec4,0x3f22bf7b,0xbef13f6d,0x3f46be48
.long 0xbe483f35,0x3f55bec4,0x3e48bf35,0xbf553ec4,0xbf7f3f6d,0xbef13f55,0x3dc93ec4,0x3f62bf0e
.long 0xbec4248d,0xbf6d3f35,0xbec4248d,0xbf6d3f35,0x3f46bf6d,0x3e95bf0e,0x3f22bec4,0x3f75bf55
.long 0x3f55bf35,0x3f7bbf6d,0xbf553f35,0xbf7b3f6d,0xbe953ec4,0xbdc93e48,0x3f75bf6d,0x3f7fbf7b
.long 0x248d3f80,0xa554bf80,0x248d3f80,0xa554bf80,0x3dc9bf80,0xbe953f7b,0x3f7fa554,0xbf75be48
.long 0xbe483f80,0x3f0ebf6d,0x3e48bf80,0xbf0e3f6d,0x3e95bf80,0xbf463f55,0xbf75248d,0x3f223f0e
.long 0xbec43f80,0x3f6dbf35,0xbec43f80,0x3f6dbf35,0x3ef1bf80,0xbf7f3f0e,0x3f62a554,0xbdc9bf55
.long 0xbf0e3f80,0x3f7bbec4,0x3f0ebf80,0xbf7b3ec4,0x3f22bf80,0xbf623e48,0xbf46248d,0xbef13f7b
.long 0xbf353f80,0x3f35a554,0xbf353f80,0x3f35a554,0x3f46bf80,0xbef1be48,0x3f22a554,0x3f62bf7b
.long 0xbf553f80,0x3e483ec4,0x3f55bf80,0xbe48bec4,0x3f62bf80,0x3dc9bf0e,0xbef1248d,0xbf7f3f55
.long 0xbf6d3f80,0xbec43f35,0xbf6d3f80,0xbec43f35,0x3f75bf80,0x3f22bf55,0x3e95a554,0x3f46bf0e
.long 0xbf7b3f80,0xbf553f6d,0x3f7bbf80,0x3f55bf6d,0x3f7fbf80,0x3f75bf7b,0xbdc9248d,0xbe953e48
.long 0x248d3f80,0xa554bf80,0x248d3f80,0xa554bf80,0x3ef1bf6d,0xbf223f55,0x3f623ec4,0xbf46bf0e
.long 0xbf553f35,0x3f7bbec4,0x3f55bf35,0xbf7b3ec4,0x3f7fbec4,0xbf62be48,0xbdc9bf6d,0xbef13f7b
.long 0xbf6d248d,0x3ec43f35,0xbf6d248d,0x3ec43f35,0x3f223ec4,0x3e95bf7b,0xbf463f6d,0x3f75be48
.long 0xbe48bf35,0xbf553f6d,0x3e483f35,0x3f55bf6d,0xbe953f6d,0x3f7fbf0e,0x3f75bec4,0x3dc9bf55
.long 0x3f35bf80,0xbf35248d,0x3f35bf80,0xbf35248d,0xbf753f6d,0x3dc93f0e,0xbe95bec4,0xbf7f3f55
.long 0x3f7bbf35,0x3f0ebf6d,0xbf7b3f35,0xbf0e3f6d,0xbf463ec4,0xbf753f7b,0xbf223f6d,0x3e953e48
.long 0x3ec4a554,0x3f6dbf35,0x3ec4a554,0x3f6dbf35,0x3dc9bec4,0xbef13e48,0x3f7fbf6d,0x3f62bf7b
.long 0xbf0e3f35,0xbe483ec4,0x3f0ebf35,0x3e48bec4,0x3f62bf6d,0x3f46bf55,0xbef13ec4,0xbf223f0e
.long 0x248d3f80,0xa554bf80,0x248d3f80,0xa554bf80,0x3f46bf35,0xbf623f0e,0x3f223f35,0xbef1bf55
.long 0xbf7b248d,0x3f553ec4,0x3f7ba554,0xbf55bec4,0x3ef13f35,0x3dc9bf7b,0x3f62bf35,0xbf7f3e48
.long 0x3ec4bf80,0xbf6d3f35,0x3ec4bf80,0xbf6d3f35,0xbf753f35,0x3f463e48,0xbe95bf35,0xbf223f7b
.long 0x3f55a554,0x3e48bf6d,0xbf55248d,0xbe483f6d,0xbdc9bf35,0xbf753f55,0xbf7f3f35,0x3e953f0e
.long 0xbf353f80,0x3f35a554,0xbf353f80,0x3f35a554,0x3f7fbf35,0x3e95bf55,0xbdc93f35,0x3f75bf0e
.long 0xbf0e248d,0xbf7b3f6d,0x3f0ea554,0x3f7bbf6d,0xbe953f35,0x3f22be48,0x3f75bf35,0x3f46bf7b
.long 0x3f6dbf80,0x3ec4bf35,0x3f6dbf80,0x3ec4bf35,0xbf623f35,0xbf7f3f7b,0x3ef1bf35,0xbdc9be48
.long 0x3e48a554,0x3f0ebec4,0xbe48248d,0xbf0e3ec4,0x3f22bf35,0x3ef1bf0e,0xbf463f35,0xbf623f55
.long 0x248d3f80,0xa554bf80,0x248d3f80,0xa554bf80,0x3f75bec4,0xbf7f3e48,0x3e953f6d,0xbdc9bf7b
.long 0xbf0ebf35,0x3e483f6d,0x3f0e3f35,0xbe48bf6d,0xbf223f6d,0x3f75bf0e,0x3f463ec4,0xbe95bf55
.long 0x3f6da554,0xbec4bf35,0x3f6da554,0xbec4bf35,0x3dc9bf6d,0xbf623f55,0x3f7fbec4,0xbef1bf0e
.long 0xbf7b3f35,0x3f0e3ec4,0x3f7bbf35,0xbf0ebec4,0x3ef13ec4,0x3f46bf7b,0x3f62bf6d,0xbf22be48
.long 0x3f35bf80,0xbf35248d,0x3f35bf80,0xbf35248d,0xbf623ec4,0xbf223f7b,0x3ef1bf6d,0xbf463e48
.long 0xbe483f35,0x3f55bec4,0x3e48bf35,0xbf553ec4,0x3f7fbf6d,0x3ef1bf55,0xbdc9bec4,0xbf623f0e
.long 0xbec4248d,0xbf6d3f35,0xbec4248d,0xbf6d3f35,0xbf463f6d,0xbe953f0e,0xbf223ec4,0xbf753f55
.long 0x3f55bf35,0x3f7bbf6d,0xbf553f35,0xbf7b3f6d,0x3e95bec4,0x3dc9be48,0xbf753f6d,0xbf7f3f7b
.long 0xbf803f80,0xbf803f80,0xbf803f80,0xbf803f80,0xbf7f3f80,0xbf753f7b,0x3dc9248d,0x3e95be48
.long 0xbf7b3f80,0xbf553f6d,0x3f7bbf80,0x3f55bf6d,0xbf753f80,0xbf223f55,0xbe95a554,0xbf463f0e
.long 0xbf6d3f80,0xbec43f35,0xbf6d3f80,0xbec43f35,0xbf623f80,0xbdc93f0e,0x3ef1248d,0x3f7fbf55
.long 0xbf553f80,0x3e483ec4,0x3f55bf80,0xbe48bec4,0xbf463f80,0x3ef13e48,0xbf22a554,0xbf623f7b
.long 0xbf353f80,0x3f35248d,0xbf353f80,0x3f35248d,0xbf223f80,0x3f62be48,0x3f46248d,0x3ef1bf7b
.long 0xbf0e3f80,0x3f7bbec4,0x3f0ebf80,0xbf7b3ec4,0xbef13f80,0x3f7fbf0e,0xbf62a554,0x3dc93f55
.long 0xbec43f80,0x3f6dbf35,0xbec43f80,0x3f6dbf35,0xbe953f80,0x3f46bf55,0x3f75248d,0xbf22bf0e
.long 0xbe483f80,0x3f0ebf6d,0x3e48bf80,0xbf0e3f6d,0xbdc93f80,0x3e95bf7b,0xbf7fa554,0x3f753e48
.long 0xbf803f80,0xbf803f80,0xbf803f80,0xbf803f80,0xbf623f6d,0xbf463f55,0x3ef1bec4,0x3f22bf0e
.long 0xbf0e3f35,0xbe483ec4,0x3f0ebf35,0x3e48bec4,0xbdc93ec4,0x3ef1be48,0xbf7f3f6d,0xbf623f7b
.long 0x3ec4248d,0x3f6dbf35,0x3ec4248d,0x3f6dbf35,0x3f46bec4,0x3f75bf7b,0x3f22bf6d,0xbe95be48
.long 0x3f7bbf35,0x3f0ebf6d,0xbf7b3f35,0xbf0e3f6d,0x3f75bf6d,0xbdc9bf0e,0x3e953ec4,0x3f7fbf55
.long 0x3f35bf80,0xbf35a554,0x3f35bf80,0xbf35a554,0x3e95bf6d,0xbf7f3f0e,0xbf753ec4,0xbdc93f55
.long 0xbe48bf35,0xbf553f6d,0x3e483f35,0x3f55bf6d,0xbf22bec4,0xbe953f7b,0x3f46bf6d,0xbf753e48
.long 0xbf6da554,0x3ec43f35,0xbf6da554,0x3ec43f35,0xbf7f3ec4,0x3f623e48,0x3dc93f6d,0x3ef1bf7b
.long 0xbf553f35,0x3f7bbec4,0x3f55bf35,0xbf7b3ec4,0xbef13f6d,0x3f22bf55,0xbf62bec4,0x3f463f0e
.long 0xbf803f80,0xbf803f80,0xbf803f80,0xbf803f80,0xbf223f35,0xbef13f0e,0x3f46bf35,0x3f62bf55
.long 0x3e48248d,0x3f0ebec4,0xbe48a554,0xbf0e3ec4,0x3f62bf35,0x3f7fbf7b,0xbef13f35,0x3dc93e48
.long 0x3f6dbf80,0x3ec4bf35,0x3f6dbf80,0x3ec4bf35,0x3e95bf35,0xbf223e48,0xbf753f35,0xbf463f7b
.long 0xbf0ea554,0xbf7b3f6d,0x3f0e248d,0x3f7bbf6d,0xbf7f3f35,0xbe953f55,0x3dc9bf35,0xbf753f0e
.long 0xbf353f80,0x3f35248d,0xbf353f80,0x3f35248d,0x3dc93f35,0x3f75bf55,0x3f7fbf35,0xbe95bf0e
.long 0x3f55248d,0x3e48bf6d,0xbf55a554,0xbe483f6d,0x3f75bf35,0xbf46be48,0x3e953f35,0x3f22bf7b
.long 0x3ec4bf80,0xbf6d3f35,0x3ec4bf80,0xbf6d3f35,0xbef1bf35,0xbdc93f7b,0xbf623f35,0x3f7fbe48
.long 0xbf7ba554,0x3f553ec4,0x3f7b248d,0xbf55bec4,0xbf463f35,0x3f62bf0e,0xbf22bf35,0x3ef13f55
.long 0xbf803f80,0xbf803f80,0xbf803f80,0xbf803f80,0xbe953ec4,0xbdc93e48,0x3f75bf6d,0x3f7fbf7b
.long 0x3f55bf35,0x3f7bbf6d,0xbf553f35,0xbf7b3f6d,0x3f46bf6d,0x3e95bf0e,0x3f22bec4,0x3f75bf55
.long 0xbec4a554,0xbf6d3f35,0xbec4a554,0xbf6d3f35,0xbf7f3f6d,0xbef13f55,0x3dc93ec4,0x3f62bf0e
.long 0xbe483f35,0x3f55bec4,0x3e48bf35,0xbf553ec4,0x3f62bec4,0x3f22bf7b,0xbef13f6d,0x3f46be48
.long 0x3f35bf80,0xbf35a554,0x3f35bf80,0xbf35a554,0xbef1bec4,0xbf463f7b,0xbf623f6d,0x3f223e48
.long 0xbf7b3f35,0x3f0e3ec4,0x3f7bbf35,0xbf0ebec4,0xbdc93f6d,0x3f62bf55,0xbf7f3ec4,0x3ef13f0e
.long 0x3f6d248d,0xbec4bf35,0x3f6d248d,0xbec4bf35,0x3f22bf6d,0xbf753f0e,0xbf46bec4,0x3e953f55
.long 0xbf0ebf35,0x3e483f6d,0x3f0e3f35,0xbe48bf6d,0xbf753ec4,0x3f7fbe48,0xbe95bf6d,0x3dc93f7b
.long 0xbf803f80,0xbf803f80,0xbf803f80,0xbf803f80,0x3f7fbf80,0x3f75bf7b,0xbdc9a554,0xbe953e48
.long 0xbf7b3f80,0xbf553f6d,0x3f7bbf80,0x3f55bf6d,0x3f75bf80,0x3f22bf55,0x3e95248d,0x3f46bf0e
.long 0xbf6d3f80,0xbec43f35,0xbf6d3f80,0xbec43f35,0x3f62bf80,0x3dc9bf0e,0xbef1a554,0xbf7f3f55
.long 0xbf553f80,0x3e483ec4,0x3f55bf80,0xbe48bec4,0x3f46bf80,0xbef1be48,0x3f22248d,0x3f62bf7b
.long 0xbf353f80,0x3f35248d,0xbf353f80,0x3f35248d,0x3f22bf80,0xbf623e48,0xbf46a554,0xbef13f7b
.long 0xbf0e3f80,0x3f7bbec4,0x3f0ebf80,0xbf7b3ec4,0x3ef1bf80,0xbf7f3f0e,0x3f62248d,0xbdc9bf55
.long 0xbec43f80,0x3f6dbf35,0xbec43f80,0x3f6dbf35,0x3e95bf80,0xbf463f55,0xbf75a554,0x3f223f0e
.long 0xbe483f80,0x3f0ebf6d,0x3e48bf80,0xbf0e3f6d,0x3dc9bf80,0xbe953f7b,0x3f7f248d,0xbf75be48
.long 0xbf803f80,0xbf803f80,0xbf803f80,0xbf803f80,0x3f62bf6d,0x3f46bf55,0xbef13ec4,0xbf223f0e
.long 0xbf0e3f35,0xbe483ec4,0x3f0ebf35,0x3e48bec4,0x3dc9bec4,0xbef13e48,0x3f7fbf6d,0x3f62bf7b
.long 0x3ec4248d,0x3f6dbf35,0x3ec4248d,0x3f6dbf35,0xbf463ec4,0xbf753f7b,0xbf223f6d,0x3e953e48
.long 0x3f7bbf35,0x3f0ebf6d,0xbf7b3f35,0xbf0e3f6d,0xbf753f6d,0x3dc93f0e,0xbe95bec4,0xbf7f3f55
.long 0x3f35bf80,0xbf35a554,0x3f35bf80,0xbf35a554,0xbe953f6d,0x3f7fbf0e,0x3f75bec4,0x3dc9bf55
.long 0xbe48bf35,0xbf553f6d,0x3e483f35,0x3f55bf6d,0x3f223ec4,0x3e95bf7b,0xbf463f6d,0x3f75be48
.long 0xbf6da554,0x3ec43f35,0xbf6da554,0x3ec43f35,0x3f7fbec4,0xbf62be48,0xbdc9bf6d,0xbef13f7b
.long 0xbf553f35,0x3f7bbec4,0x3f55bf35,0xbf7b3ec4,0x3ef1bf6d,0xbf223f55,0x3f623ec4,0xbf46bf0e
.long 0xbf803f80,0xbf803f80,0xbf803f80,0xbf803f80,0x3f22bf35,0x3ef1bf0e,0xbf463f35,0xbf623f55
.long 0x3e48248d,0x3f0ebec4,0xbe48a554,0xbf0e3ec4,0xbf623f35,0xbf7f3f7b,0x3ef1bf35,0xbdc9be48
.long 0x3f6dbf80,0x3ec4bf35,0x3f6dbf80,0x3ec4bf35,0xbe953f35,0x3f22be48,0x3f75bf35,0x3f46bf7b
.long 0xbf0ea554,0xbf7b3f6d,0x3f0e248d,0x3f7bbf6d,0x3f7fbf35,0x3e95bf55,0xbdc93f35,0x3f75bf0e
.long 0xbf353f80,0x3f35248d,0xbf353f80,0x3f35248d,0xbdc9bf35,0xbf753f55,0xbf7f3f35,0x3e953f0e
.long 0x3f55248d,0x3e48bf6d,0xbf55a554,0xbe483f6d,0xbf753f35,0x3f463e48,0xbe95bf35,0xbf223f7b
.long 0x3ec4bf80,0xbf6d3f35,0x3ec4bf80,0xbf6d3f35,0x3ef13f35,0x3dc9bf7b,0x3f62bf35,0xbf7f3e48
.long 0xbf7ba554,0x3f553ec4,0x3f7b248d,0xbf55bec4,0x3f46bf35,0xbf623f0e,0x3f223f35,0xbef1bf55
.long 0xbf803f80,0xbf803f80,0xbf803f80,0xbf803f80,0x3e95bec4,0x3dc9be48,0xbf753f6d,0xbf7f3f7b
.long 0x3f55bf35,0x3f7bbf6d,0xbf553f35,0xbf7b3f6d,0xbf463f6d,0xbe953f0e,0xbf223ec4,0xbf753f55
.long 0xbec4a554,0xbf6d3f35,0xbec4a554,0xbf6d3f35,0x3f7fbf6d,0x3ef1bf55,0xbdc9bec4,0xbf623f0e
.long 0xbe483f35,0x3f55bec4,0x3e48bf35,0xbf553ec4,0xbf623ec4,0xbf223f7b,0x3ef1bf6d,0xbf463e48
.long 0x3f35bf80,0xbf35a554,0x3f35bf80,0xbf35a554,0x3ef13ec4,0x3f46bf7b,0x3f62bf6d,0xbf22be48
.long 0xbf7b3f35,0x3f0e3ec4,0x3f7bbf35,0xbf0ebec4,0x3dc9bf6d,0xbf623f55,0x3f7fbec4,0xbef1bf0e
.long 0x3f6d248d,0xbec4bf35,0x3f6d248d,0xbec4bf35,0xbf223f6d,0x3f75bf0e,0x3f463ec4,0xbe95bf55
.long 0xbf0ebf35,0x3e483f6d,0x3f0e3f35,0xbe48bf6d,0x3f75bec4,0xbf7f3e48,0x3e953f6d,0xbdc9bf7b
.long 0xa5543f80,0x248dbf80,0xa5543f80,0x248dbf80,0x3dc93f80,0xbe95bf7b,0x3f7f248d,0xbf753e48
.long 0x3e483f80,0xbf0ebf6d,0xbe48bf80,0x3f0e3f6d,0x3e953f80,0xbf46bf55,0xbf75a554,0x3f22bf0e
.long 0x3ec43f80,0xbf6dbf35,0x3ec43f80,0xbf6dbf35,0x3ef13f80,0xbf7fbf0e,0x3f62248d,0xbdc93f55
.long 0x3f0e3f80,0xbf7bbec4,0xbf0ebf80,0x3f7b3ec4,0x3f223f80,0xbf62be48,0xbf46a554,0xbef1bf7b
.long 0x3f353f80,0xbf35a554,0x3f353f80,0xbf35a554,0x3f463f80,0xbef13e48,0x3f22248d,0x3f623f7b
.long 0x3f553f80,0xbe483ec4,0xbf55bf80,0x3e48bec4,0x3f623f80,0x3dc93f0e,0xbef1a554,0xbf7fbf55
.long 0x3f6d3f80,0x3ec43f35,0x3f6d3f80,0x3ec43f35,0x3f753f80,0x3f223f55,0x3e95248d,0x3f463f0e
.long 0x3f7b3f80,0x3f553f6d,0xbf7bbf80,0xbf55bf6d,0x3f7f3f80,0x3f753f7b,0xbdc9a554,0xbe95be48
.long 0xa5543f80,0x248dbf80,0xa5543f80,0x248dbf80,0x3ef13f6d,0xbf22bf55,0x3f62bec4,0xbf463f0e
.long 0x3f553f35,0xbf7bbec4,0xbf55bf35,0x3f7b3ec4,0x3f7f3ec4,0xbf623e48,0xbdc93f6d,0xbef1bf7b
.long 0x3f6d248d,0xbec43f35,0x3f6d248d,0xbec43f35,0x3f22bec4,0x3e953f7b,0xbf46bf6d,0x3f753e48
.long 0x3e48bf35,0x3f553f6d,0xbe483f35,0xbf55bf6d,0xbe95bf6d,0x3f7f3f0e,0x3f753ec4,0x3dc93f55
.long 0xbf35bf80,0x3f35248d,0xbf35bf80,0x3f35248d,0xbf75bf6d,0x3dc9bf0e,0xbe953ec4,0xbf7fbf55
.long 0xbf7bbf35,0xbf0ebf6d,0x3f7b3f35,0x3f0e3f6d,0xbf46bec4,0xbf75bf7b,0xbf22bf6d,0x3e95be48
.long 0xbec4a554,0xbf6dbf35,0xbec4a554,0xbf6dbf35,0x3dc93ec4,0xbef1be48,0x3f7f3f6d,0x3f623f7b
.long 0x3f0e3f35,0x3e483ec4,0xbf0ebf35,0xbe48bec4,0x3f623f6d,0x3f463f55,0xbef1bec4,0xbf22bf0e
.long 0xa5543f80,0x248dbf80,0xa5543f80,0x248dbf80,0x3f463f35,0xbf62bf0e,0x3f22bf35,0xbef13f55
.long 0x3f7b248d,0xbf553ec4,0xbf7ba554,0x3f55bec4,0x3ef1bf35,0x3dc93f7b,0x3f623f35,0xbf7fbe48
.long 0xbec4bf80,0x3f6d3f35,0xbec4bf80,0x3f6d3f35,0xbf75bf35,0x3f46be48,0xbe953f35,0xbf22bf7b
.long 0xbf55a554,0xbe48bf6d,0x3f55248d,0x3e483f6d,0xbdc93f35,0xbf75bf55,0xbf7fbf35,0x3e95bf0e
.long 0x3f353f80,0xbf35a554,0x3f353f80,0xbf35a554,0x3f7f3f35,0x3e953f55,0xbdc9bf35,0x3f753f0e
.long 0x3f0e248d,0x3f7b3f6d,0xbf0ea554,0xbf7bbf6d,0xbe95bf35,0x3f223e48,0x3f753f35,0x3f463f7b
.long 0xbf6dbf80,0xbec4bf35,0xbf6dbf80,0xbec4bf35,0xbf62bf35,0xbf7fbf7b,0x3ef13f35,0xbdc93e48
.long 0xbe48a554,0xbf0ebec4,0x3e48248d,0x3f0e3ec4,0x3f223f35,0x3ef13f0e,0xbf46bf35,0xbf62bf55
.long 0xa5543f80,0x248dbf80,0xa5543f80,0x248dbf80,0x3f753ec4,0xbf7fbe48,0x3e95bf6d,0xbdc93f7b
.long 0x3f0ebf35,0xbe483f6d,0xbf0e3f35,0x3e48bf6d,0xbf22bf6d,0x3f753f0e,0x3f46bec4,0xbe953f55
.long 0xbf6da554,0x3ec4bf35,0xbf6da554,0x3ec4bf35,0x3dc93f6d,0xbf62bf55,0x3f7f3ec4,0xbef13f0e
.long 0x3f7b3f35,0xbf0e3ec4,0xbf7bbf35,0x3f0ebec4,0x3ef1bec4,0x3f463f7b,0x3f623f6d,0xbf223e48
.long 0xbf35bf80,0x3f35248d,0xbf35bf80,0x3f35248d,0xbf62bec4,0xbf22bf7b,0x3ef13f6d,0xbf46be48
.long 0x3e483f35,0xbf55bec4,0xbe48bf35,0x3f553ec4,0x3f7f3f6d,0x3ef13f55,0xbdc93ec4,0xbf62bf0e
.long 0x3ec4248d,0x3f6d3f35,0x3ec4248d,0x3f6d3f35,0xbf46bf6d,0xbe95bf0e,0xbf22bec4,0xbf75bf55
.long 0xbf55bf35,0xbf7bbf6d,0x3f553f35,0x3f7b3f6d,0x3e953ec4,0x3dc93e48,0xbf75bf6d,0xbf7fbf7b
.long 0xa5543f80,0x248dbf80,0xa5543f80,0x248dbf80,0xbdc9bf80,0x3e953f7b,0xbf7fa554,0x3f75be48
.long 0x3e483f80,0xbf0ebf6d,0xbe48bf80,0x3f0e3f6d,0xbe95bf80,0x3f463f55,0x3f75248d,0xbf223f0e
.long 0x3ec43f80,0xbf6dbf35,0x3ec43f80,0xbf6dbf35,0xbef1bf80,0x3f7f3f0e,0xbf62a554,0x3dc9bf55
.long 0x3f0e3f80,0xbf7bbec4,0xbf0ebf80,0x3f7b3ec4,0xbf22bf80,0x3f623e48,0x3f46248d,0x3ef13f7b
.long 0x3f353f80,0xbf35a554,0x3f353f80,0xbf35a554,0xbf46bf80,0x3ef1be48,0xbf22a554,0xbf62bf7b
.long 0x3f553f80,0xbe483ec4,0xbf55bf80,0x3e48bec4,0xbf62bf80,0xbdc9bf0e,0x3ef1248d,0x3f7f3f55
.long 0x3f6d3f80,0x3ec43f35,0x3f6d3f80,0x3ec43f35,0xbf75bf80,0xbf22bf55,0xbe95a554,0xbf46bf0e
.long 0x3f7b3f80,0x3f553f6d,0xbf7bbf80,0xbf55bf6d,0xbf7fbf80,0xbf75bf7b,0x3dc9248d,0x3e953e48
.long 0xa5543f80,0x248dbf80,0xa5543f80,0x248dbf80,0xbef1bf6d,0x3f223f55,0xbf623ec4,0x3f46bf0e
.long 0x3f553f35,0xbf7bbec4,0xbf55bf35,0x3f7b3ec4,0xbf7fbec4,0x3f62be48,0x3dc9bf6d,0x3ef13f7b
.long 0x3f6d248d,0xbec43f35,0x3f6d248d,0xbec43f35,0xbf223ec4,0xbe95bf7b,0x3f463f6d,0xbf75be48
.long 0x3e48bf35,0x3f553f6d,0xbe483f35,0xbf55bf6d,0x3e953f6d,0xbf7fbf0e,0xbf75bec4,0xbdc9bf55
.long 0xbf35bf80,0x3f35248d,0xbf35bf80,0x3f35248d,0x3f753f6d,0xbdc93f0e,0x3e95bec4,0x3f7f3f55
.long 0xbf7bbf35,0xbf0ebf6d,0x3f7b3f35,0x3f0e3f6d,0x3f463ec4,0x3f753f7b,0x3f223f6d,0xbe953e48
.long 0xbec4a554,0xbf6dbf35,0xbec4a554,0xbf6dbf35,0xbdc9bec4,0x3ef13e48,0xbf7fbf6d,0xbf62bf7b
.long 0x3f0e3f35,0x3e483ec4,0xbf0ebf35,0xbe48bec4,0xbf62bf6d,0xbf46bf55,0x3ef13ec4,0x3f223f0e
.long 0xa5543f80,0x248dbf80,0xa5543f80,0x248dbf80,0xbf46bf35,0x3f623f0e,0xbf223f35,0x3ef1bf55
.long 0x3f7b248d,0xbf553ec4,0xbf7ba554,0x3f55bec4,0xbef13f35,0xbdc9bf7b,0xbf62bf35,0x3f7f3e48
.long 0xbec4bf80,0x3f6d3f35,0xbec4bf80,0x3f6d3f35,0x3f753f35,0xbf463e48,0x3e95bf35,0x3f223f7b
.long 0xbf55a554,0xbe48bf6d,0x3f55248d,0x3e483f6d,0x3dc9bf35,0x3f753f55,0x3f7f3f35,0xbe953f0e
.long 0x3f353f80,0xbf35a554,0x3f353f80,0xbf35a554,0xbf7fbf35,0xbe95bf55,0x3dc93f35,0xbf75bf0e
.long 0x3f0e248d,0x3f7b3f6d,0xbf0ea554,0xbf7bbf6d,0x3e953f35,0xbf22be48,0xbf75bf35,0xbf46bf7b
.long 0xbf6dbf80,0xbec4bf35,0xbf6dbf80,0xbec4bf35,0x3f623f35,0x3f7f3f7b,0xbef1bf35,0x3dc9be48
.long 0xbe48a554,0xbf0ebec4,0x3e48248d,0x3f0e3ec4,0xbf22bf35,0xbef1bf0e,0x3f463f35,0x3f623f55
.long 0xa5543f80,0x248dbf80,0xa5543f80,0x248dbf80,0xbf75bec4,0x3f7f3e48,0xbe953f6d,0x3dc9bf7b
.long 0x3f0ebf35,0xbe483f6d,0xbf0e3f35,0x3e48bf6d,0x3f223f6d,0xbf75bf0e,0xbf463ec4,0x3e95bf55
.long 0xbf6da554,0x3ec4bf35,0xbf6da554,0x3ec4bf35,0xbdc9bf6d,0x3f623f55,0xbf7fbec4,0x3ef1bf0e
.long 0x3f7b3f35,0xbf0e3ec4,0xbf7bbf35,0x3f0ebec4,0xbef13ec4,0xbf46bf7b,0xbf62bf6d,0x3f22be48
.long 0xbf35bf80,0x3f35248d,0xbf35bf80,0x3f35248d,0x3f623ec4,0x3f223f7b,0xbef1bf6d,0x3f463e48
.long 0x3e483f35,0xbf55bec4,0xbe48bf35,0x3f553ec4,0xbf7fbf6d,0xbef1bf55,0x3dc9bec4,0x3f623f0e
.long 0x3ec4248d,0x3f6d3f35,0x3ec4248d,0x3f6d3f35,0x3f463f6d,0x3e953f0e,0x3f223ec4,0x3f753f55
.long 0xbf55bf35,0xbf7bbf6d,0x3f553f35,0x3f7b3f6d,0xbe95bec4,0xbdc9be48,0x3f753f6d,0x3f7f3f7b
.long 0x0,0x0,0x0,0x0,0x3dc90000,0x3e953e48,0x3f7f3f80,0x3f753f7b
.long 0x3e480000,0x3f0e3ec4,0xbe48250d,0xbf0ebec4,0x3e950000,0x3f463f0e,0xbf75bf80,0xbf22bf55
.long 0x3ec40000,0x3f6d3f35,0x3ec40000,0x3f6d3f35,0x3ef10000,0x3f7f3f55,0x3f623f80,0x3dc93f0e
.long 0x3f0e0000,0x3f7b3f6d,0xbf0e250d,0xbf7bbf6d,0x3f220000,0x3f623f7b,0xbf46bf80,0x3ef1be48
.long 0x3f350000,0x3f353f80,0x3f350000,0x3f353f80,0x3f460000,0x3ef13f7b,0x3f223f80,0xbf62be48
.long 0x3f550000,0x3e483f6d,0xbf55250d,0xbe48bf6d,0x3f620000,0xbdc93f55,0xbef1bf80,0x3f7f3f0e
.long 0x3f6d0000,0xbec43f35,0x3f6d0000,0xbec43f35,0x3f750000,0xbf223f0e,0x3e953f80,0xbf46bf55
.long 0x3f7b0000,0xbf553ec4,0xbf7b250d,0x3f55bec4,0x3f7f0000,0xbf753e48,0xbdc9bf80,0x3e953f7b
.long 0x0,0x0,0x0,0x0,0x3ef13ec4,0x3f223f0e,0x3f623f6d,0x3f463f55
.long 0x3f553f35,0x3f7b3f6d,0xbf55bf35,0xbf7bbf6d,0x3f7f3f6d,0x3f623f7b,0xbdc9bec4,0x3ef13e48
.long 0x3f6d3f80,0x3ec43f35,0x3f6d3f80,0x3ec43f35,0x3f223f6d,0xbe953e48,0xbf46bec4,0xbf75bf7b
.long 0x3e483f35,0xbf55bec4,0xbe48bf35,0x3f553ec4,0xbe953ec4,0xbf7fbf55,0x3f753f6d,0xbdc93f0e
.long 0xbf35250d,0xbf35bf80,0xbf35250d,0xbf35bf80,0xbf75bec4,0xbdc9bf55,0xbe95bf6d,0x3f7f3f0e
.long 0xbf7bbf35,0x3f0ebec4,0x3f7b3f35,0xbf0e3ec4,0xbf46bf6d,0x3f753e48,0xbf223ec4,0xbe95bf7b
.long 0xbec4bf80,0x3f6d3f35,0xbec4bf80,0x3f6d3f35,0x3dc9bf6d,0x3ef13f7b,0x3f7f3ec4,0xbf623e48
.long 0x3f0ebf35,0xbe483f6d,0xbf0e3f35,0x3e48bf6d,0x3f62bec4,0xbf463f0e,0xbef1bf6d,0x3f223f55
.long 0x0,0x0,0x0,0x0,0x3f463f35,0x3f623f55,0x3f223f35,0x3ef13f0e
.long 0x3f7b3f80,0x3f553f6d,0xbf7bbf80,0xbf55bf6d,0x3ef13f35,0xbdc93e48,0x3f623f35,0x3f7f3f7b
.long 0xbec4250d,0xbf6dbf35,0xbec4250d,0xbf6dbf35,0xbf75bf35,0xbf46bf7b,0xbe95bf35,0x3f223e48
.long 0xbf55bf80,0x3e48bec4,0x3f553f80,0xbe483ec4,0xbdc9bf35,0x3f753f0e,0xbf7fbf35,0xbe95bf55
.long 0x3f350000,0x3f353f80,0x3f350000,0x3f353f80,0x3f7f3f35,0xbe953f0e,0xbdc93f35,0xbf75bf55
.long 0x3f0e3f80,0xbf7bbec4,0xbf0ebf80,0x3f7b3ec4,0xbe953f35,0xbf22bf7b,0x3f753f35,0xbf463e48
.long 0xbf6d250d,0x3ec4bf35,0xbf6d250d,0x3ec4bf35,0xbf62bf35,0x3f7f3e48,0x3ef1bf35,0x3dc93f7b
.long 0xbe48bf80,0x3f0e3f6d,0x3e483f80,0xbf0ebf6d,0x3f22bf35,0xbef13f55,0xbf46bf35,0x3f623f0e
.long 0x0,0x0,0x0,0x0,0x3f753f6d,0x3f7f3f7b,0x3e953ec4,0x3dc93e48
.long 0x3f0e3f35,0x3e483ec4,0xbf0ebf35,0xbe48bec4,0xbf22bec4,0xbf75bf55,0x3f463f6d,0x3e953f0e
.long 0xbf6dbf80,0xbec4bf35,0xbf6dbf80,0xbec4bf35,0x3dc9bec4,0x3f623f0e,0x3f7f3f6d,0x3ef13f55
.long 0x3f7b3f35,0x3f0e3f6d,0xbf7bbf35,0xbf0ebf6d,0x3ef13f6d,0xbf46be48,0x3f623ec4,0x3f223f7b
.long 0xbf35250d,0xbf35bf80,0xbf35250d,0xbf35bf80,0xbf62bf6d,0x3f22be48,0x3ef1bec4,0x3f463f7b
.long 0x3e48bf35,0x3f553f6d,0xbe483f35,0xbf55bf6d,0x3f7f3ec4,0xbef13f0e,0xbdc9bf6d,0x3f623f55
.long 0x3ec43f80,0xbf6dbf35,0x3ec43f80,0xbf6dbf35,0xbf463ec4,0x3e95bf55,0xbf22bf6d,0x3f753f0e
.long 0xbf55bf35,0x3f7b3ec4,0x3f553f35,0xbf7bbec4,0x3e95bf6d,0xbdc93f7b,0xbf75bec4,0x3f7f3e48
.long 0x0,0x0,0x0,0x0,0xbdc9250d,0xbe95be48,0xbf7fbf80,0xbf75bf7b
.long 0x3e480000,0x3f0e3ec4,0xbe48250d,0xbf0ebec4,0xbe95250d,0xbf46bf0e,0x3f753f80,0x3f223f55
.long 0x3ec40000,0x3f6d3f35,0x3ec40000,0x3f6d3f35,0xbef1250d,0xbf7fbf55,0xbf62bf80,0xbdc9bf0e
.long 0x3f0e0000,0x3f7b3f6d,0xbf0e250d,0xbf7bbf6d,0xbf22250d,0xbf62bf7b,0x3f463f80,0xbef13e48
.long 0x3f350000,0x3f353f80,0x3f350000,0x3f353f80,0xbf46250d,0xbef1bf7b,0xbf22bf80,0x3f623e48
.long 0x3f550000,0x3e483f6d,0xbf55250d,0xbe48bf6d,0xbf62250d,0x3dc9bf55,0x3ef13f80,0xbf7fbf0e
.long 0x3f6d0000,0xbec43f35,0x3f6d0000,0xbec43f35,0xbf75250d,0x3f22bf0e,0xbe95bf80,0x3f463f55
.long 0x3f7b0000,0xbf553ec4,0xbf7b250d,0x3f55bec4,0xbf7f250d,0x3f75be48,0x3dc93f80,0xbe95bf7b
.long 0x0,0x0,0x0,0x0,0xbef1bec4,0xbf22bf0e,0xbf62bf6d,0xbf46bf55
.long 0x3f553f35,0x3f7b3f6d,0xbf55bf35,0xbf7bbf6d,0xbf7fbf6d,0xbf62bf7b,0x3dc93ec4,0xbef1be48
.long 0x3f6d3f80,0x3ec43f35,0x3f6d3f80,0x3ec43f35,0xbf22bf6d,0x3e95be48,0x3f463ec4,0x3f753f7b
.long 0x3e483f35,0xbf55bec4,0xbe48bf35,0x3f553ec4,0x3e95bec4,0x3f7f3f55,0xbf75bf6d,0x3dc9bf0e
.long 0xbf35250d,0xbf35bf80,0xbf35250d,0xbf35bf80,0x3f753ec4,0x3dc93f55,0x3e953f6d,0xbf7fbf0e
.long 0xbf7bbf35,0x3f0ebec4,0x3f7b3f35,0xbf0e3ec4,0x3f463f6d,0xbf75be48,0x3f22bec4,0x3e953f7b
.long 0xbec4bf80,0x3f6d3f35,0xbec4bf80,0x3f6d3f35,0xbdc93f6d,0xbef1bf7b,0xbf7fbec4,0x3f62be48
.long 0x3f0ebf35,0xbe483f6d,0xbf0e3f35,0x3e48bf6d,0xbf623ec4,0x3f46bf0e,0x3ef13f6d,0xbf22bf55
.long 0x0,0x0,0x0,0x0,0xbf46bf35,0xbf62bf55,0xbf22bf35,0xbef1bf0e
.long 0x3f7b3f80,0x3f553f6d,0xbf7bbf80,0xbf55bf6d,0xbef1bf35,0x3dc9be48,0xbf62bf35,0xbf7fbf7b
.long 0xbec4250d,0xbf6dbf35,0xbec4250d,0xbf6dbf35,0x3f753f35,0x3f463f7b,0x3e953f35,0xbf22be48
.long 0xbf55bf80,0x3e48bec4,0x3f553f80,0xbe483ec4,0x3dc93f35,0xbf75bf0e,0x3f7f3f35,0x3e953f55
.long 0x3f350000,0x3f353f80,0x3f350000,0x3f353f80,0xbf7fbf35,0x3e95bf0e,0x3dc9bf35,0x3f753f55
.long 0x3f0e3f80,0xbf7bbec4,0xbf0ebf80,0x3f7b3ec4,0x3e95bf35,0x3f223f7b,0xbf75bf35,0x3f46be48
.long 0xbf6d250d,0x3ec4bf35,0xbf6d250d,0x3ec4bf35,0x3f623f35,0xbf7fbe48,0xbef13f35,0xbdc9bf7b
.long 0xbe48bf80,0x3f0e3f6d,0x3e483f80,0xbf0ebf6d,0xbf223f35,0x3ef1bf55,0x3f463f35,0xbf62bf0e
.long 0x0,0x0,0x0,0x0,0xbf75bf6d,0xbf7fbf7b,0xbe95bec4,0xbdc9be48
.long 0x3f0e3f35,0x3e483ec4,0xbf0ebf35,0xbe48bec4,0x3f223ec4,0x3f753f55,0xbf46bf6d,0xbe95bf0e
.long 0xbf6dbf80,0xbec4bf35,0xbf6dbf80,0xbec4bf35,0xbdc93ec4,0xbf62bf0e,0xbf7fbf6d,0xbef1bf55
.long 0x3f7b3f35,0x3f0e3f6d,0xbf7bbf35,0xbf0ebf6d,0xbef1bf6d,0x3f463e48,0xbf62bec4,0xbf22bf7b
.long 0xbf35250d,0xbf35bf80,0xbf35250d,0xbf35bf80,0x3f623f6d,0xbf223e48,0xbef13ec4,0xbf46bf7b
.long 0x3e48bf35,0x3f553f6d,0xbe483f35,0xbf55bf6d,0xbf7fbec4,0x3ef1bf0e,0x3dc93f6d,0xbf62bf55
.long 0x3ec43f80,0xbf6dbf35,0x3ec43f80,0xbf6dbf35,0x3f46bec4,0xbe953f55,0x3f223f6d,0xbf75bf0e
.long 0xbf55bf35,0x3f7b3ec4,0x3f553f35,0xbf7bbec4,0xbe953f6d,0x3dc9bf7b,0x3f753ec4,0xbf7fbe48
.long 0x3f800000,0xbf80250d,0x3f800000,0xbf80250d,0x3f7f0000,0xbf75be48,0xbdc93f80,0x3e95bf7b
.long 0x3f7b0000,0xbf55bec4,0xbf7b250d,0x3f553ec4,0x3f750000,0xbf22bf0e,0x3e95bf80,0xbf463f55
.long 0x3f6d0000,0xbec4bf35,0x3f6d0000,0xbec4bf35,0x3f620000,0xbdc9bf55,0xbef13f80,0x3f7fbf0e
.long 0x3f550000,0x3e48bf6d,0xbf55250d,0xbe483f6d,0x3f460000,0x3ef1bf7b,0x3f22bf80,0xbf623e48
.long 0x3f350000,0x3f35bf80,0x3f350000,0x3f35bf80,0x3f220000,0x3f62bf7b,0xbf463f80,0x3ef13e48
.long 0x3f0e0000,0x3f7bbf6d,0xbf0e250d,0xbf7b3f6d,0x3ef10000,0x3f7fbf55,0x3f62bf80,0x3dc9bf0e
.long 0x3ec40000,0x3f6dbf35,0x3ec40000,0x3f6dbf35,0x3e950000,0x3f46bf0e,0xbf753f80,0xbf223f55
.long 0x3e480000,0x3f0ebec4,0xbe48250d,0xbf0e3ec4,0x3dc90000,0x3e95be48,0x3f7fbf80,0x3f75bf7b
.long 0x3f800000,0xbf80250d,0x3f800000,0xbf80250d,0x3f623ec4,0xbf46bf0e,0xbef13f6d,0x3f22bf55
.long 0x3f0e3f35,0xbe48bf6d,0xbf0ebf35,0x3e483f6d,0x3dc93f6d,0x3ef1bf7b,0x3f7fbec4,0xbf62be48
.long 0xbec43f80,0x3f6dbf35,0xbec43f80,0x3f6dbf35,0xbf463f6d,0x3f75be48,0xbf22bec4,0xbe953f7b
.long 0xbf7b3f35,0x3f0e3ec4,0x3f7bbf35,0xbf0ebec4,0xbf753ec4,0xbdc93f55,0xbe953f6d,0x3f7fbf0e
.long 0xbf35250d,0xbf353f80,0xbf35250d,0xbf353f80,0xbe95bec4,0xbf7f3f55,0x3f75bf6d,0xbdc9bf0e
.long 0x3e48bf35,0xbf553ec4,0xbe483f35,0x3f55bec4,0x3f22bf6d,0xbe95be48,0xbf463ec4,0xbf753f7b
.long 0x3f6dbf80,0x3ec4bf35,0x3f6dbf80,0x3ec4bf35,0x3f7fbf6d,0x3f62bf7b,0xbdc93ec4,0x3ef1be48
.long 0x3f55bf35,0x3f7bbf6d,0xbf553f35,0xbf7b3f6d,0x3ef1bec4,0x3f22bf0e,0x3f62bf6d,0x3f46bf55
.long 0x3f800000,0xbf80250d,0x3f800000,0xbf80250d,0x3f223f35,0xbef1bf55,0xbf463f35,0x3f62bf0e
.long 0xbe483f80,0x3f0ebf6d,0x3e48bf80,0xbf0e3f6d,0xbf623f35,0x3f7fbe48,0x3ef13f35,0x3dc9bf7b
.long 0xbf6d250d,0x3ec43f35,0xbf6d250d,0x3ec43f35,0xbe95bf35,0xbf223f7b,0x3f75bf35,0xbf46be48
.long 0x3f0ebf80,0xbf7b3ec4,0xbf0e3f80,0x3f7bbec4,0x3f7fbf35,0xbe95bf0e,0xbdc9bf35,0xbf753f55
.long 0x3f350000,0x3f35bf80,0x3f350000,0x3f35bf80,0xbdc93f35,0x3f75bf0e,0xbf7f3f35,0xbe953f55
.long 0xbf553f80,0x3e483ec4,0x3f55bf80,0xbe48bec4,0xbf753f35,0xbf463f7b,0xbe953f35,0x3f22be48
.long 0xbec4250d,0xbf6d3f35,0xbec4250d,0xbf6d3f35,0x3ef1bf35,0xbdc9be48,0x3f62bf35,0x3f7fbf7b
.long 0x3f7bbf80,0x3f55bf6d,0xbf7b3f80,0xbf553f6d,0x3f46bf35,0x3f62bf55,0x3f22bf35,0x3ef1bf0e
.long 0x3f800000,0xbf80250d,0x3f800000,0xbf80250d,0x3e953f6d,0xbdc9bf7b,0xbf753ec4,0x3f7fbe48
.long 0xbf553f35,0x3f7bbec4,0x3f55bf35,0xbf7b3ec4,0xbf46bec4,0x3e953f55,0xbf223f6d,0x3f75bf0e
.long 0x3ec4bf80,0xbf6d3f35,0x3ec4bf80,0xbf6d3f35,0x3f7fbec4,0xbef1bf0e,0xbdc93f6d,0x3f62bf55
.long 0x3e483f35,0x3f55bf6d,0xbe48bf35,0xbf553f6d,0xbf623f6d,0x3f223e48,0x3ef13ec4,0x3f46bf7b
.long 0xbf35250d,0xbf353f80,0xbf35250d,0xbf353f80,0x3ef1bf6d,0xbf463e48,0x3f62bec4,0x3f22bf7b
.long 0x3f7bbf35,0x3f0ebf6d,0xbf7b3f35,0xbf0e3f6d,0x3dc93ec4,0x3f62bf0e,0x3f7fbf6d,0x3ef1bf55
.long 0xbf6d3f80,0xbec43f35,0xbf6d3f80,0xbec43f35,0xbf223ec4,0xbf753f55,0x3f46bf6d,0x3e95bf0e
.long 0x3f0ebf35,0x3e48bec4,0xbf0e3f35,0xbe483ec4,0x3f75bf6d,0x3f7fbf7b,0x3e95bec4,0x3dc9be48
.long 0x3f800000,0xbf80250d,0x3f800000,0xbf80250d,0xbf7f250d,0x3f753e48,0x3dc9bf80,0xbe953f7b
.long 0x3f7b0000,0xbf55bec4,0xbf7b250d,0x3f553ec4,0xbf75250d,0x3f223f0e,0xbe953f80,0x3f46bf55
.long 0x3f6d0000,0xbec4bf35,0x3f6d0000,0xbec4bf35,0xbf62250d,0x3dc93f55,0x3ef1bf80,0xbf7f3f0e
.long 0x3f550000,0x3e48bf6d,0xbf55250d,0xbe483f6d,0xbf46250d,0xbef13f7b,0xbf223f80,0x3f62be48
.long 0x3f350000,0x3f35bf80,0x3f350000,0x3f35bf80,0xbf22250d,0xbf623f7b,0x3f46bf80,0xbef1be48
.long 0x3f0e0000,0x3f7bbf6d,0xbf0e250d,0xbf7b3f6d,0xbef1250d,0xbf7f3f55,0xbf623f80,0xbdc93f0e
.long 0x3ec40000,0x3f6dbf35,0x3ec40000,0x3f6dbf35,0xbe95250d,0xbf463f0e,0x3f75bf80,0x3f22bf55
.long 0x3e480000,0x3f0ebec4,0xbe48250d,0xbf0e3ec4,0xbdc9250d,0xbe953e48,0xbf7f3f80,0xbf753f7b
.long 0x3f800000,0xbf80250d,0x3f800000,0xbf80250d,0xbf62bec4,0x3f463f0e,0x3ef1bf6d,0xbf223f55
.long 0x3f0e3f35,0xbe48bf6d,0xbf0ebf35,0x3e483f6d,0xbdc9bf6d,0xbef13f7b,0xbf7f3ec4,0x3f623e48
.long 0xbec43f80,0x3f6dbf35,0xbec43f80,0x3f6dbf35,0x3f46bf6d,0xbf753e48,0x3f223ec4,0x3e95bf7b
.long 0xbf7b3f35,0x3f0e3ec4,0x3f7bbf35,0xbf0ebec4,0x3f75bec4,0x3dc9bf55,0x3e95bf6d,0xbf7f3f0e
.long 0xbf35250d,0xbf353f80,0xbf35250d,0xbf353f80,0x3e953ec4,0x3f7fbf55,0xbf753f6d,0x3dc93f0e
.long 0x3e48bf35,0xbf553ec4,0xbe483f35,0x3f55bec4,0xbf223f6d,0x3e953e48,0x3f46bec4,0x3f75bf7b
.long 0x3f6dbf80,0x3ec4bf35,0x3f6dbf80,0x3ec4bf35,0xbf7f3f6d,0xbf623f7b,0x3dc9bec4,0xbef13e48
.long 0x3f55bf35,0x3f7bbf6d,0xbf553f35,0xbf7b3f6d,0xbef13ec4,0xbf223f0e,0xbf623f6d,0xbf463f55
.long 0x3f800000,0xbf80250d,0x3f800000,0xbf80250d,0xbf22bf35,0x3ef13f55,0x3f46bf35,0xbf623f0e
.long 0xbe483f80,0x3f0ebf6d,0x3e48bf80,0xbf0e3f6d,0x3f62bf35,0xbf7f3e48,0xbef1bf35,0xbdc93f7b
.long 0xbf6d250d,0x3ec43f35,0xbf6d250d,0x3ec43f35,0x3e953f35,0x3f22bf7b,0xbf753f35,0x3f463e48
.long 0x3f0ebf80,0xbf7b3ec4,0xbf0e3f80,0x3f7bbec4,0xbf7f3f35,0x3e953f0e,0x3dc93f35,0x3f75bf55
.long 0x3f350000,0x3f35bf80,0x3f350000,0x3f35bf80,0x3dc9bf35,0xbf753f0e,0x3f7fbf35,0x3e95bf55
.long 0xbf553f80,0x3e483ec4,0x3f55bf80,0xbe48bec4,0x3f75bf35,0x3f46bf7b,0x3e95bf35,0xbf223e48
.long 0xbec4250d,0xbf6d3f35,0xbec4250d,0xbf6d3f35,0xbef13f35,0x3dc93e48,0xbf623f35,0xbf7f3f7b
.long 0x3f7bbf80,0x3f55bf6d,0xbf7b3f80,0xbf553f6d,0xbf463f35,0xbf623f55,0xbf223f35,0xbef13f0e
.long 0x3f800000,0xbf80250d,0x3f800000,0xbf80250d,0xbe95bf6d,0x3dc93f7b,0x3f75bec4,0xbf7f3e48
.long 0xbf553f35,0x3f7bbec4,0x3f55bf35,0xbf7b3ec4,0x3f463ec4,0xbe95bf55,0x3f22bf6d,0xbf753f0e
.long 0x3ec4bf80,0xbf6d3f35,0x3ec4bf80,0xbf6d3f35,0xbf7f3ec4,0x3ef13f0e,0x3dc9bf6d,0xbf623f55
.long 0x3e483f35,0x3f55bf6d,0xbe48bf35,0xbf553f6d,0x3f62bf6d,0xbf22be48,0xbef1bec4,0xbf463f7b
.long 0xbf35250d,0xbf353f80,0xbf35250d,0xbf353f80,0xbef13f6d,0x3f46be48,0xbf623ec4,0xbf223f7b
.long 0x3f7bbf35,0x3f0ebf6d,0xbf7b3f35,0xbf0e3f6d,0xbdc9bec4,0xbf623f0e,0xbf7f3f6d,0xbef13f55
.long 0xbf6d3f80,0xbec43f35,0xbf6d3f80,0xbec43f35,0x3f22bec4,0x3f75bf55,0xbf463f6d,0xbe953f0e
.long 0x3f0ebf35,0x3e48bec4,0xbf0e3f35,0xbe483ec4,0xbf753f6d,0xbf7f3f7b,0xbe953ec4,0xbdc93e48
.long 0x250d0000,0x250d0000,0x250d0000,0x250d0000,0xbdc90000,0xbe953e48,0xbf7f3f80,0xbf753f7b
.long 0xbe480000,0xbf0e3ec4,0x3e48250d,0x3f0ebec4,0xbe950000,0xbf463f0e,0x3f75bf80,0x3f22bf55
.long 0xbec40000,0xbf6d3f35,0xbec40000,0xbf6d3f35,0xbef10000,0xbf7f3f55,0xbf623f80,0xbdc93f0e
.long 0xbf0e0000,0xbf7b3f6d,0x3f0e250d,0x3f7bbf6d,0xbf220000,0xbf623f7b,0x3f46bf80,0xbef1be48
.long 0xbf350000,0xbf353f80,0xbf350000,0xbf353f80,0xbf460000,0xbef13f7b,0xbf223f80,0x3f62be48
.long 0xbf550000,0xbe483f6d,0x3f55250d,0x3e48bf6d,0xbf620000,0x3dc93f55,0x3ef1bf80,0xbf7f3f0e
.long 0xbf6d0000,0x3ec43f35,0xbf6d0000,0x3ec43f35,0xbf750000,0x3f223f0e,0xbe953f80,0x3f46bf55
.long 0xbf7b0000,0x3f553ec4,0x3f7b250d,0xbf55bec4,0xbf7f0000,0x3f753e48,0x3dc9bf80,0xbe953f7b
.long 0x250d0000,0x250d0000,0x250d0000,0x250d0000,0xbef13ec4,0xbf223f0e,0xbf623f6d,0xbf463f55
.long 0xbf553f35,0xbf7b3f6d,0x3f55bf35,0x3f7bbf6d,0xbf7f3f6d,0xbf623f7b,0x3dc9bec4,0xbef13e48
.long 0xbf6d3f80,0xbec43f35,0xbf6d3f80,0xbec43f35,0xbf223f6d,0x3e953e48,0x3f46bec4,0x3f75bf7b
.long 0xbe483f35,0x3f55bec4,0x3e48bf35,0xbf553ec4,0x3e953ec4,0x3f7fbf55,0xbf753f6d,0x3dc93f0e
.long 0x3f35250d,0x3f35bf80,0x3f35250d,0x3f35bf80,0x3f75bec4,0x3dc9bf55,0x3e95bf6d,0xbf7f3f0e
.long 0x3f7bbf35,0xbf0ebec4,0xbf7b3f35,0x3f0e3ec4,0x3f46bf6d,0xbf753e48,0x3f223ec4,0x3e95bf7b
.long 0x3ec4bf80,0xbf6d3f35,0x3ec4bf80,0xbf6d3f35,0xbdc9bf6d,0xbef13f7b,0xbf7f3ec4,0x3f623e48
.long 0xbf0ebf35,0x3e483f6d,0x3f0e3f35,0xbe48bf6d,0xbf62bec4,0x3f463f0e,0x3ef1bf6d,0xbf223f55
.long 0x250d0000,0x250d0000,0x250d0000,0x250d0000,0xbf463f35,0xbf623f55,0xbf223f35,0xbef13f0e
.long 0xbf7b3f80,0xbf553f6d,0x3f7bbf80,0x3f55bf6d,0xbef13f35,0x3dc93e48,0xbf623f35,0xbf7f3f7b
.long 0x3ec4250d,0x3f6dbf35,0x3ec4250d,0x3f6dbf35,0x3f75bf35,0x3f46bf7b,0x3e95bf35,0xbf223e48
.long 0x3f55bf80,0xbe48bec4,0xbf553f80,0x3e483ec4,0x3dc9bf35,0xbf753f0e,0x3f7fbf35,0x3e95bf55
.long 0xbf350000,0xbf353f80,0xbf350000,0xbf353f80,0xbf7f3f35,0x3e953f0e,0x3dc93f35,0x3f75bf55
.long 0xbf0e3f80,0x3f7bbec4,0x3f0ebf80,0xbf7b3ec4,0x3e953f35,0x3f22bf7b,0xbf753f35,0x3f463e48
.long 0x3f6d250d,0xbec4bf35,0x3f6d250d,0xbec4bf35,0x3f62bf35,0xbf7f3e48,0xbef1bf35,0xbdc93f7b
.long 0x3e48bf80,0xbf0e3f6d,0xbe483f80,0x3f0ebf6d,0xbf22bf35,0x3ef13f55,0x3f46bf35,0xbf623f0e
.long 0x250d0000,0x250d0000,0x250d0000,0x250d0000,0xbf753f6d,0xbf7f3f7b,0xbe953ec4,0xbdc93e48
.long 0xbf0e3f35,0xbe483ec4,0x3f0ebf35,0x3e48bec4,0x3f22bec4,0x3f75bf55,0xbf463f6d,0xbe953f0e
.long 0x3f6dbf80,0x3ec4bf35,0x3f6dbf80,0x3ec4bf35,0xbdc9bec4,0xbf623f0e,0xbf7f3f6d,0xbef13f55
.long 0xbf7b3f35,0xbf0e3f6d,0x3f7bbf35,0x3f0ebf6d,0xbef13f6d,0x3f46be48,0xbf623ec4,0xbf223f7b
.long 0x3f35250d,0x3f35bf80,0x3f35250d,0x3f35bf80,0x3f62bf6d,0xbf22be48,0xbef1bec4,0xbf463f7b
.long 0xbe48bf35,0xbf553f6d,0x3e483f35,0x3f55bf6d,0xbf7f3ec4,0x3ef13f0e,0x3dc9bf6d,0xbf623f55
.long 0xbec43f80,0x3f6dbf35,0xbec43f80,0x3f6dbf35,0x3f463ec4,0xbe95bf55,0x3f22bf6d,0xbf753f0e
.long 0x3f55bf35,0xbf7b3ec4,0xbf553f35,0x3f7bbec4,0xbe95bf6d,0x3dc93f7b,0x3f75bec4,0xbf7f3e48
.long 0x250d0000,0x250d0000,0x250d0000,0x250d0000,0x3dc9250d,0x3e95be48,0x3f7fbf80,0x3f75bf7b
.long 0xbe480000,0xbf0e3ec4,0x3e48250d,0x3f0ebec4,0x3e95250d,0x3f46bf0e,0xbf753f80,0xbf223f55
.long 0xbec40000,0xbf6d3f35,0xbec40000,0xbf6d3f35,0x3ef1250d,0x3f7fbf55,0x3f62bf80,0x3dc9bf0e
.long 0xbf0e0000,0xbf7b3f6d,0x3f0e250d,0x3f7bbf6d,0x3f22250d,0x3f62bf7b,0xbf463f80,0x3ef13e48
.long 0xbf350000,0xbf353f80,0xbf350000,0xbf353f80,0x3f46250d,0x3ef1bf7b,0x3f22bf80,0xbf623e48
.long 0xbf550000,0xbe483f6d,0x3f55250d,0x3e48bf6d,0x3f62250d,0xbdc9bf55,0xbef13f80,0x3f7fbf0e
.long 0xbf6d0000,0x3ec43f35,0xbf6d0000,0x3ec43f35,0x3f75250d,0xbf22bf0e,0x3e95bf80,0xbf463f55
.long 0xbf7b0000,0x3f553ec4,0x3f7b250d,0xbf55bec4,0x3f7f250d,0xbf75be48,0xbdc93f80,0x3e95bf7b
.long 0x250d0000,0x250d0000,0x250d0000,0x250d0000,0x3ef1bec4,0x3f22bf0e,0x3f62bf6d,0x3f46bf55
.long 0xbf553f35,0xbf7b3f6d,0x3f55bf35,0x3f7bbf6d,0x3f7fbf6d,0x3f62bf7b,0xbdc93ec4,0x3ef1be48
.long 0xbf6d3f80,0xbec43f35,0xbf6d3f80,0xbec43f35,0x3f22bf6d,0xbe95be48,0xbf463ec4,0xbf753f7b
.long 0xbe483f35,0x3f55bec4,0x3e48bf35,0xbf553ec4,0xbe95bec4,0xbf7f3f55,0x3f75bf6d,0xbdc9bf0e
.long 0x3f35250d,0x3f35bf80,0x3f35250d,0x3f35bf80,0xbf753ec4,0xbdc93f55,0xbe953f6d,0x3f7fbf0e
.long 0x3f7bbf35,0xbf0ebec4,0xbf7b3f35,0x3f0e3ec4,0xbf463f6d,0x3f75be48,0xbf22bec4,0xbe953f7b
.long 0x3ec4bf80,0xbf6d3f35,0x3ec4bf80,0xbf6d3f35,0x3dc93f6d,0x3ef1bf7b,0x3f7fbec4,0xbf62be48
.long 0xbf0ebf35,0x3e483f6d,0x3f0e3f35,0xbe48bf6d,0x3f623ec4,0xbf46bf0e,0xbef13f6d,0x3f22bf55
.long 0x250d0000,0x250d0000,0x250d0000,0x250d0000,0x3f46bf35,0x3f62bf55,0x3f22bf35,0x3ef1bf0e
.long 0xbf7b3f80,0xbf553f6d,0x3f7bbf80,0x3f55bf6d,0x3ef1bf35,0xbdc9be48,0x3f62bf35,0x3f7fbf7b
.long 0x3ec4250d,0x3f6dbf35,0x3ec4250d,0x3f6dbf35,0xbf753f35,0xbf463f7b,0xbe953f35,0x3f22be48
.long 0x3f55bf80,0xbe48bec4,0xbf553f80,0x3e483ec4,0xbdc93f35,0x3f75bf0e,0xbf7f3f35,0xbe953f55
.long 0xbf350000,0xbf353f80,0xbf350000,0xbf353f80,0x3f7fbf35,0xbe95bf0e,0xbdc9bf35,0xbf753f55
.long 0xbf0e3f80,0x3f7bbec4,0x3f0ebf80,0xbf7b3ec4,0xbe95bf35,0xbf223f7b,0x3f75bf35,0xbf46be48
.long 0x3f6d250d,0xbec4bf35,0x3f6d250d,0xbec4bf35,0xbf623f35,0x3f7fbe48,0x3ef13f35,0x3dc9bf7b
.long 0x3e48bf80,0xbf0e3f6d,0xbe483f80,0x3f0ebf6d,0x3f223f35,0xbef1bf55,0xbf463f35,0x3f62bf0e
.long 0x250d0000,0x250d0000,0x250d0000,0x250d0000,0x3f75bf6d,0x3f7fbf7b,0x3e95bec4,0x3dc9be48
.long 0xbf0e3f35,0xbe483ec4,0x3f0ebf35,0x3e48bec4,0xbf223ec4,0xbf753f55,0x3f46bf6d,0x3e95bf0e
.long 0x3f6dbf80,0x3ec4bf35,0x3f6dbf80,0x3ec4bf35,0x3dc93ec4,0x3f62bf0e,0x3f7fbf6d,0x3ef1bf55
.long 0xbf7b3f35,0xbf0e3f6d,0x3f7bbf35,0x3f0ebf6d,0x3ef1bf6d,0xbf463e48,0x3f62bec4,0x3f22bf7b
.long 0x3f35250d,0x3f35bf80,0x3f35250d,0x3f35bf80,0xbf623f6d,0x3f223e48,0x3ef13ec4,0x3f46bf7b
.long 0xbe48bf35,0xbf553f6d,0x3e483f35,0x3f55bf6d,0x3f7fbec4,0xbef1bf0e,0xbdc93f6d,0x3f62bf55
.long 0xbec43f80,0x3f6dbf35,0xbec43f80,0x3f6dbf35,0xbf46bec4,0x3e953f55,0xbf223f6d,0x3f75bf0e
.long 0x3f55bf35,0xbf7b3ec4,0xbf553f35,0x3f7bbec4,0x3e953f6d,0xbdc9bf7b,0xbf753ec4,0x3f7fbe48
.long 0xbf800000,0x3f80250d,0xbf800000,0x3f80250d,0xbf7f0000,0x3f75be48,0x3dc93f80,0xbe95bf7b
.long 0xbf7b0000,0x3f55bec4,0x3f7b250d,0xbf553ec4,0xbf750000,0x3f22bf0e,0xbe95bf80,0x3f463f55
.long 0xbf6d0000,0x3ec4bf35,0xbf6d0000,0x3ec4bf35,0xbf620000,0x3dc9bf55,0x3ef13f80,0xbf7fbf0e
.long 0xbf550000,0xbe48bf6d,0x3f55250d,0x3e483f6d,0xbf460000,0xbef1bf7b,0xbf22bf80,0x3f623e48
.long 0xbf350000,0xbf35bf80,0xbf350000,0xbf35bf80,0xbf220000,0xbf62bf7b,0x3f463f80,0xbef13e48
.long 0xbf0e0000,0xbf7bbf6d,0x3f0e250d,0x3f7b3f6d,0xbef10000,0xbf7fbf55,0xbf62bf80,0xbdc9bf0e
.long 0xbec40000,0xbf6dbf35,0xbec40000,0xbf6dbf35,0xbe950000,0xbf46bf0e,0x3f753f80,0x3f223f55
.long 0xbe480000,0xbf0ebec4,0x3e48250d,0x3f0e3ec4,0xbdc90000,0xbe95be48,0xbf7fbf80,0xbf75bf7b
.long 0xbf800000,0x3f80250d,0xbf800000,0x3f80250d,0xbf623ec4,0x3f46bf0e,0x3ef13f6d,0xbf22bf55
.long 0xbf0e3f35,0x3e48bf6d,0x3f0ebf35,0xbe483f6d,0xbdc93f6d,0xbef1bf7b,0xbf7fbec4,0x3f62be48
.long 0x3ec43f80,0xbf6dbf35,0x3ec43f80,0xbf6dbf35,0x3f463f6d,0xbf75be48,0x3f22bec4,0x3e953f7b
.long 0x3f7b3f35,0xbf0e3ec4,0xbf7bbf35,0x3f0ebec4,0x3f753ec4,0x3dc93f55,0x3e953f6d,0xbf7fbf0e
.long 0x3f35250d,0x3f353f80,0x3f35250d,0x3f353f80,0x3e95bec4,0x3f7f3f55,0xbf75bf6d,0x3dc9bf0e
.long 0xbe48bf35,0x3f553ec4,0x3e483f35,0xbf55bec4,0xbf22bf6d,0x3e95be48,0x3f463ec4,0x3f753f7b
.long 0xbf6dbf80,0xbec4bf35,0xbf6dbf80,0xbec4bf35,0xbf7fbf6d,0xbf62bf7b,0x3dc93ec4,0xbef1be48
.long 0xbf55bf35,0xbf7bbf6d,0x3f553f35,0x3f7b3f6d,0xbef1bec4,0xbf22bf0e,0xbf62bf6d,0xbf46bf55
.long 0xbf800000,0x3f80250d,0xbf800000,0x3f80250d,0xbf223f35,0x3ef1bf55,0x3f463f35,0xbf62bf0e
.long 0x3e483f80,0xbf0ebf6d,0xbe48bf80,0x3f0e3f6d,0x3f623f35,0xbf7fbe48,0xbef13f35,0xbdc9bf7b
.long 0x3f6d250d,0xbec43f35,0x3f6d250d,0xbec43f35,0x3e95bf35,0x3f223f7b,0xbf75bf35,0x3f46be48
.long 0xbf0ebf80,0x3f7b3ec4,0x3f0e3f80,0xbf7bbec4,0xbf7fbf35,0x3e95bf0e,0x3dc9bf35,0x3f753f55
.long 0xbf350000,0xbf35bf80,0xbf350000,0xbf35bf80,0x3dc93f35,0xbf75bf0e,0x3f7f3f35,0x3e953f55
.long 0x3f553f80,0xbe483ec4,0xbf55bf80,0x3e48bec4,0x3f753f35,0x3f463f7b,0x3e953f35,0xbf22be48
.long 0x3ec4250d,0x3f6d3f35,0x3ec4250d,0x3f6d3f35,0xbef1bf35,0x3dc9be48,0xbf62bf35,0xbf7fbf7b
.long 0xbf7bbf80,0xbf55bf6d,0x3f7b3f80,0x3f553f6d,0xbf46bf35,0xbf62bf55,0xbf22bf35,0xbef1bf0e
.long 0xbf800000,0x3f80250d,0xbf800000,0x3f80250d,0xbe953f6d,0x3dc9bf7b,0x3f753ec4,0xbf7fbe48
.long 0x3f553f35,0xbf7bbec4,0xbf55bf35,0x3f7b3ec4,0x3f46bec4,0xbe953f55,0x3f223f6d,0xbf75bf0e
.long 0xbec4bf80,0x3f6d3f35,0xbec4bf80,0x3f6d3f35,0xbf7fbec4,0x3ef1bf0e,0x3dc93f6d,0xbf62bf55
.long 0xbe483f35,0xbf55bf6d,0x3e48bf35,0x3f553f6d,0x3f623f6d,0xbf223e48,0xbef13ec4,0xbf46bf7b
.long 0x3f35250d,0x3f353f80,0x3f35250d,0x3f353f80,0xbef1bf6d,0x3f463e48,0xbf62bec4,0xbf22bf7b
.long 0xbf7bbf35,0xbf0ebf6d,0x3f7b3f35,0x3f0e3f6d,0xbdc93ec4,0xbf62bf0e,0xbf7fbf6d,0xbef1bf55
.long 0x3f6d3f80,0x3ec43f35,0x3f6d3f80,0x3ec43f35,0x3f223ec4,0x3f753f55,0xbf46bf6d,0xbe95bf0e
.long 0xbf0ebf35,0xbe48bec4,0x3f0e3f35,0x3e483ec4,0xbf75bf6d,0xbf7fbf7b,0xbe95bec4,0xbdc9be48
.long 0xbf800000,0x3f80250d,0xbf800000,0x3f80250d,0x3f7f250d,0xbf753e48,0xbdc9bf80,0x3e953f7b
.long 0xbf7b0000,0x3f55bec4,0x3f7b250d,0xbf553ec4,0x3f75250d,0xbf223f0e,0x3e953f80,0xbf46bf55
.long 0xbf6d0000,0x3ec4bf35,0xbf6d0000,0x3ec4bf35,0x3f62250d,0xbdc93f55,0xbef1bf80,0x3f7f3f0e
.long 0xbf550000,0xbe48bf6d,0x3f55250d,0x3e483f6d,0x3f46250d,0x3ef13f7b,0x3f223f80,0xbf62be48
.long 0xbf350000,0xbf35bf80,0xbf350000,0xbf35bf80,0x3f22250d,0x3f623f7b,0xbf46bf80,0x3ef1be48
.long 0xbf0e0000,0xbf7bbf6d,0x3f0e250d,0x3f7b3f6d,0x3ef1250d,0x3f7f3f55,0x3f623f80,0x3dc93f0e
.long 0xbec40000,0xbf6dbf35,0xbec40000,0xbf6dbf35,0x3e95250d,0x3f463f0e,0xbf75bf80,0xbf22bf55
.long 0xbe480000,0xbf0ebec4,0x3e48250d,0x3f0e3ec4,0x3dc9250d,0x3e953e48,0x3f7f3f80,0x3f753f7b
.long 0xbf800000,0x3f80250d,0xbf800000,0x3f80250d,0x3f62bec4,0xbf463f0e,0xbef1bf6d,0x3f223f55
.long 0xbf0e3f35,0x3e48bf6d,0x3f0ebf35,0xbe483f6d,0x3dc9bf6d,0x3ef13f7b,0x3f7f3ec4,0xbf623e48
.long 0x3ec43f80,0xbf6dbf35,0x3ec43f80,0xbf6dbf35,0xbf46bf6d,0x3f753e48,0xbf223ec4,0xbe95bf7b
.long 0x3f7b3f35,0xbf0e3ec4,0xbf7bbf35,0x3f0ebec4,0xbf75bec4,0xbdc9bf55,0xbe95bf6d,0x3f7f3f0e
.long 0x3f35250d,0x3f353f80,0x3f35250d,0x3f353f80,0xbe953ec4,0xbf7fbf55,0x3f753f6d,0xbdc93f0e
.long 0xbe48bf35,0x3f553ec4,0x3e483f35,0xbf55bec4,0x3f223f6d,0xbe953e48,0xbf46bec4,0xbf75bf7b
.long 0xbf6dbf80,0xbec4bf35,0xbf6dbf80,0xbec4bf35,0x3f7f3f6d,0x3f623f7b,0xbdc9bec4,0x3ef13e48
.long 0xbf55bf35,0xbf7bbf6d,0x3f553f35,0x3f7b3f6d,0x3ef13ec4,0x3f223f0e,0x3f623f6d,0x3f463f55
.long 0xbf800000,0x3f80250d,0xbf800000,0x3f80250d,0x3f22bf35,0xbef13f55,0xbf46bf35,0x3f623f0e
.long 0x3e483f80,0xbf0ebf6d,0xbe48bf80,0x3f0e3f6d,0xbf62bf35,0x3f7f3e48,0x3ef1bf35,0x3dc93f7b
.long 0x3f6d250d,0xbec43f35,0x3f6d250d,0xbec43f35,0xbe953f35,0xbf22bf7b,0x3f753f35,0xbf463e48
.long 0xbf0ebf80,0x3f7b3ec4,0x3f0e3f80,0xbf7bbec4,0x3f7f3f35,0xbe953f0e,0xbdc93f35,0xbf75bf55
.long 0xbf350000,0xbf35bf80,0xbf350000,0xbf35bf80,0xbdc9bf35,0x3f753f0e,0xbf7fbf35,0xbe95bf55
.long 0x3f553f80,0xbe483ec4,0xbf55bf80,0x3e48bec4,0xbf75bf35,0xbf46bf7b,0xbe95bf35,0x3f223e48
.long 0x3ec4250d,0x3f6d3f35,0x3ec4250d,0x3f6d3f35,0x3ef13f35,0xbdc93e48,0x3f623f35,0x3f7f3f7b
.long 0xbf7bbf80,0xbf55bf6d,0x3f7b3f80,0x3f553f6d,0x3f463f35,0x3f623f55,0x3f223f35,0x3ef13f0e
.long 0xbf800000,0x3f80250d,0xbf800000,0x3f80250d,0x3e95bf6d,0xbdc93f7b,0xbf75bec4,0x3f7f3e48
.long 0x3f553f35,0xbf7bbec4,0xbf55bf35,0x3f7b3ec4,0xbf463ec4,0x3e95bf55,0xbf22bf6d,0x3f753f0e
.long 0xbec4bf80,0x3f6d3f35,0xbec4bf80,0x3f6d3f35,0x3f7f3ec4,0xbef13f0e,0xbdc9bf6d,0x3f623f55
.long 0xbe483f35,0xbf55bf6d,0x3e48bf35,0x3f553f6d,0xbf62bf6d,0x3f22be48,0x3ef1bec4,0x3f463f7b
.long 0x3f35250d,0x3f353f80,0x3f35250d,0x3f353f80,0x3ef13f6d,0xbf46be48,0x3f623ec4,0x3f223f7b
.long 0xbf7bbf35,0xbf0ebf6d,0x3f7b3f35,0x3f0e3f6d,0x3dc9bec4,0x3f623f0e,0x3f7f3f6d,0x3ef13f55
.long 0x3f6d3f80,0x3ec43f35,0x3f6d3f80,0x3ec43f35,0xbf22bec4,0xbf75bf55,0x3f463f6d,0x3e953f0e
.long 0xbf0ebf35,0xbe48bec4,0x3f0e3f35,0x3e483ec4,0x3f753f6d,0x3f7f3f7b,0x3e953ec4,0x3dc93e48
.long 0x80003f80,0x80003f80,0x80003f80,0x80003f80,0x80003f80,0xbe483f7b,0xbec43f6d,0xbf0e3f55
.long 0x80003f80,0xbec43f6d,0xbf353f35,0xbf6d3ec4,0x80003f80,0xbf0e3f55,0xbf6d3ec4,0xbf7bbe48
.long 0x80003f80,0xbf353f35,0xbf80248d,0xbf35bf35,0x80003f80,0xbf553f0e,0xbf6dbec4,0xbe48bf7b
.long 0x80003f80,0xbf6d3ec4,0xbf35bf35,0x3ec4bf6d,0x80003f80,0xbf7b3e48,0xbec4bf6d,0x3f55bf0e
.long 0x80003f80,0xbf80248d,0xa50dbf80,0x3f80a554,0x80003f80,0xbf7bbe48,0x3ec4bf6d,0x3f553f0e
.long 0x80003f80,0xbf6dbec4,0x3f35bf35,0x3ec43f6d,0x80003f80,0xbf55bf0e,0x3f6dbec4,0xbe483f7b
.long 0x80003f80,0xbf35bf35,0x3f80a554,0xbf353f35,0x80003f80,0xbf0ebf55,0x3f6d3ec4,0xbf7b3e48
.long 0x80003f80,0xbec4bf6d,0x3f353f35,0xbf6dbec4,0x80003f80,0xbe48bf7b,0x3ec43f6d,0xbf0ebf55
.long 0x80003f80,0x80003f80,0x80003f80,0x80003f80,0xbf353f35,0xbf553f0e,0xbf6d3ec4,0xbf7b3e48
.long 0xbf80248d,0xbf6dbec4,0xbf35bf35,0xbec4bf6d,0xbf35bf35,0xbe48bf7b,0x3ec4bf6d,0x3f55bf0e
.long 0xa50dbf80,0x3f35bf35,0x3f80a554,0x3f353f35,0x3f35bf35,0x3f7b3e48,0x3ec43f6d,0xbf0e3f55
.long 0x3f80a554,0x3ec43f6d,0xbf353f35,0xbf6dbec4,0x3f353f35,0xbf0e3f55,0xbf6dbec4,0x3e48bf7b
.long 0x80003f80,0xbf80248d,0xa50dbf80,0x3f80a554,0xbf353f35,0xbf0ebf55,0x3f6dbec4,0x3e483f7b
.long 0xbf80248d,0x3ec4bf6d,0x3f353f35,0xbf6d3ec4,0xbf35bf35,0x3f7bbe48,0xbec43f6d,0xbf0ebf55
.long 0xa50dbf80,0x3f353f35,0xbf80248d,0x3f35bf35,0x3f35bf35,0xbe483f7b,0xbec4bf6d,0x3f553f0e
.long 0x3f80a554,0xbf6d3ec4,0x3f35bf35,0xbec43f6d,0x3f353f35,0xbf55bf0e,0x3f6d3ec4,0xbf7bbe48
.long 0x80003f80,0x80003f80,0x80003f80,0x80003f80,0xbf80248d,0xbf7bbe48,0xbf6dbec4,0xbf55bf0e
.long 0xa50dbf80,0x3ec4bf6d,0x3f35bf35,0x3f6dbec4,0x3f80a554,0x3f553f0e,0x3ec43f6d,0xbe483f7b
.long 0x80003f80,0xbf353f35,0xbf80248d,0xbf35bf35,0xbf80248d,0xbf0ebf55,0x3ec4bf6d,0x3f7bbe48
.long 0xa50dbf80,0x3f6dbec4,0x3f353f35,0xbec43f6d,0x3f80a554,0x3e483f7b,0xbf6d3ec4,0xbf0ebf55
.long 0x80003f80,0xbf80248d,0xa50dbf80,0x3f80a554,0xbf80248d,0x3e48bf7b,0x3f6d3ec4,0xbf0e3f55
.long 0xa50dbf80,0x3f6d3ec4,0xbf353f35,0xbec4bf6d,0x3f80a554,0xbf0e3f55,0xbec4bf6d,0x3f7b3e48
.long 0x80003f80,0xbf35bf35,0x3f80a554,0xbf353f35,0xbf80248d,0x3f55bf0e,0xbec43f6d,0xbe48bf7b
.long 0xa50dbf80,0x3ec43f6d,0xbf35bf35,0x3f6d3ec4,0x3f80a554,0xbf7b3e48,0x3f6dbec4,0xbf553f0e
.long 0x80003f80,0x80003f80,0x80003f80,0x80003f80,0xbf35bf35,0xbf0ebf55,0xbec4bf6d,0xbe48bf7b
.long 0x3f80a554,0x3f6d3ec4,0x3f353f35,0x3ec43f6d,0xbf353f35,0xbf7b3e48,0xbf6dbec4,0xbf0ebf55
.long 0xa50dbf80,0x3f35bf35,0x3f80a554,0x3f353f35,0x3f353f35,0xbe483f7b,0xbf6d3ec4,0xbf55bf0e
.long 0xbf80248d,0xbec4bf6d,0x3f35bf35,0x3f6d3ec4,0x3f35bf35,0x3f553f0e,0xbec43f6d,0xbf7bbe48
.long 0x80003f80,0xbf80248d,0xa50dbf80,0x3f80a554,0xbf35bf35,0x3f55bf0e,0x3ec43f6d,0xbf7b3e48
.long 0x3f80a554,0xbec43f6d,0xbf35bf35,0x3f6dbec4,0xbf353f35,0xbe48bf7b,0x3f6d3ec4,0xbf553f0e
.long 0xa50dbf80,0x3f353f35,0xbf80248d,0x3f35bf35,0x3f353f35,0xbf7bbe48,0x3f6dbec4,0xbf0e3f55
.long 0xbf80248d,0x3f6dbec4,0xbf353f35,0x3ec4bf6d,0x3f35bf35,0xbf0e3f55,0x3ec4bf6d,0xbe483f7b
.long 0x3f80,0x3f80,0x3f80,0x3f80,0x250dbf80,0xbe48bf7b,0xbec4bf6d,0xbf0ebf55
.long 0x3f80,0x3ec43f6d,0x3f353f35,0x3f6d3ec4,0x250dbf80,0xbf0ebf55,0xbf6dbec4,0xbf7b3e48
.long 0x3f80,0x3f353f35,0x3f80248d,0x3f35bf35,0x250dbf80,0xbf55bf0e,0xbf6d3ec4,0xbe483f7b
.long 0x3f80,0x3f6d3ec4,0x3f35bf35,0xbec4bf6d,0x250dbf80,0xbf7bbe48,0xbec43f6d,0x3f553f0e
.long 0x3f80,0x3f80248d,0x250dbf80,0xbf80a554,0x250dbf80,0xbf7b3e48,0x3ec43f6d,0x3f55bf0e
.long 0x3f80,0x3f6dbec4,0xbf35bf35,0xbec43f6d,0x250dbf80,0xbf553f0e,0x3f6d3ec4,0xbe48bf7b
.long 0x3f80,0x3f35bf35,0xbf80a554,0x3f353f35,0x250dbf80,0xbf0e3f55,0x3f6dbec4,0xbf7bbe48
.long 0x3f80,0x3ec4bf6d,0xbf353f35,0x3f6dbec4,0x250dbf80,0xbe483f7b,0x3ec4bf6d,0xbf0e3f55
.long 0x3f80,0x3f80,0x3f80,0x3f80,0xbf35bf35,0xbf55bf0e,0xbf6dbec4,0xbf7bbe48
.long 0x3f80248d,0x3f6dbec4,0x3f35bf35,0x3ec4bf6d,0xbf353f35,0xbe483f7b,0x3ec43f6d,0x3f553f0e
.long 0x250dbf80,0xbf35bf35,0xbf80a554,0xbf353f35,0x3f353f35,0x3f7bbe48,0x3ec4bf6d,0xbf0ebf55
.long 0xbf80a554,0xbec43f6d,0x3f353f35,0x3f6dbec4,0x3f35bf35,0xbf0ebf55,0xbf6d3ec4,0x3e483f7b
.long 0x3f80,0x3f80248d,0x250dbf80,0xbf80a554,0xbf35bf35,0xbf0e3f55,0x3f6d3ec4,0x3e48bf7b
.long 0x3f80248d,0xbec4bf6d,0xbf353f35,0x3f6d3ec4,0xbf353f35,0x3f7b3e48,0xbec4bf6d,0xbf0e3f55
.long 0x250dbf80,0xbf353f35,0x3f80248d,0xbf35bf35,0x3f353f35,0xbe48bf7b,0xbec43f6d,0x3f55bf0e
.long 0xbf80a554,0x3f6d3ec4,0xbf35bf35,0x3ec43f6d,0x3f35bf35,0xbf553f0e,0x3f6dbec4,0xbf7b3e48
.long 0x3f80,0x3f80,0x3f80,0x3f80,0xbf80a554,0xbf7b3e48,0xbf6d3ec4,0xbf553f0e
.long 0x250dbf80,0xbec4bf6d,0xbf35bf35,0xbf6dbec4,0x3f80248d,0x3f55bf0e,0x3ec4bf6d,0xbe48bf7b
.long 0x3f80,0x3f353f35,0x3f80248d,0x3f35bf35,0xbf80a554,0xbf0e3f55,0x3ec43f6d,0x3f7b3e48
.long 0x250dbf80,0xbf6dbec4,0xbf353f35,0x3ec43f6d,0x3f80248d,0x3e48bf7b,0xbf6dbec4,0xbf0e3f55
.long 0x3f80,0x3f80248d,0x250dbf80,0xbf80a554,0xbf80a554,0x3e483f7b,0x3f6dbec4,0xbf0ebf55
.long 0x250dbf80,0xbf6d3ec4,0x3f353f35,0x3ec4bf6d,0x3f80248d,0xbf0ebf55,0xbec43f6d,0x3f7bbe48
.long 0x3f80,0x3f35bf35,0xbf80a554,0x3f353f35,0xbf80a554,0x3f553f0e,0xbec4bf6d,0xbe483f7b
.long 0x250dbf80,0xbec43f6d,0x3f35bf35,0xbf6d3ec4,0x3f80248d,0xbf7bbe48,0x3f6d3ec4,0xbf55bf0e
.long 0x3f80,0x3f80,0x3f80,0x3f80,0xbf353f35,0xbf0e3f55,0xbec43f6d,0xbe483f7b
.long 0xbf80a554,0xbf6d3ec4,0xbf353f35,0xbec43f6d,0xbf35bf35,0xbf7bbe48,0xbf6d3ec4,0xbf0e3f55
.long 0x250dbf80,0xbf35bf35,0xbf80a554,0xbf353f35,0x3f35bf35,0xbe48bf7b,0xbf6dbec4,0xbf553f0e
.long 0x3f80248d,0x3ec4bf6d,0xbf35bf35,0xbf6d3ec4,0x3f353f35,0x3f55bf0e,0xbec4bf6d,0xbf7b3e48
.long 0x3f80,0x3f80248d,0x250dbf80,0xbf80a554,0xbf353f35,0x3f553f0e,0x3ec4bf6d,0xbf7bbe48
.long 0xbf80a554,0x3ec43f6d,0x3f35bf35,0xbf6dbec4,0xbf35bf35,0xbe483f7b,0x3f6dbec4,0xbf55bf0e
.long 0x250dbf80,0xbf353f35,0x3f80248d,0xbf35bf35,0x3f35bf35,0xbf7b3e48,0x3f6d3ec4,0xbf0ebf55
.long 0x3f80248d,0xbf6dbec4,0x3f353f35,0xbec4bf6d,0x3f353f35,0xbf0ebf55,0x3ec43f6d,0xbe48bf7b
.long 0x3f800000,0x3f800000,0x3f800000,0x3f800000,0x3f800000,0x3f7b3e48,0x3f6d3ec4,0x3f553f0e
.long 0x3f800000,0x3f6d3ec4,0x3f353f35,0x3ec43f6d,0x3f800000,0x3f553f0e,0x3ec43f6d,0xbe483f7b
.long 0x3f800000,0x3f353f35,0x248d3f80,0xbf353f35,0x3f800000,0x3f0e3f55,0xbec43f6d,0xbf7b3e48
.long 0x3f800000,0x3ec43f6d,0xbf353f35,0xbf6dbec4,0x3f800000,0x3e483f7b,0xbf6d3ec4,0xbf0ebf55
.long 0x3f800000,0x248d3f80,0xbf80250d,0xa554bf80,0x3f800000,0xbe483f7b,0xbf6dbec4,0x3f0ebf55
.long 0x3f800000,0xbec43f6d,0xbf35bf35,0x3f6dbec4,0x3f800000,0xbf0e3f55,0xbec4bf6d,0x3f7b3e48
.long 0x3f800000,0xbf353f35,0xa554bf80,0x3f353f35,0x3f800000,0xbf553f0e,0x3ec4bf6d,0x3e483f7b
.long 0x3f800000,0xbf6d3ec4,0x3f35bf35,0xbec43f6d,0x3f800000,0xbf7b3e48,0x3f6dbec4,0xbf553f0e
.long 0x3f800000,0x3f800000,0x3f800000,0x3f800000,0x3f353f35,0x3f0e3f55,0x3ec43f6d,0x3e483f7b
.long 0x248d3f80,0xbec43f6d,0xbf353f35,0xbf6d3ec4,0xbf353f35,0xbf7b3e48,0xbf6dbec4,0xbf0ebf55
.long 0xbf80250d,0xbf35bf35,0xa554bf80,0x3f35bf35,0xbf35bf35,0x3e48bf7b,0x3f6dbec4,0x3f553f0e
.long 0xa554bf80,0x3f6dbec4,0x3f353f35,0xbec43f6d,0x3f35bf35,0x3f553f0e,0xbec43f6d,0xbf7bbe48
.long 0x3f800000,0x248d3f80,0xbf80250d,0xa554bf80,0x3f353f35,0xbf553f0e,0xbec4bf6d,0x3f7bbe48
.long 0x248d3f80,0xbf6dbec4,0x3f35bf35,0x3ec43f6d,0xbf353f35,0xbe48bf7b,0x3f6d3ec4,0xbf553f0e
.long 0xbf80250d,0x3f35bf35,0x248d3f80,0xbf35bf35,0xbf35bf35,0x3f7b3e48,0xbf6d3ec4,0x3f0ebf55
.long 0xa554bf80,0x3ec43f6d,0xbf35bf35,0x3f6d3ec4,0x3f35bf35,0xbf0e3f55,0x3ec4bf6d,0xbe483f7b
.long 0x3f800000,0x3f800000,0x3f800000,0x3f800000,0x248d3f80,0xbe483f7b,0xbec43f6d,0xbf0e3f55
.long 0xbf80250d,0xbf6dbec4,0xbf35bf35,0xbec4bf6d,0xa554bf80,0x3f0ebf55,0x3f6dbec4,0x3f7b3e48
.long 0x3f800000,0x3f353f35,0x248d3f80,0xbf353f35,0x248d3f80,0xbf553f0e,0xbf6dbec4,0xbe48bf7b
.long 0xbf80250d,0xbec4bf6d,0x3f35bf35,0x3f6d3ec4,0xa554bf80,0x3f7bbe48,0x3ec43f6d,0xbf553f0e
.long 0x3f800000,0x248d3f80,0xbf80250d,0xa554bf80,0x248d3f80,0xbf7bbe48,0x3ec4bf6d,0x3f553f0e
.long 0xbf80250d,0x3ec4bf6d,0x3f353f35,0xbf6d3ec4,0xa554bf80,0x3f553f0e,0xbf6d3ec4,0x3e48bf7b
.long 0x3f800000,0xbf353f35,0xa554bf80,0x3f353f35,0x248d3f80,0xbf0ebf55,0x3f6d3ec4,0xbf7b3e48
.long 0xbf80250d,0x3f6dbec4,0xbf353f35,0x3ec4bf6d,0xa554bf80,0x3e483f7b,0xbec4bf6d,0x3f0e3f55
.long 0x3f800000,0x3f800000,0x3f800000,0x3f800000,0xbf353f35,0xbf553f0e,0xbf6d3ec4,0xbf7b3e48
.long 0xa554bf80,0x3ec4bf6d,0x3f35bf35,0x3f6dbec4,0x3f353f35,0x3e483f7b,0xbec43f6d,0xbf553f0e
.long 0xbf80250d,0xbf35bf35,0xa554bf80,0x3f35bf35,0x3f35bf35,0x3f7b3e48,0x3ec43f6d,0xbf0e3f55
.long 0x248d3f80,0xbf6d3ec4,0xbf35bf35,0x3ec4bf6d,0xbf35bf35,0x3f0ebf55,0x3f6d3ec4,0xbe483f7b
.long 0x3f800000,0x248d3f80,0xbf80250d,0xa554bf80,0xbf353f35,0xbf0ebf55,0x3f6dbec4,0x3e483f7b
.long 0xa554bf80,0x3f6d3ec4,0xbf353f35,0xbec4bf6d,0x3f353f35,0xbf7b3e48,0x3ec4bf6d,0x3f0e3f55
.long 0xbf80250d,0x3f35bf35,0x248d3f80,0xbf35bf35,0x3f35bf35,0xbe483f7b,0xbec4bf6d,0x3f553f0e
.long 0x248d3f80,0xbec4bf6d,0x3f353f35,0xbf6dbec4,0xbf35bf35,0x3f553f0e,0xbf6dbec4,0x3f7b3e48
.long 0xbf800000,0xbf800000,0xbf800000,0xbf800000,0x3f80250d,0x3f7bbe48,0x3f6dbec4,0x3f55bf0e
.long 0xbf800000,0xbf6d3ec4,0xbf353f35,0xbec43f6d,0x3f80250d,0x3f55bf0e,0x3ec4bf6d,0xbe48bf7b
.long 0xbf800000,0xbf353f35,0xa48d3f80,0x3f353f35,0x3f80250d,0x3f0ebf55,0xbec4bf6d,0xbf7bbe48
.long 0xbf800000,0xbec43f6d,0x3f353f35,0x3f6dbec4,0x3f80250d,0x3e48bf7b,0xbf6dbec4,0xbf0e3f55
.long 0xbf800000,0xa48d3f80,0x3f80250d,0x2554bf80,0x3f80250d,0xbe48bf7b,0xbf6d3ec4,0x3f0e3f55
.long 0xbf800000,0x3ec43f6d,0x3f35bf35,0xbf6dbec4,0x3f80250d,0xbf0ebf55,0xbec43f6d,0x3f7bbe48
.long 0xbf800000,0x3f353f35,0x2554bf80,0xbf353f35,0x3f80250d,0xbf55bf0e,0x3ec43f6d,0x3e48bf7b
.long 0xbf800000,0x3f6d3ec4,0xbf35bf35,0x3ec43f6d,0x3f80250d,0xbf7bbe48,0x3f6d3ec4,0xbf55bf0e
.long 0xbf800000,0xbf800000,0xbf800000,0xbf800000,0x3f35bf35,0x3f0ebf55,0x3ec4bf6d,0x3e48bf7b
.long 0xa48d3f80,0x3ec43f6d,0x3f353f35,0x3f6d3ec4,0xbf35bf35,0xbf7bbe48,0xbf6d3ec4,0xbf0e3f55
.long 0x3f80250d,0x3f35bf35,0x2554bf80,0xbf35bf35,0xbf353f35,0x3e483f7b,0x3f6d3ec4,0x3f55bf0e
.long 0x2554bf80,0xbf6dbec4,0xbf353f35,0x3ec43f6d,0x3f353f35,0x3f55bf0e,0xbec4bf6d,0xbf7b3e48
.long 0xbf800000,0xa48d3f80,0x3f80250d,0x2554bf80,0x3f35bf35,0xbf55bf0e,0xbec43f6d,0x3f7b3e48
.long 0xa48d3f80,0x3f6dbec4,0xbf35bf35,0xbec43f6d,0xbf35bf35,0xbe483f7b,0x3f6dbec4,0xbf55bf0e
.long 0x3f80250d,0xbf35bf35,0xa48d3f80,0x3f35bf35,0xbf353f35,0x3f7bbe48,0xbf6dbec4,0x3f0e3f55
.long 0x2554bf80,0xbec43f6d,0x3f35bf35,0xbf6d3ec4,0x3f353f35,0xbf0ebf55,0x3ec43f6d,0xbe48bf7b
.long 0xbf800000,0xbf800000,0xbf800000,0xbf800000,0x2554bf80,0xbe48bf7b,0xbec4bf6d,0xbf0ebf55
.long 0x3f80250d,0x3f6dbec4,0x3f35bf35,0x3ec4bf6d,0xa48d3f80,0x3f0e3f55,0x3f6d3ec4,0x3f7bbe48
.long 0xbf800000,0xbf353f35,0xa48d3f80,0x3f353f35,0x2554bf80,0xbf55bf0e,0xbf6d3ec4,0xbe483f7b
.long 0x3f80250d,0x3ec4bf6d,0xbf35bf35,0xbf6d3ec4,0xa48d3f80,0x3f7b3e48,0x3ec4bf6d,0xbf55bf0e
.long 0xbf800000,0xa48d3f80,0x3f80250d,0x2554bf80,0x2554bf80,0xbf7b3e48,0x3ec43f6d,0x3f55bf0e
.long 0x3f80250d,0xbec4bf6d,0xbf353f35,0x3f6d3ec4,0xa48d3f80,0x3f55bf0e,0xbf6dbec4,0x3e483f7b
.long 0xbf800000,0x3f353f35,0x2554bf80,0xbf353f35,0x2554bf80,0xbf0e3f55,0x3f6dbec4,0xbf7bbe48
.long 0x3f80250d,0xbf6dbec4,0x3f353f35,0xbec4bf6d,0xa48d3f80,0x3e48bf7b,0xbec43f6d,0x3f0ebf55
.long 0xbf800000,0xbf800000,0xbf800000,0xbf800000,0xbf35bf35,0xbf55bf0e,0xbf6dbec4,0xbf7bbe48
.long 0x2554bf80,0xbec4bf6d,0xbf35bf35,0xbf6dbec4,0x3f35bf35,0x3e48bf7b,0xbec4bf6d,0xbf55bf0e
.long 0x3f80250d,0x3f35bf35,0x2554bf80,0xbf35bf35,0x3f353f35,0x3f7bbe48,0x3ec4bf6d,0xbf0ebf55
.long 0xa48d3f80,0x3f6d3ec4,0x3f35bf35,0xbec4bf6d,0xbf353f35,0x3f0e3f55,0x3f6dbec4,0xbe48bf7b
.long 0xbf800000,0xa48d3f80,0x3f80250d,0x2554bf80,0xbf35bf35,0xbf0e3f55,0x3f6d3ec4,0x3e48bf7b
.long 0x2554bf80,0xbf6d3ec4,0x3f353f35,0x3ec4bf6d,0x3f35bf35,0xbf7bbe48,0x3ec43f6d,0x3f0ebf55
.long 0x3f80250d,0xbf35bf35,0xa48d3f80,0x3f35bf35,0x3f353f35,0xbe48bf7b,0xbec43f6d,0x3f55bf0e
.long 0xa48d3f80,0x3ec4bf6d,0xbf353f35,0x3f6dbec4,0xbf353f35,0x3f55bf0e,0xbf6d3ec4,0x3f7bbe48
.long 0x80003f80,0xa50dbf80,0x80003f80,0xa50dbf80,0x80003f80,0x3e48bf7b,0xbec43f6d,0x3f0ebf55
.long 0x80003f80,0x3ec4bf6d,0xbf353f35,0x3f6dbec4,0x80003f80,0x3f0ebf55,0xbf6d3ec4,0x3f7b3e48
.long 0x80003f80,0x3f35bf35,0xbf80248d,0x3f353f35,0x80003f80,0x3f55bf0e,0xbf6dbec4,0x3e483f7b
.long 0x80003f80,0x3f6dbec4,0xbf35bf35,0xbec43f6d,0x80003f80,0x3f7bbe48,0xbec4bf6d,0xbf553f0e
.long 0x80003f80,0x3f80a554,0xa50dbf80,0xbf80248d,0x80003f80,0x3f7b3e48,0x3ec4bf6d,0xbf55bf0e
.long 0x80003f80,0x3f6d3ec4,0x3f35bf35,0xbec4bf6d,0x80003f80,0x3f553f0e,0x3f6dbec4,0x3e48bf7b
.long 0x80003f80,0x3f353f35,0x3f80a554,0x3f35bf35,0x80003f80,0x3f0e3f55,0x3f6d3ec4,0x3f7bbe48
.long 0x80003f80,0x3ec43f6d,0x3f353f35,0x3f6d3ec4,0x80003f80,0x3e483f7b,0x3ec43f6d,0x3f0e3f55
.long 0x80003f80,0xa50dbf80,0x80003f80,0xa50dbf80,0xbf353f35,0x3f55bf0e,0xbf6d3ec4,0x3f7bbe48
.long 0xbf80248d,0x3f6d3ec4,0xbf35bf35,0x3ec43f6d,0xbf35bf35,0x3e483f7b,0x3ec4bf6d,0xbf553f0e
.long 0xa50dbf80,0xbf353f35,0x3f80a554,0xbf35bf35,0x3f35bf35,0xbf7bbe48,0x3ec43f6d,0x3f0ebf55
.long 0x3f80a554,0xbec4bf6d,0xbf353f35,0x3f6d3ec4,0x3f353f35,0x3f0ebf55,0xbf6dbec4,0xbe483f7b
.long 0x80003f80,0x3f80a554,0xa50dbf80,0xbf80248d,0xbf353f35,0x3f0e3f55,0x3f6dbec4,0xbe48bf7b
.long 0xbf80248d,0xbec43f6d,0x3f353f35,0x3f6dbec4,0xbf35bf35,0xbf7b3e48,0xbec43f6d,0x3f0e3f55
.long 0xa50dbf80,0xbf35bf35,0xbf80248d,0xbf353f35,0x3f35bf35,0x3e48bf7b,0xbec4bf6d,0xbf55bf0e
.long 0x3f80a554,0x3f6dbec4,0x3f35bf35,0x3ec4bf6d,0x3f353f35,0x3f553f0e,0x3f6d3ec4,0x3f7b3e48
.long 0x80003f80,0xa50dbf80,0x80003f80,0xa50dbf80,0xbf80248d,0x3f7b3e48,0xbf6dbec4,0x3f553f0e
.long 0xa50dbf80,0xbec43f6d,0x3f35bf35,0xbf6d3ec4,0x3f80a554,0xbf55bf0e,0x3ec43f6d,0x3e48bf7b
.long 0x80003f80,0x3f35bf35,0xbf80248d,0x3f353f35,0xbf80248d,0x3f0e3f55,0x3ec4bf6d,0xbf7b3e48
.long 0xa50dbf80,0xbf6d3ec4,0x3f353f35,0x3ec4bf6d,0x3f80a554,0xbe48bf7b,0xbf6d3ec4,0x3f0e3f55
.long 0x80003f80,0x3f80a554,0xa50dbf80,0xbf80248d,0xbf80248d,0xbe483f7b,0x3f6d3ec4,0x3f0ebf55
.long 0xa50dbf80,0xbf6dbec4,0xbf353f35,0x3ec43f6d,0x3f80a554,0x3f0ebf55,0xbec4bf6d,0xbf7bbe48
.long 0x80003f80,0x3f353f35,0x3f80a554,0x3f35bf35,0xbf80248d,0xbf553f0e,0xbec43f6d,0x3e483f7b
.long 0xa50dbf80,0xbec4bf6d,0xbf35bf35,0xbf6dbec4,0x3f80a554,0x3f7bbe48,0x3f6dbec4,0x3f55bf0e
.long 0x80003f80,0xa50dbf80,0x80003f80,0xa50dbf80,0xbf35bf35,0x3f0e3f55,0xbec4bf6d,0x3e483f7b
.long 0x3f80a554,0xbf6dbec4,0x3f353f35,0xbec4bf6d,0xbf353f35,0x3f7bbe48,0xbf6dbec4,0x3f0e3f55
.long 0xa50dbf80,0xbf353f35,0x3f80a554,0xbf35bf35,0x3f353f35,0x3e48bf7b,0xbf6d3ec4,0x3f553f0e
.long 0xbf80248d,0x3ec43f6d,0x3f35bf35,0xbf6dbec4,0x3f35bf35,0xbf55bf0e,0xbec43f6d,0x3f7b3e48
.long 0x80003f80,0x3f80a554,0xa50dbf80,0xbf80248d,0xbf35bf35,0xbf553f0e,0x3ec43f6d,0x3f7bbe48
.long 0x3f80a554,0x3ec4bf6d,0xbf35bf35,0xbf6d3ec4,0xbf353f35,0x3e483f7b,0x3f6d3ec4,0x3f55bf0e
.long 0xa50dbf80,0xbf35bf35,0xbf80248d,0xbf353f35,0x3f353f35,0x3f7b3e48,0x3f6dbec4,0x3f0ebf55
.long 0xbf80248d,0xbf6d3ec4,0xbf353f35,0xbec43f6d,0x3f35bf35,0x3f0ebf55,0x3ec4bf6d,0x3e48bf7b
.long 0x3f80,0x250dbf80,0x3f80,0x250dbf80,0x250dbf80,0x3e483f7b,0xbec4bf6d,0x3f0e3f55
.long 0x3f80,0xbec4bf6d,0x3f353f35,0xbf6dbec4,0x250dbf80,0x3f0e3f55,0xbf6dbec4,0x3f7bbe48
.long 0x3f80,0xbf35bf35,0x3f80248d,0xbf353f35,0x250dbf80,0x3f553f0e,0xbf6d3ec4,0x3e48bf7b
.long 0x3f80,0xbf6dbec4,0x3f35bf35,0x3ec43f6d,0x250dbf80,0x3f7b3e48,0xbec43f6d,0xbf55bf0e
.long 0x3f80,0xbf80a554,0x250dbf80,0x3f80248d,0x250dbf80,0x3f7bbe48,0x3ec43f6d,0xbf553f0e
.long 0x3f80,0xbf6d3ec4,0xbf35bf35,0x3ec4bf6d,0x250dbf80,0x3f55bf0e,0x3f6d3ec4,0x3e483f7b
.long 0x3f80,0xbf353f35,0xbf80a554,0xbf35bf35,0x250dbf80,0x3f0ebf55,0x3f6dbec4,0x3f7b3e48
.long 0x3f80,0xbec43f6d,0xbf353f35,0xbf6d3ec4,0x250dbf80,0x3e48bf7b,0x3ec4bf6d,0x3f0ebf55
.long 0x3f80,0x250dbf80,0x3f80,0x250dbf80,0xbf35bf35,0x3f553f0e,0xbf6dbec4,0x3f7b3e48
.long 0x3f80248d,0xbf6d3ec4,0x3f35bf35,0xbec43f6d,0xbf353f35,0x3e48bf7b,0x3ec43f6d,0xbf55bf0e
.long 0x250dbf80,0x3f353f35,0xbf80a554,0x3f35bf35,0x3f353f35,0xbf7b3e48,0x3ec4bf6d,0x3f0e3f55
.long 0xbf80a554,0x3ec4bf6d,0x3f353f35,0xbf6d3ec4,0x3f35bf35,0x3f0e3f55,0xbf6d3ec4,0xbe48bf7b
.long 0x3f80,0xbf80a554,0x250dbf80,0x3f80248d,0xbf35bf35,0x3f0ebf55,0x3f6d3ec4,0xbe483f7b
.long 0x3f80248d,0x3ec43f6d,0xbf353f35,0xbf6dbec4,0xbf353f35,0xbf7bbe48,0xbec4bf6d,0x3f0ebf55
.long 0x250dbf80,0x3f35bf35,0x3f80248d,0x3f353f35,0x3f353f35,0x3e483f7b,0xbec43f6d,0xbf553f0e
.long 0xbf80a554,0xbf6dbec4,0xbf35bf35,0xbec4bf6d,0x3f35bf35,0x3f55bf0e,0x3f6dbec4,0x3f7bbe48
.long 0x3f80,0x250dbf80,0x3f80,0x250dbf80,0xbf80a554,0x3f7bbe48,0xbf6d3ec4,0x3f55bf0e
.long 0x250dbf80,0x3ec43f6d,0xbf35bf35,0x3f6d3ec4,0x3f80248d,0xbf553f0e,0x3ec4bf6d,0x3e483f7b
.long 0x3f80,0xbf35bf35,0x3f80248d,0xbf353f35,0xbf80a554,0x3f0ebf55,0x3ec43f6d,0xbf7bbe48
.long 0x250dbf80,0x3f6d3ec4,0xbf353f35,0xbec4bf6d,0x3f80248d,0xbe483f7b,0xbf6dbec4,0x3f0ebf55
.long 0x3f80,0xbf80a554,0x250dbf80,0x3f80248d,0xbf80a554,0xbe48bf7b,0x3f6dbec4,0x3f0e3f55
.long 0x250dbf80,0x3f6dbec4,0x3f353f35,0xbec43f6d,0x3f80248d,0x3f0e3f55,0xbec43f6d,0xbf7b3e48
.long 0x3f80,0xbf353f35,0xbf80a554,0xbf35bf35,0xbf80a554,0xbf55bf0e,0xbec4bf6d,0x3e48bf7b
.long 0x250dbf80,0x3ec4bf6d,0x3f35bf35,0x3f6dbec4,0x3f80248d,0x3f7b3e48,0x3f6d3ec4,0x3f553f0e
.long 0x3f80,0x250dbf80,0x3f80,0x250dbf80,0xbf353f35,0x3f0ebf55,0xbec43f6d,0x3e48bf7b
.long 0xbf80a554,0x3f6dbec4,0xbf353f35,0x3ec4bf6d,0xbf35bf35,0x3f7b3e48,0xbf6d3ec4,0x3f0ebf55
.long 0x250dbf80,0x3f353f35,0xbf80a554,0x3f35bf35,0x3f35bf35,0x3e483f7b,0xbf6dbec4,0x3f55bf0e
.long 0x3f80248d,0xbec43f6d,0xbf35bf35,0x3f6dbec4,0x3f353f35,0xbf553f0e,0xbec4bf6d,0x3f7bbe48
.long 0x3f80,0xbf80a554,0x250dbf80,0x3f80248d,0xbf353f35,0xbf55bf0e,0x3ec4bf6d,0x3f7b3e48
.long 0xbf80a554,0xbec4bf6d,0x3f35bf35,0x3f6d3ec4,0xbf35bf35,0x3e48bf7b,0x3f6dbec4,0x3f553f0e
.long 0x250dbf80,0x3f35bf35,0x3f80248d,0x3f353f35,0x3f35bf35,0x3f7bbe48,0x3f6d3ec4,0x3f0e3f55
.long 0x3f80248d,0x3f6d3ec4,0x3f353f35,0x3ec43f6d,0x3f353f35,0x3f0e3f55,0x3ec43f6d,0x3e483f7b
.long 0x3f800000,0xbf80250d,0x3f800000,0xbf80250d,0x3f800000,0xbf7bbe48,0x3f6d3ec4,0xbf55bf0e
.long 0x3f800000,0xbf6dbec4,0x3f353f35,0xbec4bf6d,0x3f800000,0xbf55bf0e,0x3ec43f6d,0x3e48bf7b
.long 0x3f800000,0xbf35bf35,0x248d3f80,0x3f35bf35,0x3f800000,0xbf0ebf55,0xbec43f6d,0x3f7bbe48
.long 0x3f800000,0xbec4bf6d,0xbf353f35,0x3f6d3ec4,0x3f800000,0xbe48bf7b,0xbf6d3ec4,0x3f0e3f55
.long 0x3f800000,0xa554bf80,0xbf80250d,0x248d3f80,0x3f800000,0x3e48bf7b,0xbf6dbec4,0xbf0e3f55
.long 0x3f800000,0x3ec4bf6d,0xbf35bf35,0xbf6d3ec4,0x3f800000,0x3f0ebf55,0xbec4bf6d,0xbf7bbe48
.long 0x3f800000,0x3f35bf35,0xa554bf80,0xbf35bf35,0x3f800000,0x3f55bf0e,0x3ec4bf6d,0xbe48bf7b
.long 0x3f800000,0x3f6dbec4,0x3f35bf35,0x3ec4bf6d,0x3f800000,0x3f7bbe48,0x3f6dbec4,0x3f55bf0e
.long 0x3f800000,0xbf80250d,0x3f800000,0xbf80250d,0x3f353f35,0xbf0ebf55,0x3ec43f6d,0xbe48bf7b
.long 0x248d3f80,0x3ec4bf6d,0xbf353f35,0x3f6dbec4,0xbf353f35,0x3f7bbe48,0xbf6dbec4,0x3f0e3f55
.long 0xbf80250d,0x3f353f35,0xa554bf80,0xbf353f35,0xbf35bf35,0xbe483f7b,0x3f6dbec4,0xbf55bf0e
.long 0xa554bf80,0xbf6d3ec4,0x3f353f35,0x3ec4bf6d,0x3f35bf35,0xbf55bf0e,0xbec43f6d,0x3f7b3e48
.long 0x3f800000,0xa554bf80,0xbf80250d,0x248d3f80,0x3f353f35,0x3f55bf0e,0xbec4bf6d,0xbf7b3e48
.long 0x248d3f80,0x3f6d3ec4,0x3f35bf35,0xbec4bf6d,0xbf353f35,0x3e483f7b,0x3f6d3ec4,0x3f55bf0e
.long 0xbf80250d,0xbf353f35,0x248d3f80,0x3f353f35,0xbf35bf35,0xbf7bbe48,0xbf6d3ec4,0xbf0e3f55
.long 0xa554bf80,0xbec4bf6d,0xbf35bf35,0xbf6dbec4,0x3f35bf35,0x3f0ebf55,0x3ec4bf6d,0x3e48bf7b
.long 0x3f800000,0xbf80250d,0x3f800000,0xbf80250d,0x248d3f80,0x3e48bf7b,0xbec43f6d,0x3f0ebf55
.long 0xbf80250d,0x3f6d3ec4,0xbf35bf35,0x3ec43f6d,0xa554bf80,0xbf0e3f55,0x3f6dbec4,0xbf7bbe48
.long 0x3f800000,0xbf35bf35,0x248d3f80,0x3f35bf35,0x248d3f80,0x3f55bf0e,0xbf6dbec4,0x3e483f7b
.long 0xbf80250d,0x3ec43f6d,0x3f35bf35,0xbf6dbec4,0xa554bf80,0xbf7b3e48,0x3ec43f6d,0x3f55bf0e
.long 0x3f800000,0xa554bf80,0xbf80250d,0x248d3f80,0x248d3f80,0x3f7b3e48,0x3ec4bf6d,0xbf55bf0e
.long 0xbf80250d,0xbec43f6d,0x3f353f35,0x3f6dbec4,0xa554bf80,0xbf55bf0e,0xbf6d3ec4,0xbe483f7b
.long 0x3f800000,0x3f35bf35,0xa554bf80,0xbf35bf35,0x248d3f80,0x3f0e3f55,0x3f6d3ec4,0x3f7bbe48
.long 0xbf80250d,0xbf6d3ec4,0xbf353f35,0xbec43f6d,0xa554bf80,0xbe48bf7b,0xbec4bf6d,0xbf0ebf55
.long 0x3f800000,0xbf80250d,0x3f800000,0xbf80250d,0xbf353f35,0x3f55bf0e,0xbf6d3ec4,0x3f7bbe48
.long 0xa554bf80,0xbec43f6d,0x3f35bf35,0xbf6d3ec4,0x3f353f35,0xbe48bf7b,0xbec43f6d,0x3f55bf0e
.long 0xbf80250d,0x3f353f35,0xa554bf80,0xbf353f35,0x3f35bf35,0xbf7bbe48,0x3ec43f6d,0x3f0ebf55
.long 0x248d3f80,0x3f6dbec4,0xbf35bf35,0xbec43f6d,0xbf35bf35,0xbf0e3f55,0x3f6d3ec4,0x3e48bf7b
.long 0x3f800000,0xa554bf80,0xbf80250d,0x248d3f80,0xbf353f35,0x3f0e3f55,0x3f6dbec4,0xbe48bf7b
.long 0xa554bf80,0xbf6dbec4,0xbf353f35,0x3ec43f6d,0x3f353f35,0x3f7bbe48,0x3ec4bf6d,0xbf0ebf55
.long 0xbf80250d,0xbf353f35,0x248d3f80,0x3f353f35,0x3f35bf35,0x3e48bf7b,0xbec4bf6d,0xbf55bf0e
.long 0x248d3f80,0x3ec43f6d,0x3f353f35,0x3f6d3ec4,0xbf35bf35,0xbf55bf0e,0xbf6dbec4,0xbf7bbe48
.long 0xbf800000,0x3f80250d,0xbf800000,0x3f80250d,0x3f80250d,0xbf7b3e48,0x3f6dbec4,0xbf553f0e
.long 0xbf800000,0x3f6dbec4,0xbf353f35,0x3ec4bf6d,0x3f80250d,0xbf553f0e,0x3ec4bf6d,0x3e483f7b
.long 0xbf800000,0x3f35bf35,0xa48d3f80,0xbf35bf35,0x3f80250d,0xbf0e3f55,0xbec4bf6d,0x3f7b3e48
.long 0xbf800000,0x3ec4bf6d,0x3f353f35,0xbf6d3ec4,0x3f80250d,0xbe483f7b,0xbf6dbec4,0x3f0ebf55
.long 0xbf800000,0x2554bf80,0x3f80250d,0xa48d3f80,0x3f80250d,0x3e483f7b,0xbf6d3ec4,0xbf0ebf55
.long 0xbf800000,0xbec4bf6d,0x3f35bf35,0x3f6d3ec4,0x3f80250d,0x3f0e3f55,0xbec43f6d,0xbf7b3e48
.long 0xbf800000,0xbf35bf35,0x2554bf80,0x3f35bf35,0x3f80250d,0x3f553f0e,0x3ec43f6d,0xbe483f7b
.long 0xbf800000,0xbf6dbec4,0xbf35bf35,0xbec4bf6d,0x3f80250d,0x3f7b3e48,0x3f6d3ec4,0x3f553f0e
.long 0xbf800000,0x3f80250d,0xbf800000,0x3f80250d,0x3f35bf35,0xbf0e3f55,0x3ec4bf6d,0xbe483f7b
.long 0xa48d3f80,0xbec4bf6d,0x3f353f35,0xbf6dbec4,0xbf35bf35,0x3f7b3e48,0xbf6d3ec4,0x3f0ebf55
.long 0x3f80250d,0xbf353f35,0x2554bf80,0x3f353f35,0xbf353f35,0xbe48bf7b,0x3f6d3ec4,0xbf553f0e
.long 0x2554bf80,0x3f6d3ec4,0xbf353f35,0xbec4bf6d,0x3f353f35,0xbf553f0e,0xbec4bf6d,0x3f7bbe48
.long 0xbf800000,0x2554bf80,0x3f80250d,0xa48d3f80,0x3f35bf35,0x3f553f0e,0xbec43f6d,0xbf7bbe48
.long 0xa48d3f80,0xbf6d3ec4,0xbf35bf35,0x3ec4bf6d,0xbf35bf35,0x3e48bf7b,0x3f6dbec4,0x3f553f0e
.long 0x3f80250d,0x3f353f35,0xa48d3f80,0xbf353f35,0xbf353f35,0xbf7b3e48,0xbf6dbec4,0xbf0ebf55
.long 0x2554bf80,0x3ec4bf6d,0x3f35bf35,0x3f6dbec4,0x3f353f35,0x3f0e3f55,0x3ec43f6d,0x3e483f7b
.long 0xbf800000,0x3f80250d,0xbf800000,0x3f80250d,0x2554bf80,0x3e483f7b,0xbec4bf6d,0x3f0e3f55
.long 0x3f80250d,0xbf6d3ec4,0x3f35bf35,0xbec43f6d,0xa48d3f80,0xbf0ebf55,0x3f6d3ec4,0xbf7b3e48
.long 0xbf800000,0x3f35bf35,0xa48d3f80,0xbf35bf35,0x2554bf80,0x3f553f0e,0xbf6d3ec4,0x3e48bf7b
.long 0x3f80250d,0xbec43f6d,0xbf35bf35,0x3f6dbec4,0xa48d3f80,0xbf7bbe48,0x3ec4bf6d,0x3f553f0e
.long 0xbf800000,0x2554bf80,0x3f80250d,0xa48d3f80,0x2554bf80,0x3f7bbe48,0x3ec43f6d,0xbf553f0e
.long 0x3f80250d,0x3ec43f6d,0xbf353f35,0xbf6dbec4,0xa48d3f80,0xbf553f0e,0xbf6dbec4,0xbe48bf7b
.long 0xbf800000,0xbf35bf35,0x2554bf80,0x3f35bf35,0x2554bf80,0x3f0ebf55,0x3f6dbec4,0x3f7b3e48
.long 0x3f80250d,0x3f6d3ec4,0x3f353f35,0x3ec43f6d,0xa48d3f80,0xbe483f7b,0xbec43f6d,0xbf0e3f55
.long 0xbf800000,0x3f80250d,0xbf800000,0x3f80250d,0xbf35bf35,0x3f553f0e,0xbf6dbec4,0x3f7b3e48
.long 0x2554bf80,0x3ec43f6d,0xbf35bf35,0x3f6d3ec4,0x3f35bf35,0xbe483f7b,0xbec4bf6d,0x3f553f0e
.long 0x3f80250d,0xbf353f35,0x2554bf80,0x3f353f35,0x3f353f35,0xbf7b3e48,0x3ec4bf6d,0x3f0e3f55
.long 0xa48d3f80,0xbf6dbec4,0x3f35bf35,0x3ec43f6d,0xbf353f35,0xbf0ebf55,0x3f6dbec4,0x3e483f7b
.long 0xbf800000,0x2554bf80,0x3f80250d,0xa48d3f80,0xbf35bf35,0x3f0ebf55,0x3f6d3ec4,0xbe483f7b
.long 0x2554bf80,0x3f6dbec4,0x3f353f35,0xbec43f6d,0x3f35bf35,0x3f7b3e48,0x3ec43f6d,0xbf0e3f55
.long 0x3f80250d,0x3f353f35,0xa48d3f80,0xbf353f35,0x3f353f35,0x3e483f7b,0xbec43f6d,0xbf553f0e
.long 0xa48d3f80,0xbec43f6d,0xbf353f35,0xbf6d3ec4,0xbf353f35,0xbf553f0e,0xbf6d3ec4,0xbf7b3e48
.long 0x3f803f80,0x3f803f80,0x80008000,0x80008000,0x3f733f80,0x3f163f4f,0xbe9e8000,0xbf4fbf16
.long 0x3f4f3f80,0xbe9e3e9e,0xbf168000,0xbf73bf73,0x3f163f80,0xbf73be9e,0xbf4f8000,0xbe9ebf73
.long 0x3e9e3f80,0xbf4fbf4f,0xbf738000,0x3f16bf16,0x248d3f80,0xa554bf80,0xbf808000,0x3f80a50d
.long 0xbe9e3f80,0x3f4fbf4f,0xbf738000,0x3f163f16,0xbf163f80,0x3f73be9e,0xbf4f8000,0xbe9e3f73
.long 0xbf4f3f80,0x3e9e3e9e,0xbf168000,0xbf733f73,0xbf733f80,0xbf163f4f,0xbe9e8000,0xbf4f3f16
.long 0xbf803f80,0xbf803f80,0xa50d8000,0xa50d8000,0xbf733f80,0xbf163f4f,0x3e9e8000,0x3f4fbf16
.long 0xbf4f3f80,0x3e9e3e9e,0x3f168000,0x3f73bf73,0xbf163f80,0x3f73be9e,0x3f4f8000,0x3e9ebf73
.long 0xbe9e3f80,0x3f4fbf4f,0x3f738000,0xbf16bf16,0xa5543f80,0x248dbf80,0x3f808000,0xbf80a50d
.long 0x3f803f80,0x3f803f80,0x80008000,0x80008000,0x248d3e9e,0xbf16be9e,0xbf80bf73,0xbf4fbf73
.long 0xbf80bf4f,0xbe9ebf4f,0xa50dbf16,0x3f733f16,0xa554bf4f,0x3f733f4f,0x3f803f16,0xbe9e3f16
.long 0x3f803e9e,0xbf4f3e9e,0x80003f73,0xbf16bf73,0x248d3f80,0xa554bf80,0xbf808000,0x3f80a50d
.long 0xbf803e9e,0x3f4f3e9e,0xa50dbf73,0xbf163f73,0xa554bf4f,0xbf733f4f,0x3f80bf16,0xbe9ebf16
.long 0x3f80bf4f,0x3e9ebf4f,0x80003f16,0x3f73bf16,0x248d3e9e,0x3f16be9e,0xbf803f73,0xbf4f3f73
.long 0xbf803f80,0xbf803f80,0xa50d8000,0xa50d8000,0xa5543e9e,0x3f16be9e,0x3f80bf73,0x3f4fbf73
.long 0x3f80bf4f,0x3e9ebf4f,0x8000bf16,0xbf733f16,0x248dbf4f,0xbf733f4f,0xbf803f16,0x3e9e3f16
.long 0xbf803e9e,0x3f4f3e9e,0xa50d3f73,0x3f16bf73,0xa5543f80,0x248dbf80,0x3f808000,0xbf80a50d
.long 0x3f803f80,0x3f803f80,0x80008000,0x80008000,0xbf73bf4f,0xbf73bf80,0xbe9ebf16,0x3e9ea50d
.long 0x3f4f3e9e,0x3f4f3f80,0x3f163f73,0xbf168000,0xbf163e9e,0xbf16bf80,0xbf4fbf73,0x3f4fa50d
.long 0x3e9ebf4f,0x3e9e3f80,0x3f733f16,0xbf738000,0x248d3f80,0xa554bf80,0xbf808000,0x3f80a50d
.long 0xbe9ebf4f,0xbe9e3f80,0x3f73bf16,0xbf738000,0x3f163e9e,0x3f16bf80,0xbf4f3f73,0x3f4fa50d
.long 0xbf4f3e9e,0xbf4f3f80,0x3f16bf73,0xbf168000,0x3f73bf4f,0x3f73bf80,0xbe9e3f16,0x3e9ea50d
.long 0xbf803f80,0xbf803f80,0xa50d8000,0xa50d8000,0x3f73bf4f,0x3f73bf80,0x3e9ebf16,0xbe9ea50d
.long 0xbf4f3e9e,0xbf4f3f80,0xbf163f73,0x3f168000,0x3f163e9e,0x3f16bf80,0x3f4fbf73,0xbf4fa50d
.long 0xbe9ebf4f,0xbe9e3f80,0xbf733f16,0x3f738000,0xa5543f80,0x248dbf80,0x3f808000,0xbf80a50d
.long 0x3f803f80,0x3f803f80,0x80008000,0x80008000,0xbf16bf4f,0xa554be9e,0x3f4f3f16,0x3f803f73
.long 0xbe9e3e9e,0xbf80bf4f,0xbf73bf73,0xa50dbf16,0x3f733e9e,0x248d3f4f,0x3e9e3f73,0xbf80bf16
.long 0xbf4fbf4f,0x3f803e9e,0x3f16bf16,0x80003f73,0x248d3f80,0xa554bf80,0xbf808000,0x3f80a50d
.long 0x3f4fbf4f,0xbf803e9e,0x3f163f16,0xa50dbf73,0xbf733e9e,0x248d3f4f,0x3e9ebf73,0xbf803f16
.long 0x3e9e3e9e,0x3f80bf4f,0xbf733f73,0x80003f16,0x3f16bf4f,0xa554be9e,0x3f4fbf16,0x3f80bf73
.long 0xbf803f80,0xbf803f80,0xa50d8000,0xa50d8000,0x3f16bf4f,0x248dbe9e,0xbf4f3f16,0xbf803f73
.long 0x3e9e3e9e,0x3f80bf4f,0x3f73bf73,0x8000bf16,0xbf733e9e,0xa5543f4f,0xbe9e3f73,0x3f80bf16
.long 0x3f4fbf4f,0xbf803e9e,0xbf16bf16,0xa50d3f73,0xa5543f80,0x248dbf80,0x3f808000,0xbf80a50d
.long 0x3e9e3f80,0xbf4fbf4f,0x3f738000,0xbf163f16,0x3f163f80,0xbf73be9e,0x3f4f8000,0x3e9e3f73
.long 0x3f4f3f80,0xbe9e3e9e,0x3f168000,0x3f733f73,0x3f733f80,0x3f163f4f,0x3e9e8000,0x3f4f3f16
.long 0x0,0x0,0x0,0x0,0x0,0x0,0x0,0x0
.long 0x0,0x0,0x0,0x0,0x0,0x0,0x0,0x0
.long 0x0,0x0,0x0,0x0,0x0,0x0,0x0,0x0
.long 0x0,0x0,0x0,0x0,0x0,0x0,0x0,0x0
.long 0x0,0x0,0x0,0x0,0x0,0x0,0x0,0x0
.long 0x0,0x0,0x0,0x0,0x0,0x0,0x0,0x0
.long 0x3f803e9e,0xbf4f3e9e,0x8000bf73,0x3f163f73,0x248dbf4f,0x3f733f4f,0xbf80bf16,0x3e9ebf16
.long 0xbf80bf4f,0xbe9ebf4f,0xa50d3f16,0xbf73bf16,0xa5543e9e,0xbf16be9e,0x3f803f73,0x3f4f3f73
.long 0x0,0x0,0x0,0x0,0x0,0x0,0x0,0x0
.long 0x0,0x0,0x0,0x0,0x0,0x0,0x0,0x0
.long 0x0,0x0,0x0,0x0,0x0,0x0,0x0,0x0
.long 0x0,0x0,0x0,0x0,0x0,0x0,0x0,0x0
.long 0x0,0x0,0x0,0x0,0x0,0x0,0x0,0x0
.long 0x0,0x0,0x0,0x0,0x0,0x0,0x0,0x0
.long 0x3e9ebf4f,0x3e9e3f80,0xbf73bf16,0x3f738000,0xbf163e9e,0xbf16bf80,0x3f4f3f73,0xbf4fa50d
.long 0x3f4f3e9e,0x3f4f3f80,0xbf16bf73,0x3f168000,0xbf73bf4f,0xbf73bf80,0x3e9e3f16,0xbe9ea50d
.long 0x0,0x0,0x0,0x0,0x0,0x0,0x0,0x0
.long 0x0,0x0,0x0,0x0,0x0,0x0,0x0,0x0
.long 0x0,0x0,0x0,0x0,0x0,0x0,0x0,0x0
.long 0x0,0x0,0x0,0x0,0x0,0x0,0x0,0x0
.long 0x0,0x0,0x0,0x0,0x0,0x0,0x0,0x0
.long 0x0,0x0,0x0,0x0,0x0,0x0,0x0,0x0
.long 0xbf4fbf4f,0x3f803e9e,0xbf163f16,0x8000bf73,0x3f733e9e,0xa5543f4f,0xbe9ebf73,0x3f803f16
.long 0xbe9e3e9e,0xbf80bf4f,0x3f733f73,0xa50d3f16,0xbf16bf4f,0x248dbe9e,0xbf4fbf16,0xbf80bf73
.long 0x0,0x0,0x0,0x0,0x0,0x0,0x0,0x0
.long 0x0,0x0,0x0,0x0,0x0,0x0,0x0,0x0
.long 0x0,0x0,0x0,0x0,0x0,0x0,0x0,0x0
.long 0x0,0x0,0x0,0x0,0x0,0x0,0x0,0x0
.long 0x0,0x0,0x0,0x0,0x0,0x0,0x0,0x0
.long 0x0,0x0,0x0,0x0,0x0,0x0,0x0,0x0
.long 0x354ccccd,0x35cccccd,0x35cccccd,0x35cccccd,0x354ccccd,0x35ccca46,0x35ccc2b2,0x35ccb610
.long 0x354ccccd,0x35ccc2b2,0x35cca461,0x35cc71de,0x354ccccd,0x35ccb610,0x35cc71de,0x35cc0047
.long 0x354ccccd,0x35cca461,0x35cc2b2e,0x35cb6163,0x354ccccd,0x35cc8da6,0x35cbd057,0x35ca9556
.long 0x354ccccd,0x35cc71de,0x35cb6163,0x35c99c4e,0x354ccccd,0x35cc510b,0x35cade5d,0x35c87681
.long 0x354ccccd,0x35cc2b2e,0x35ca4751,0x35c72430,0x354ccccd,0x35cc0047,0x35c99c4e,0x35c5a5a8
.long 0x354ccccd,0x35cbd057,0x35c8dd65,0x35c3fb3c,0x354ccccd,0x35cb9b60,0x35c80aaa,0x35c2254b
.long 0x354ccccd,0x35cb6163,0x35c72430,0x35c0243f,0x354ccccd,0x35cb2261,0x35c62a0f,0x35bdf888
.long 0x354ccccd,0x35cade5d,0x35c51c60,0x35bba2a3,0x354ccccd,0x35ca9556,0x35c3fb3c,0x35b92313
.long 0x35cccccd,0x35cccccd,0x35cccccd,0x35cccccd,0x35cca461,0x35cc8da6,0x35cc71de,0x35cc510b
.long 0x35cc2b2e,0x35cbd057,0x35cb6163,0x35cade5d,0x35cb6163,0x35ca9556,0x35c99c4e,0x35c87681
.long 0x35ca4751,0x35c8dd65,0x35c72430,0x35c51c60,0x35c8dd65,0x35c6a993,0x35c3fb3c,0x35c0d407
.long 0x35c72430,0x35c3fb3c,0x35c0243f,0x35bba2a3,0x35c51c60,0x35c0d407,0x35bba2a3,0x35b58e7a
.long 0x35c2c6c0,0x35bd35e5,0x35b67a67,0x35ae9ee7,0x35c0243f,0x35b92313,0x35b0b021,0x35a6dc49
.long 0x35bd35e5,0x35b49e13,0x35aa48f4,0x359e5003,0x35b9fcdb,0x35afa9af,0x35a34a91,0x35950468
.long 0x35b67a67,0x35aa48f4,0x359bbb2c,0x358b04b5,0x35b2afeb,0x35a47f35,0x3593a17d,0x35805d00
.long 0x35ae9ee7,0x359e5003,0x358b04b5,0x356a3450,0x35aa48f4,0x3597bf2e,0x3581ec7b,0x35529394
.long 0x35cccccd,0x35cccccd,0x354ccccd,0x0,0x35cc2b2e,0x35cc0047,0x354bd057,0x0
.long 0x35ca4751,0x35c99c4e,0x3548dd65,0x0,0x35c72430,0x35c5a5a8,0x3543fb3c,0x0
.long 0x35c2c6c0,0x35c0243f,0x353d35e5,0x0,0x35bd35e5,0x35b92313,0x35349e13,0x0
.long 0x35b67a67,0x35b0b021,0x352a48f4,0x0,0x35ae9ee7,0x35a6dc49,0x351e5003,0x0
.long 0x35a5afca,0x359bbb2c,0x3510d0c3,0x0,0x359bbb2c,0x358f6305,0x3501ec7b,0x0
.long 0x3590d0c3,0x3581ec7b,0x34e38fc3,0x0,0x358501c8,0x3566e4e3,0x34c11588,0x0
.long 0x3570c1c0,0x354823a7,0x349cbf44,0x0,0x355603f2,0x3527d2ae,0x346dcd1c,0x0
.long 0x3539f45b,0x35063284,0x341fd168,0x0,0x351cbf44,0x34c70ca3,0x33a0975e,0x80000000
.long 0x0,0x0,0x0,0x0,0x0,0x0,0x0,0x0
.long 0x0,0x0,0x0,0x0,0x0,0x0,0x0,0x0
.long 0x0,0x0,0x0,0x0,0x0,0x0,0x0,0x0
.long 0x0,0x0,0x0,0x0,0x0,0x0,0x0,0x0
.long 0x0,0x0,0x0,0x0,0x0,0x0,0x0,0x0
.long 0x0,0x0,0x0,0x0,0x0,0x0,0x0,0x80000000
.long 0x0,0x0,0x80000000,0x80000000,0x0,0x80000000,0x80000000,0x80000000
.long 0x80000000,0x80000000,0x80000000,0x80000000,0x80000000,0x80000000,0x80000000,0x80000000
.long 0x80000000,0x80000000,0x80000000,0x80000000,0x80000000,0xb280ad75,0xb300abdf,0xb340fdd6
.long 0x80000000,0xb300abdf,0xb380a585,0xb3c0e869,0x80000000,0xb340fdd6,0xb3c0e869,0xb4109388
.long 0x80000000,0xb380a585,0xb4008c21,0xb44092c2,0x80000000,0xb3a0c8f3,0xb420975e,0xb4706739
.long 0x80000000,0xb3c0e869,0xb44092c2,0xb4900327,0x80000000,0xb3e1031c,0xb4607b24,0xb4a7b2b7
.long 0x80000000,0xb4008c21,0xb48026af,0xb4bf3d0b,0x80000000,0xb4109388,0xb4900327,0xb4d69ce7
.long 0x80000000,0xb420975e,0xb49fd168,0xb4edcd1c,0x80000000,0xb430973e,0xb4af8fe3,0xb5026442
.long 0x80000000,0xb44092c2,0xb4bf3d0b,0xb50dc501,0x80000000,0xb4508986,0xb4ced752,0xb5190646
.long 0x80000000,0xb4607b24,0xb4de5d30,0xb5242590,0x80000000,0xb4706739,0xb4edcd1c,0xb52f2067
.long 0x80000000,0x80000000,0x80000000,0x80000000,0xb380a585,0xb3a0c8f3,0xb3c0e869,0xb3e1031c
.long 0xb4008c21,0xb420975e,0xb44092c2,0xb4607b24,0xb44092c2,0xb4706739,0xb4900327,0xb4a7b2b7
.long 0xb48026af,0xb49fd168,0xb4bf3d0b,0xb4de5d30,0xb49fd168,0xb4c70ca3,0xb4edcd1c,0xb509fd76
.long 0xb4bf3d0b,0xb4edcd1c,0xb50dc501,0xb5242590,0xb4de5d30,0xb509fd76,0xb5242590,0xb53d8748
.long 0xb4fd2590,0xb51cbf44,0xb539f45b,0xb55603f2,0xb50dc501,0xb52f2067,0xb54f1e05,0xb56d7df6
.long 0xb51cbf44,0xb5411588,0xb5638fc3,0xb581ec7b,0xb52b7ba8,0xb5529394,0xb577376d,0xb58c7cf5
.long 0xb539f45b,0xb5638fc3,0xb58501c8,0xb59663a6,0xb54823a7,0xb573ff99,0xb58df1bd,0xb59f9496
.long 0xb55603f2,0xb581ec7b,0xb59663a6,0xb5a804aa,0xb5638fc3,0xb5898908,0xb59e5003,0xb5afa9af
.long 0x80000000,0x80000000,0x80000000,0x80000000,0xb4008c21,0xb4109388,0xb3a0975e,0x80000000
.long 0xb48026af,0xb4900327,0xb41fd168,0x80000000,0xb4bf3d0b,0xb4d69ce7,0xb46dcd1c,0x80000000
.long 0xb4fd2590,0xb50dc501,0xb49cbf44,0x80000000,0xb51cbf44,0xb52f2067,0xb4c11588,0x80000000
.long 0xb539f45b,0xb54f1e05,0xb4e38fc3,0x80000000,0xb55603f2,0xb56d7df6,0xb501ec7b,0x80000000
.long 0xb570c1c0,0xb58501c8,0xb510d0c3,0x80000000,0xb58501c8,0xb5923aee,0xb51e5003,0x80000000
.long 0xb590d0c3,0xb59e5003,0xb52a48f4,0x80000000,0xb59bbb2c,0xb5a928e5,0xb5349e13,0x80000000
.long 0xb5a5afca,0xb5b2afeb,0xb53d35e5,0x80000000,0xb5ae9ee7,0xb5bad20d,0xb543fb3c,0x80000000
.long 0xb5b67a67,0xb5c17f0c,0xb548dd65,0x80000000,0xb5bd35e5,0xb5c6a993,0xb54bd057,0x80000000
.long 0x80000000,0x80000000,0x80000000,0x80000000,0x80000000,0x80000000,0x80000000,0x80000000
.long 0x80000000,0x80000000,0x80000000,0x80000000,0x80000000,0x80000000,0x80000000,0x80000000
.long 0x80000000,0x80000000,0x80000000,0x80000000,0x80000000,0x80000000,0x80000000,0x80000000
.long 0x80000000,0x80000000,0x80000000,0x80000000,0x80000000,0x80000000,0x80000000,0x80000000
.long 0x80000000,0x80000000,0x80000000,0x80000000,0x80000000,0x80000000,0x80000000,0x80000000
.long 0x80000000,0x80000000,0x80000000,0x80000000,0x80000000,0x80000000,0x80000000,0x80000000
.long 0x80000000,0x80000000,0x80000000,0x80000000,0x80000000,0x80000000,0x80000000,0x80000000
.long 0x80000000,0x80000000,0x80000000,0x80000000,0x80000000,0x80000000,0x80000000,0x80000000
.long 0x354ccccd,0x35ca4751,0x35c2c6c0,0x35b67a67,0x354ccccd,0x35c9f44d,0x35c17f0c,0x35b3a936
.long 0x354ccccd,0x35c99c4e,0x35c0243f,0x35b0b021,0x354ccccd,0x35c93f55,0x35beb67b,0x35ad8fd0
.long 0x354ccccd,0x35c8dd65,0x35bd35e5,0x35aa48f4,0x354ccccd,0x35c87681,0x35bba2a3,0x35a6dc49
.long 0x354ccccd,0x35c80aaa,0x35b9fcdb,0x35a34a91,0x354ccccd,0x35c799e3,0x35b844b9,0x359f9496
.long 0x354ccccd,0x35c72430,0x35b67a67,0x359bbb2c,0x354ccccd,0x35c6a993,0x35b49e13,0x3597bf2e
.long 0x354ccccd,0x35c62a0f,0x35b2afeb,0x3593a17d,0x354ccccd,0x35c5a5a8,0x35b0b021,0x358f6305
.long 0x354ccccd,0x35c51c60,0x35ae9ee7,0x358b04b5,0x354ccccd,0x35c48e3a,0x35ac7c70,0x35868788
.long 0x354ccccd,0x35c3fb3c,0x35aa48f4,0x3581ec7b,0x354ccccd,0x35c36367,0x35a804aa,0x357a6928
.long 0x35a5afca,0x3590d0c3,0x3570c1c0,0x3539f45b,0x35a0d539,0x35898908,0x355cd4c0,0x35207465
.long 0x359bbb2c,0x3581ec7b,0x354823a7,0x35063284,0x359663a6,0x3573ff99,0x3532c0d3,0x34d69ce7
.long 0x3590d0c3,0x35638fc3,0x351cbf44,0x349fd168,0x358b04b5,0x35529394,0x35063284,0x34508986
.long 0x358501c8,0x35411588,0x34de5d30,0x33c0e869,0x357d94b5,0x352f2067,0x34af8fe3,0xb280ad75
.long 0x3570c1c0,0x351cbf44,0x348026af,0xb4008c21,0x35638fc3,0x3509fd76,0x3420975e,0xb4706739
.long 0x355603f2,0x34edcd1c,0x3380a585,0xb4af8fe3,0x354823a7,0x34c70ca3,0xb300abdf,0xb4e617fd
.long 0x3539f45b,0x349fd168,0xb4008c21,0xb50dc501,0x352b7ba8,0x34706739,0xb4607b24,0xb527d2ae
.long 0x351cbf44,0x3420975e,0xb49fd168,0xb5411588,0x350dc501,0x33a0c8f3,0xb4ced752,0xb5596f08
.long 0x34fd2590,0x348026af,0x1a61e84f,0x80000000,0x34bf3d0b,0x33e1031c,0xb3a0975e,0x80000000
.long 0x348026af,0xb300abdf,0xb41fd168,0x80000000,0x34008c21,0xb430973e,0xb46dcd1c,0x80000000
.long 0x1ae1e84f,0xb49fd168,0xb49cbf44,0x80000000,0xb4008c21,0xb4e617fd,0xb4c11588,0x80000000
.long 0xb48026af,0xb5154980,0xb4e38fc3,0x80000000,0xb4bf3d0b,0xb5365cd7,0xb501ec7b,0x80000000
.long 0xb4fd2590,0xb55603f2,0xb510d0c3,0x80000000,0xb51cbf44,0xb573ff99,0xb51e5003,0x80000000
.long 0xb539f45b,0xb58809f5,0xb52a48f4,0x80000000,0xb55603f2,0xb5950468,0xb5349e13,0x80000000
.long 0xb570c1c0,0xb5a0d539,0xb53d35e5,0x80000000,0xb58501c8,0xb5ab64d0,0xb543fb3c,0x80000000
.long 0xb590d0c3,0xb5b49e13,0xb548dd65,0x80000000,0xb59bbb2c,0xb5bc6e97,0xb54bd057,0x80000000
.long 0x80000000,0x80000000,0x80000000,0x80000000,0x80000000,0x80000000,0x80000000,0x80000000
.long 0x80000000,0x80000000,0x80000000,0x80000000,0x80000000,0x80000000,0x80000000,0x80000000
.long 0x80000000,0x80000000,0x80000000,0x80000000,0x80000000,0x80000000,0x80000000,0x80000000
.long 0x80000000,0x80000000,0x80000000,0x80000000,0x80000000,0x80000000,0x80000000,0x80000000
.long 0x80000000,0x80000000,0x80000000,0x80000000,0x80000000,0x80000000,0x80000000,0x80000000
.long 0x80000000,0x80000000,0x80000000,0x80000000,0x80000000,0x80000000,0x80000000,0x80000000
.long 0x80000000,0x80000000,0x80000000,0x80000000,0x80000000,0x80000000,0x80000000,0x80000000
.long 0x80000000,0x80000000,0x80000000,0x80000000,0x80000000,0x80000000,0x80000000,0x80000000
.long 0x80000000,0xb48026af,0xb4fd2590,0xb539f45b,0x80000000,0xb4881699,0xb5063284,0xb5449f04
.long 0x80000000,0xb4900327,0xb50dc501,0xb54f1e05,0x80000000,0xb497ec27,0xb5154980,0xb5596f08
.long 0x80000000,0xb49fd168,0xb51cbf44,0xb5638fc3,0x80000000,0xb4a7b2b7,0xb5242590,0xb56d7df6
.long 0x80000000,0xb4af8fe3,0xb52b7ba8,0xb577376d,0x80000000,0xb4b768ba,0xb532c0d3,0xb5805d00
.long 0x80000000,0xb4bf3d0b,0xb539f45b,0xb58501c8,0x80000000,0xb4c70ca3,0xb5411588,0xb5898908
.long 0x80000000,0xb4ced752,0xb54823a7,0xb58df1bd,0x80000000,0xb4d69ce7,0xb54f1e05,0xb5923aee
.long 0x80000000,0xb4de5d30,0xb55603f2,0xb59663a6,0x80000000,0xb4e617fd,0xb55cd4c0,0xb59a6af9
.long 0x80000000,0xb4edcd1c,0xb5638fc3,0xb59e5003,0x80000000,0xb4f57c5d,0xb56a3450,0xb5a211e5
.long 0xb570c1c0,0xb590d0c3,0xb5a5afca,0xb5b67a67,0xb57d94b5,0xb597bf2e,0xb5ac7c70,0xb5bc6e97
.long 0xb58501c8,0xb59e5003,0xb5b2afeb,0xb5c17f0c,0xb58b04b5,0xb5a47f35,0xb5b844b9,0xb5c5a5a8
.long 0xb590d0c3,0xb5aa48f4,0xb5bd35e5,0xb5c8dd65,0xb59663a6,0xb5afa9af,0xb5c17f0c,0xb5cb2261
.long 0xb59bbb2c,0xb5b49e13,0xb5c51c60,0xb5cc71de,0xb5a0d539,0xb5b92313,0xb5c80aaa,0xb5ccca46
.long 0xb5a5afca,0xb5bd35e5,0xb5ca4751,0xb5cc2b2e,0xb5aa48f4,0xb5c0d407,0xb5cbd057,0xb5ca9556
.long 0xb5ae9ee7,0xb5c3fb3c,0xb5cca461,0xb5c80aaa,0xb5b2afeb,0xb5c6a993,0xb5ccc2b2,0xb5c48e3a
.long 0xb5b67a67,0xb5c8dd65,0xb5cc2b2e,0xb5c0243f,0xb5b9fcdb,0xb5ca9556,0xb5cade5d,0xb5bad20d
.long 0xb5bd35e5,0xb5cbd057,0xb5c8dd65,0xb5b49e13,0xb5c0243f,0xb5cc8da6,0xb5c62a0f,0xb5ad8fd0
.long 0xb5c2c6c0,0xb5ca4751,0xb54ccccd,0x80000000,0xb5c72430,0xb5cc510b,0xb54bd057,0x80000000
.long 0xb5ca4751,0xb5ccc2b2,0xb548dd65,0x80000000,0xb5cc2b2e,0xb5cb9b60,0xb543fb3c,0x80000000
.long 0xb5cccccd,0xb5c8dd65,0xb53d35e5,0x80000000,0xb5cc2b2e,0xb5c48e3a,0xb5349e13,0x80000000
.long 0xb5ca4751,0xb5beb67b,0xb52a48f4,0x80000000,0xb5c72430,0xb5b761d3,0xb51e5003,0x80000000
.long 0xb5c2c6c0,0xb5ae9ee7,0xb510d0c3,0x80000000,0xb5bd35e5,0xb5a47f35,0xb501ec7b,0x80000000
.long 0xb5b67a67,0xb59916f7,0xb4e38fc3,0x80000000,0xb5ae9ee7,0xb58c7cf5,0xb4c11588,0x80000000
.long 0xb5a5afca,0xb57d94b5,0xb49cbf44,0x80000000,0xb59bbb2c,0xb5603506,0xb46dcd1c,0x80000000
.long 0xb590d0c3,0xb5411588,0xb41fd168,0x0,0xb58501c8,0xb5207465,0xb3a0975e,0x0
.long 0x80000000,0x80000000,0x80000000,0x80000000,0x80000000,0x80000000,0x80000000,0x80000000
.long 0x80000000,0x80000000,0x80000000,0x80000000,0x80000000,0x80000000,0x80000000,0x80000000
.long 0x80000000,0x80000000,0x80000000,0x80000000,0x80000000,0x80000000,0x80000000,0x80000000
.long 0x80000000,0x80000000,0x80000000,0x0,0x80000000,0x80000000,0x0,0x0
.long 0x80000000,0x80000000,0x0,0x0,0x80000000,0x0,0x0,0x0
.long 0x80000000,0x0,0x0,0x0,0x0,0x0,0x0,0x0
.long 0x0,0x0,0x0,0x0,0x0,0x0,0x0,0x0
.long 0x0,0x0,0x0,0x0,0x0,0x0,0x0,0x0
.long 0x0,0x1e0040,0x0,0x0,0x10,0x1e0044,0x8,0x4
.long 0x20,0x1e0048,0x10,0x8,0x30,0x1e004c,0x18,0xc
.long 0x40,0x1e0050,0x180,0x10,0x50,0x1e0054,0x188,0x14
.long 0x60,0x1e0058,0x190,0x18,0x70,0x1e005c,0x198,0x1c
.long 0x80,0x1e0060,0x320,0x20,0x90,0x1e0064,0x328,0x24
.long 0x50000,0x1e0068,0x330,0x28,0x50010,0x1e006c,0x338,0x2c
.long 0x50020,0x1e0070,0x4a0,0x30,0x50030,0x1e0074,0x4a8,0x34
.long 0x50040,0x1e0078,0x4b0,0x38,0x50050,0x1e007c,0x4b8,0x3c
.long 0x50060,0x1e0080,0x640,0xac0,0x50070,0x1e0084,0x648,0xac4
.long 0x50080,0x1e0088,0x650,0xac8,0x50090,0x1e008c,0x658,0xacc
.long 0xa0000,0x1e0090,0x7c0,0xad0,0xa0010,0x1e0094,0x7c8,0xad4
.long 0xa0020,0x1e0098,0x7d0,0xad8,0xa0030,0x1e009c,0x7d8,0xadc
.long 0xa0040,0x230000,0x960,0xae0,0xa0050,0x230004,0x968,0xae4
.long 0xa0060,0x230008,0x970,0xae8,0xa0070,0x23000c,0x978,0xaec
.long 0xa0080,0x230010,0xae0,0xaf0,0xa0090,0x230014,0xae8,0xaf4
.long 0xf0000,0x230018,0xaf0,0xaf8,0xf0010,0x23001c,0xaf8,0xafc
.long 0xf0020,0x230020,0xc00,0x1580,0xf0030,0x230024,0xc08,0x1584
.long 0xf0040,0x230028,0xc10,0x1588,0xf0050,0x23002c,0xc18,0x158c
.long 0xf0060,0x230030,0xd80,0x1590,0xf0070,0x230034,0xd88,0x1594
.long 0xf0080,0x230038,0xd90,0x1598,0xf0090,0x23003c,0xd98,0x159c
.long 0x140000,0x230040,0xf20,0x15a0,0x140010,0x230044,0xf28,0x15a4
.long 0x140020,0x230048,0xf30,0x15a8,0x140030,0x23004c,0xf38,0x15ac
.long 0x140040,0x230050,0x10a0,0x15b0,0x140050,0x230054,0x10a8,0x15b4
.long 0x140060,0x230058,0x10b0,0x15b8,0x140070,0x23005c,0x10b8,0x15bc
.long 0x140080,0x230060,0x1240,0x2040,0x140090,0x230064,0x1248,0x2044
.long 0x190000,0x230068,0x1250,0x2048,0x190010,0x23006c,0x1258,0x204c
.long 0x190020,0x230070,0x13c0,0x2050,0x190030,0x230074,0x13c8,0x2054
.long 0x190040,0x230078,0x13d0,0x2058,0x190050,0x23007c,0x13d8,0x205c
.long 0x190060,0x230080,0x1560,0x2060,0x190070,0x230084,0x1568,0x2064
.long 0x190080,0x230088,0x1570,0x2068,0x190090,0x23008c,0x1578,0x206c
.long 0x1e0000,0x230090,0x16e0,0x2070,0x1e0010,0x230094,0x16e8,0x2074
.long 0x1e0020,0x230098,0x16f0,0x2078,0x1e0030,0x23009c,0x16f8,0x207c
.long 0x4,0x0,0x0,0x0,0x8,0x4,0x40,0x8
.long 0xc,0x8,0x90,0x10,0x10,0xc,0xd0,0x18
.long 0x14,0x10,0x120,0x20,0x18,0x14,0x160,0x28
.long 0x1c,0x18,0x1b0,0x30,0x0,0x1c,0x1f0,0x38
.long 0x24,0x20,0x200,0x40,0x28,0x24,0x240,0x48
.long 0x2c,0x28,0x290,0x50,0x30,0x2c,0x2d0,0x58
.long 0x34,0x30,0x320,0x60,0x38,0x34,0x360,0x68
.long 0x3c,0x38,0x3b0,0x70,0x40,0x3c,0x3f0,0x78
.long 0xac4,0x140,0x8,0x80,0xac8,0x144,0x48,0x88
.long 0xacc,0x148,0x98,0x90,0xad0,0x14c,0xd8,0x98
.long 0xad4,0x150,0x128,0xa0,0xad8,0x154,0x168,0xa8
.long 0xadc,0x158,0x1b8,0xb0,0xac0,0x15c,0x1f8,0xb8
.long 0xae4,0x160,0x208,0xb8,0xae8,0x164,0x248,0xb8
.long 0xaec,0x168,0x298,0xb8,0xaf0,0x16c,0x2d8,0xb8
.long 0xaf4,0x170,0x328,0xb8,0xaf8,0x174,0x368,0xb8
.long 0xafc,0x178,0x3b8,0xb8,0xb00,0x17c,0x3f8,0xb8
.long 0x1584,0x280,0x10,0xb8,0x1588,0x284,0x50,0xb8
.long 0x158c,0x288,0x80,0xb8,0x1590,0x28c,0xc0,0xb8
.long 0x1594,0x290,0x130,0xb8,0x1598,0x294,0x170,0xb8
.long 0x159c,0x298,0x1a0,0xb8,0x1580,0x29c,0x1e0,0xb8
.long 0x15a4,0x2a0,0x210,0xb8,0x15a8,0x2a4,0x250,0xb8
.long 0x15ac,0x2a8,0x280,0xb8,0x15b0,0x2ac,0x2c0,0xb8
.long 0x15b4,0x2b0,0x330,0xb8,0x15b8,0x2b4,0x370,0xb8
.long 0x15bc,0x2b8,0x3a0,0xb8,0x15c0,0x2bc,0x3e0,0xb8
.long 0x2044,0x3c0,0x18,0xb8,0x2048,0x3c4,0x58,0xb8
.long 0x204c,0x3c8,0x88,0xb8,0x2050,0x3cc,0xc8,0xb8
.long 0x2054,0x3d0,0x138,0xb8,0x2058,0x3d4,0x178,0xb8
.long 0x205c,0x3d8,0x1a8,0xb8,0x2040,0x3dc,0x1e8,0xb8
.long 0x2064,0x3e0,0x218,0xb8,0x2068,0x3e4,0x258,0xb8
.long 0x206c,0x3e8,0x288,0xb8,0x2070,0x3ec,0x2c8,0xb8
.long 0x2074,0x3f0,0x338,0xb8,0x2078,0x3f4,0x378,0xb8
.long 0x207c,0x3f8,0x3a8,0xb8,0x2080,0x3fc,0x3e8,0xb8
.size ctab, 49152
```
